```python
import torch

def _softmax(x, axis=-1):
    return torch.softmax(x, dim=axis)
def _gelu(x):
    return torch.nn.functional.gelu(x, approximate="tanh")
def _silu(x):
    return torch.nn.functional.silu(x)
def _sigmoid(x):
    return torch.sigmoid(x)
def _layernorm(x, axis=-1, eps=1e-5):
    m = x.mean(dim=axis, keepdim=True)
    v = x.var(dim=axis, keepdim=True, unbiased=False)
    return (x - m) / torch.sqrt(v + eps)
def _scatter_add(tgt, idx, src, axis=0):
    return tgt.clone().index_add_(axis, idx, src)
def _segment_sum(src, seg, n):
    out = torch.zeros((n,) + src.shape[1:], dtype=src.dtype)
    return out.index_add_(0, seg, src)
def _pad(x, pw):
    flat = tuple(v for pair in reversed(pw) for v in pair)
    return torch.nn.functional.pad(x, flat)

kernel_name = 'sequential_preLN__ssm_conv_s4d__geglu_ffn__prompt'

def setup_inputs():

    _w = (lambda a: (lambda t: t.to(torch.bfloat16) if t.is_floating_point() else t)(torch.as_tensor(a)))
    def _A_setup():
        Bsz, L, D, N = 1, 2048, 640, 192
        return {
            "u": _w((lambda *s: torch.randn(*s, dtype=torch.bfloat16) * 0.05)(Bsz, L, D)),
            "log_A_real": _w((lambda *s: torch.randn(*s, dtype=torch.bfloat16) * 6.4)(D, N) * 0.5),
            "A_imag": _w((lambda *s: torch.randn(*s, dtype=torch.bfloat16) * 0.05)(D, N) * 3.14),
            "C_real": _w((lambda *s: torch.randn(*s, dtype=torch.bfloat16) * 0.05)(D, N) / N ** 0.5),
            "C_imag": _w((lambda *s: torch.randn(*s, dtype=torch.bfloat16) * 0.05)(D, N) / N ** 0.5),
            "log_dt": _w((lambda *s: torch.randn(*s, dtype=torch.bfloat16) * 0.05)(D) * 0.5 - 4.0),
            "D_skip": _w((lambda *s: torch.randn(*s, dtype=torch.bfloat16) * 0.05)(D)),
        }
    _A_in = _A_setup()

    def _B_setup():
        B, S, D, F = 1, 2048, 640, 1536
        return {
            "x": _w((lambda *s: torch.randn(*s, dtype=torch.bfloat16) * 0.05)(B, S, D)),
            "w_gate": _w((lambda *s: torch.randn(*s, dtype=torch.bfloat16) * 0.05)(D, F)),
            "w_up": _w((lambda *s: torch.randn(*s, dtype=torch.bfloat16) * 0.05)(D, F)),
            "w_down": _w((lambda *s: torch.randn(*s, dtype=torch.bfloat16) * 0.05)(F, D)),
        }
    _B_in = _B_setup()

    return {
        "A_u": _A_in["u"],
        "A_log_A_real": _A_in["log_A_real"],
        "A_A_imag": _A_in["A_imag"],
        "A_C_real": _A_in["C_real"],
        "A_C_imag": _A_in["C_imag"],
        "A_log_dt": _A_in["log_dt"],
        "A_D_skip": _A_in["D_skip"],
        "B_x": _B_in["x"],
        "B_w_gate": _B_in["w_gate"],
        "B_w_up": _B_in["w_up"],
        "B_w_down": _B_in["w_down"],
    }

def reference(A_u, A_log_A_real, A_A_imag, A_C_real, A_C_imag, A_log_dt, A_D_skip, B_x, B_w_gate, B_w_up, B_w_down):
    def _A_ref(u, log_A_real, A_imag, C_real, C_imag, log_dt, D_skip):
        L = u.shape[1]
        dt = torch.exp(log_dt)
        A = -torch.exp(log_A_real) + 1j * A_imag
        C = (C_real + 1j * C_imag) * dt[:, None]
        pos = (lambda x, dt: x.to(dt))(torch.arange(L), log_dt.dtype)
        P = torch.exp((A * dt[:, None])[:, :, None] * pos[None, None, :])
        K = 2.0 * torch.einsum("dn,dnl->dl", C, P).real
        L2 = 2 * L
        u_t = (lambda x, *d: x.permute(*d))(u, 0, 2, 1)
        Kf = (lambda x, *a, **k: torch.fft.rfft(x.float(), *a, **k))(K, L2)
        Uf = (lambda x, *a, **k: torch.fft.rfft(x.float(), *a, **k))(u_t, L2)
        y = (lambda x, *a, **k: torch.fft.irfft(x, *a, **k).to(torch.bfloat16))(Uf * Kf[None, :, :], L2)[:, :, :L]
        y = (lambda x, *d: x.permute(*d))(y, 0, 2, 1)
        return y + u * D_skip[None, None, :]

    def _B_ref(x, w_gate, w_up, w_down):
        return (_gelu(x @ w_gate) * (x @ w_up)) @ w_down

    x = A_u
    h = x + _A_ref(_layernorm(x, axis=-1), A_log_A_real, A_A_imag, A_C_real, A_C_imag, A_log_dt, A_D_skip)
    h2 = h + _B_ref(_layernorm(h, axis=-1), B_w_gate, B_w_up, B_w_down)
    return h2
```

```asm
; @launch grid=(256,1,1) block=(256,1,1) lds=163840
.amdgcn_target "amdgcn-amd-amdhsa--gfx950"
.text
.p2align 12
.globl sequential_preLN__ssm_conv_s4d__geglu_ffn__prompt_kernel
.p2align 8
.type sequential_preLN__ssm_conv_s4d__geglu_ffn__prompt_kernel,@function
sequential_preLN__ssm_conv_s4d__geglu_ffn__prompt_kernel:

    s_cmp_ge_u32 s2, 256
    s_cbranch_scc1 P_END
    s_add_u32 s2, s2, 160
    s_and_b32 s2, s2, 255
    s_getpc_b64 s[68:69]
P_PC:
    s_sub_u32 s68, s68, P_PC-sequential_preLN__ssm_conv_s4d__geglu_ffn__prompt_kernel
    s_subb_u32 s69, s69, 0
    s_mov_b32 s70, P_END-sequential_preLN__ssm_conv_s4d__geglu_ffn__prompt_kernel
    s_mov_b32 s71, 0x20000
    s_lshr_b32 s31, s2, 3
    s_lshl_b32 s31, s31, 11
    v_lshlrev_b32 v2, 3, v0
    buffer_load_dword v251, v2, s[68:71], s31 offen
    s_load_dwordx16 s[8:23], s[0:1], 0
    s_load_dwordx2 s[4:5], s[0:1], 104
    s_load_dwordx4 s[40:43], s[0:1], 64
    v_lshrrev_b32 v2, 6, v0
    v_and_b32 v1, 63, v0
    s_and_b32 s30, s2, 7
    v_readfirstlane_b32 s28, v2
    s_lshr_b32 s31, s2, 3
    s_lshr_b32 s32, s30, 2
    s_lshl_b32 s32, s32, 3
    s_and_b32 s33, s31, 7
    s_add_u32 s61, s32, s33
    s_and_b32 s32, s30, 3
    s_lshl_b32 s32, s32, 2
    s_lshr_b32 s33, s31, 3
    s_add_u32 s60, s32, s33
    s_lshr_b32 s32, s30, 3
    s_lshl_b32 s32, s32, 3
    s_and_b32 s33, s31, 7
    s_add_u32 s63, s32, s33
    s_and_b32 s32, s30, 7
    s_lshl_b32 s32, s32, 2
    s_lshr_b32 s33, s31, 3
    s_add_u32 s62, s32, s33
    s_lshl_b32 s32, s61, 0
    s_lshl_b32 s33, s60, 1
    s_add_u32 s32, s32, s33
    s_and_b32 s32, s32, 7
    s_mul_i32 s32, s32, 5
    s_lshr_b32 s3, s32, 1
    s_and_b32 s32, s61, 7
    s_mul_i32 s32, s32, 5
    s_lshr_b32 s3, s32, 1
    s_mov_b32 s6, 0
    s_cmp_ge_u32 s2, 160
    s_cbranch_scc1 P_HELP
    s_mul_i32 s29, s30, 20
    s_add_u32 s29, s29, s31
    s_lshl_b32 s30, s29, 2
    s_add_u32 s30, s30, s28
    v_mov_b32 v210, 0
    v_mov_b32 v211, 0
    v_mov_b32 v212, 0
    v_mov_b32 v213, 0
    v_mov_b32 v214, 0
    v_mov_b32 v215, 0
    v_mov_b32 v216, 0
    v_mov_b32 v217, 0
    v_mov_b32 v218, 0
    v_mov_b32 v219, 0
    v_mov_b32 v220, 0
    v_mov_b32 v221, 0
    v_lshlrev_b32 v2, 1, v1
    s_mul_i32 s31, s30, 384
    s_and_b32 s32, s30, 0xfffffffe
    s_lshl_b32 s32, s32, 1
    v_mul_u32_u24 v6, 10240, v0
    s_waitcnt lgkmcnt(0)
    s_add_u32 s64, s4, 28311552
    s_addc_u32 s65, s5, 0
    s_load_dword s59, s[64:65], 0
    s_load_dword s34, s[18:19], s32
    s_load_dword s35, s[20:21], s32
    s_mov_b32 s24, s8
    s_mov_b32 s25, s9
    s_mov_b32 s26, 0x280000
    s_mov_b32 s27, 0x20000
    s_mov_b32 s36, s10
    s_mov_b32 s37, s11
    s_mov_b32 s38, 0x3c000
    s_mov_b32 s39, 0x20000
    s_mov_b32 s44, s12
    s_mov_b32 s45, s13
    s_mov_b32 s46, 0x3c000
    s_mov_b32 s47, 0x20000
    s_mov_b32 s48, s14
    s_mov_b32 s49, s15
    s_mov_b32 s50, 0x3c000
    s_mov_b32 s51, 0x20000
    s_mov_b32 s52, s16
    s_mov_b32 s53, s17
    s_mov_b32 s54, 0x3c000
    s_mov_b32 s55, 0x20000
    buffer_load_short_d16_hi v210, v2, s[36:39], s31 offen offset:0
    buffer_load_short_d16_hi v211, v2, s[44:47], s31 offen offset:0
    buffer_load_short_d16_hi v212, v2, s[48:51], s31 offen offset:0
    buffer_load_short_d16_hi v213, v2, s[52:55], s31 offen offset:0
    buffer_load_short_d16_hi v214, v2, s[36:39], s31 offen offset:128
    buffer_load_short_d16_hi v215, v2, s[44:47], s31 offen offset:128
    buffer_load_short_d16_hi v216, v2, s[48:51], s31 offen offset:128
    buffer_load_short_d16_hi v217, v2, s[52:55], s31 offen offset:128
    buffer_load_short_d16_hi v218, v2, s[36:39], s31 offen offset:256
    buffer_load_short_d16_hi v219, v2, s[44:47], s31 offen offset:256
    buffer_load_short_d16_hi v220, v2, s[48:51], s31 offen offset:256
    buffer_load_short_d16_hi v221, v2, s[52:55], s31 offen offset:256
    s_lshr_b32 s31, s2, 3
    s_lshl_b32 s31, s31, 2
    s_add_u32 s31, s31, s28
    s_mul_i32 s31, s31, 26
    v_lshrrev_b32 v2, 1, v1
    v_min_u32 v2, 25, v2
    v_add_u32 v2, s31, v2
    v_min_u32 v2, 2047, v2
    v_mul_u32_u24 v2, 1280, v2
    v_and_b32 v3, 1, v1
    v_mul_u32_u24 v3, 156, v3
    v_add_u32 v2, v2, v3
    s_and_b32 s31, s2, 7
    s_mul_i32 s31, s31, 160
    buffer_load_dword v250, v2, s[24:27], s31 offen
    s_lshl_b32 s17, s29, 3
    v_lshlrev_b32 v9, 4, v1
    s_lshl_b32 s7, s30, 12
    v_mov_b32 v252, -1
    v_mov_b32 v253, -1
    v_mov_b32 v254, -1
    v_mov_b32 v255, -1
    s_mov_b32 s66, 0x200000
    s_mov_b32 s67, 0x20000
    s_mul_i32 s32, s28, 21792
    s_movk_i32 s33, 272
    s_add_u32 s8, s4, 0x900000
    s_addc_u32 s9, s5, 0
    s_mov_b32 s10, 0x280000
    s_mov_b32 s11, 0x20000
    v_and_b32 v3, 31, v1
    v_lshrrev_b32 v4, 5, v1
    v_lshl_add_u32 v11, v4, 4, s32
    v_mad_u32_u24 v12, v3, s33, v11
    s_mov_b32 s46, 0x9040000
    s_mov_b32 s47, 0x4040
    v_lshlrev_b32 v2, 1, v3
    v_lshrrev_b64 v[146:147], v2, s[46:47]
    v_and_b32 v146, 3, v146
    v_sub_u32 v146, v3, v146
    v_mad_u32_u24 v11, v146, s33, v11
    s_add_u32 s33, s32, 512
    v_lshl_add_u32 v2, v3, 4, s33
    v_lshl_add_u32 v14, v4, 9, v2
    v_lshl_add_u32 v15, v4, 10, v2
    v_mul_u32_u24 v5, 24, v4
    v_add3_u32 v16, v2, v5, 6
    v_lshlrev_b32 v5, 3, v4
    v_sub_u32 v13, v2, v5
    v_add_u32 v13, 8, v13
    v_and_b32 v2, 15, v1
    v_lshrrev_b32 v3, 4, v1
    v_and_b32 v4, 1, v1
    v_lshlrev_b32 v3, 4, v3
    s_add_u32 s33, s32, 13480
    v_lshl_add_u32 v17, v2, 2, s33
    v_mul_u32_u24 v5, 4228, v4
    v_sub_u32 v17, v17, v5
    v_add_u32 v17, v17, v3
    v_lshrrev_b32 v2, 1, v2
    v_lshlrev_b32 v2, 6, v2
    s_add_u32 s33, s32, 112
    v_mul_u32_u24 v5, 4640, v4
    v_add3_u32 v18, v2, v5, s33
    v_sub_u32 v18, v18, v3
    s_add_u32 s33, s32, 17696
    v_lshl_add_u32 v5, v4, 3, s33
    v_add3_u32 v19, v2, v3, v5
    v_lshlrev_b32 v20, 4, v0
    s_lshl_b32 s33, s28, 12
    s_add_u32 s33, s33, 4096
    v_lshl_add_u32 v21, v1, 4, s33
    v_cmp_eq_u32 s[68:69], 1, v4
    v_cmp_eq_u32 vcc, 0, v1
    s_mov_b32 m0, s32
    s_waitcnt lgkmcnt(0)
    s_add_u32 s59, s59, 1
    s_and_b32 s31, s30, 1
    s_lshl_b32 s31, s31, 4
    s_lshr_b32 s34, s34, s31
    s_lshl_b32 s34, s34, 16
    s_lshr_b32 s35, s35, s31
    s_lshl_b32 s35, s35, 16
    v_mov_b32 v23, s35
    v_cndmask_b32 v23, 0, v23, vcc
    v_mov_b32 v2, 0x3f80
    ds_write_addtid_b32 v2 offset:8704
    v_mov_b32 v222, 0x3fb8aa3b
    v_mul_f32 v222, s34, v222
    v_exp_f32 v222, v222
    s_nop 0
    v_cvt_pk_bf16_f32 v222, 0, v222
    v_add_f32 v223, v222, v222
    s_mov_b32 s12, 0x3e22f983
    s_mov_b32 s13, 0x31dc9c88
    s_mov_b32 s14, 0x3fb8aa3b
    s_mov_b32 s15, 0x41000000
    s_mov_b32 s16, 0x43800000
    s_waitcnt vmcnt(9)
    v_mul_f32 v210, s14, v210
    v_exp_f32 v210, v210
    v_mul_f32 v211, v211, v222
    v_mul_f32 v146, s12, v211
    v_fma_f32 v147, v211, s12, -v146
    v_cvt_pk_bf16_f32 v210, 0, v210
    v_fma_f32 v147, v211, s13, v147
    v_mul_f32 v210, v210, v222
    v_fract_f32 v148, v146
    v_mul_f32 v210, s14, v210
    v_mul_f32 v149, s15, v148
    v_mul_f32 v150, s16, v148
    v_add_f32 v148, v148, v147
    v_fract_f32 v149, v149
    v_fract_f32 v150, v150
    v_fma_f32 v149, v147, s15, v149
    v_fma_f32 v150, v147, s16, v150
    v_mul_f32 v152, s15, v210
    v_mul_f32 v154, s16, v210
    v_cos_f32 v138, v149
    v_sin_f32 v139, v149
    v_exp_f32 v152, -v152
    v_cos_f32 v136, v148
    v_sin_f32 v137, v148
    v_exp_f32 v156, -v210
    v_cos_f32 v140, v150
    v_sin_f32 v141, v150
    v_exp_f32 v154, -v154
    v_mul_f32 v142, v212, v223
    v_mul_f32 v143, v213, v223
    v_mul_f32 v138, v138, v152
    v_mul_f32 v139, v139, v152
    v_mul_f32 v136, v136, v156
    v_mul_f32 v137, v137, v156
    v_mul_f32 v140, v140, v154
    v_mul_f32 v141, v141, v154
    v_pk_mul_f32 v[144:145], v[142:143], v[138:139] op_sel_hi:[1,0]
    v_cvt_pk_bf16_f32 v194, v142, v143
    v_pk_fma_f32 v[144:145], v[142:143], v[138:139], v[144:145] op_sel:[1,1,0] op_sel_hi:[0,1,1] neg_lo:[1,0,0]
    v_pk_mul_f32 v[142:143], v[144:145], v[138:139] op_sel_hi:[1,0]
    v_cvt_pk_bf16_f32 v196, v144, v145
    v_pk_fma_f32 v[142:143], v[144:145], v[138:139], v[142:143] op_sel:[1,1,0] op_sel_hi:[0,1,1] neg_lo:[1,0,0]
    v_cvt_pk_bf16_f32 v197, v136, -v137
    v_pk_mul_f32 v[146:147], v[136:137], v[136:137] op_sel_hi:[1,0]
    v_pk_mul_f32 v[144:145], v[142:143], v[138:139] op_sel_hi:[1,0]
    v_pk_fma_f32 v[146:147], v[136:137], v[136:137], v[146:147] op_sel:[1,1,0] op_sel_hi:[0,1,1] neg_lo:[1,0,0]
    v_cvt_pk_bf16_f32 v198, v142, v143
    v_pk_fma_f32 v[144:145], v[142:143], v[138:139], v[144:145] op_sel:[1,1,0] op_sel_hi:[0,1,1] neg_lo:[1,0,0]
    v_cvt_pk_bf16_f32 v199, v146, -v147
    v_pk_mul_f32 v[148:149], v[146:147], v[136:137] op_sel_hi:[1,0]
    v_pk_mul_f32 v[142:143], v[144:145], v[138:139] op_sel_hi:[1,0]
    v_pk_fma_f32 v[148:149], v[146:147], v[136:137], v[148:149] op_sel:[1,1,0] op_sel_hi:[0,1,1] neg_lo:[1,0,0]
    v_cvt_pk_bf16_f32 v200, v144, v145
    v_pk_fma_f32 v[142:143], v[144:145], v[138:139], v[142:143] op_sel:[1,1,0] op_sel_hi:[0,1,1] neg_lo:[1,0,0]
    v_cvt_pk_bf16_f32 v201, v148, -v149
    v_pk_mul_f32 v[150:151], v[148:149], v[136:137] op_sel_hi:[1,0]
    v_pk_mul_f32 v[144:145], v[142:143], v[138:139] op_sel_hi:[1,0]
    v_pk_fma_f32 v[150:151], v[148:149], v[136:137], v[150:151] op_sel:[1,1,0] op_sel_hi:[0,1,1] neg_lo:[1,0,0]
    v_cvt_pk_bf16_f32 v202, v142, v143
    v_pk_fma_f32 v[144:145], v[142:143], v[138:139], v[144:145] op_sel:[1,1,0] op_sel_hi:[0,1,1] neg_lo:[1,0,0]
    v_cvt_pk_bf16_f32 v203, v150, -v151
    v_pk_mul_f32 v[152:153], v[150:151], v[136:137] op_sel_hi:[1,0]
    v_pk_mul_f32 v[142:143], v[144:145], v[138:139] op_sel_hi:[1,0]
    v_pk_fma_f32 v[152:153], v[150:151], v[136:137], v[152:153] op_sel:[1,1,0] op_sel_hi:[0,1,1] neg_lo:[1,0,0]
    v_cvt_pk_bf16_f32 v204, v144, v145
    v_pk_fma_f32 v[142:143], v[144:145], v[138:139], v[142:143] op_sel:[1,1,0] op_sel_hi:[0,1,1] neg_lo:[1,0,0]
    v_cvt_pk_bf16_f32 v205, v152, -v153
    v_pk_mul_f32 v[154:155], v[152:153], v[136:137] op_sel_hi:[1,0]
    v_pk_mul_f32 v[144:145], v[142:143], v[138:139] op_sel_hi:[1,0]
    v_pk_fma_f32 v[154:155], v[152:153], v[136:137], v[154:155] op_sel:[1,1,0] op_sel_hi:[0,1,1] neg_lo:[1,0,0]
    v_cvt_pk_bf16_f32 v206, v142, v143
    v_pk_fma_f32 v[144:145], v[142:143], v[138:139], v[144:145] op_sel:[1,1,0] op_sel_hi:[0,1,1] neg_lo:[1,0,0]
    v_cvt_pk_bf16_f32 v207, v154, -v155
    v_pk_mul_f32 v[156:157], v[154:155], v[136:137] op_sel_hi:[1,0]
    v_pk_mul_f32 v[142:143], v[144:145], v[138:139] op_sel_hi:[1,0]
    v_pk_fma_f32 v[156:157], v[154:155], v[136:137], v[156:157] op_sel:[1,1,0] op_sel_hi:[0,1,1] neg_lo:[1,0,0]
    v_cvt_pk_bf16_f32 v208, v144, v145
    v_pk_fma_f32 v[142:143], v[144:145], v[138:139], v[142:143] op_sel:[1,1,0] op_sel_hi:[0,1,1] neg_lo:[1,0,0]
    v_cvt_pk_bf16_f32 v209, v156, -v157
    ds_write_addtid_b32 v194 offset:0
    ds_write_addtid_b32 v196 offset:272
    ds_write_addtid_b32 v197 offset:8976
    ds_write_addtid_b32 v198 offset:544
    ds_write_addtid_b32 v199 offset:9248
    ds_write_addtid_b32 v200 offset:816
    ds_write_addtid_b32 v201 offset:9520
    ds_write_addtid_b32 v202 offset:1088
    ds_write_addtid_b32 v203 offset:9792
    ds_write_addtid_b32 v204 offset:1360
    ds_write_addtid_b32 v205 offset:10064
    ds_write_addtid_b32 v206 offset:1632
    ds_write_addtid_b32 v207 offset:10336
    ds_write_addtid_b32 v208 offset:1904
    ds_write_addtid_b32 v209 offset:10608
    v_pk_mul_f32 v[144:145], v[142:143], v[138:139] op_sel_hi:[1,0]
    v_cvt_pk_bf16_f32 v194, v142, v143
    v_pk_fma_f32 v[144:145], v[142:143], v[138:139], v[144:145] op_sel:[1,1,0] op_sel_hi:[0,1,1] neg_lo:[1,0,0]
    v_cvt_pk_bf16_f32 v195, v140, -v141
    v_pk_mul_f32 v[142:143], v[144:145], v[138:139] op_sel_hi:[1,0]
    v_cvt_pk_bf16_f32 v196, v144, v145
    v_pk_fma_f32 v[142:143], v[144:145], v[138:139], v[142:143] op_sel:[1,1,0] op_sel_hi:[0,1,1] neg_lo:[1,0,0]
    v_pk_mul_f32 v[158:159], v[146:147], v[140:141] op_sel_hi:[1,0]
    v_pk_mul_f32 v[144:145], v[142:143], v[138:139] op_sel_hi:[1,0]
    v_pk_fma_f32 v[158:159], v[146:147], v[140:141], v[158:159] op_sel:[1,1,0] op_sel_hi:[0,1,1] neg_lo:[1,0,0]
    v_cvt_pk_bf16_f32 v198, v142, v143
    v_pk_fma_f32 v[144:145], v[142:143], v[138:139], v[144:145] op_sel:[1,1,0] op_sel_hi:[0,1,1] neg_lo:[1,0,0]
    v_cvt_pk_bf16_f32 v199, v158, -v159
    v_pk_mul_f32 v[160:161], v[150:151], v[140:141] op_sel_hi:[1,0]
    v_pk_mul_f32 v[142:143], v[144:145], v[138:139] op_sel_hi:[1,0]
    v_pk_fma_f32 v[160:161], v[150:151], v[140:141], v[160:161] op_sel:[1,1,0] op_sel_hi:[0,1,1] neg_lo:[1,0,0]
    v_cvt_pk_bf16_f32 v200, v144, v145
    v_pk_fma_f32 v[142:143], v[144:145], v[138:139], v[142:143] op_sel:[1,1,0] op_sel_hi:[0,1,1] neg_lo:[1,0,0]
    v_cvt_pk_bf16_f32 v201, v160, -v161
    v_pk_mul_f32 v[144:145], v[142:143], v[138:139] op_sel_hi:[1,0]
    v_cvt_pk_bf16_f32 v202, v142, v143
    v_pk_fma_f32 v[144:145], v[142:143], v[138:139], v[144:145] op_sel:[1,1,0] op_sel_hi:[0,1,1] neg_lo:[1,0,0]
    v_pk_mul_f32 v[142:143], v[144:145], v[138:139] op_sel_hi:[1,0]
    v_cvt_pk_bf16_f32 v204, v144, v145
    v_pk_fma_f32 v[142:143], v[144:145], v[138:139], v[142:143] op_sel:[1,1,0] op_sel_hi:[0,1,1] neg_lo:[1,0,0]
    v_pk_mul_f32 v[162:163], v[154:155], v[140:141] op_sel_hi:[1,0]
    v_pk_mul_f32 v[144:145], v[142:143], v[138:139] op_sel_hi:[1,0]
    v_pk_fma_f32 v[162:163], v[154:155], v[140:141], v[162:163] op_sel:[1,1,0] op_sel_hi:[0,1,1] neg_lo:[1,0,0]
    v_cvt_pk_bf16_f32 v206, v142, v143
    v_pk_fma_f32 v[144:145], v[142:143], v[138:139], v[144:145] op_sel:[1,1,0] op_sel_hi:[0,1,1] neg_lo:[1,0,0]
    v_cvt_pk_bf16_f32 v207, v162, -v163
    v_pk_mul_f32 v[164:165], v[138:139], v[140:141] op_sel_hi:[1,0]
    v_pk_mul_f32 v[142:143], v[144:145], v[138:139] op_sel_hi:[1,0]
    v_pk_fma_f32 v[164:165], v[138:139], v[140:141], v[164:165] op_sel:[1,1,0] op_sel_hi:[0,1,1] neg_lo:[1,0,0]
    v_cvt_pk_bf16_f32 v208, v144, v145
    v_pk_fma_f32 v[142:143], v[144:145], v[138:139], v[142:143] op_sel:[1,1,0] op_sel_hi:[0,1,1] neg_lo:[1,0,0]
    v_cvt_pk_bf16_f32 v209, v164, -v165
    ds_write_addtid_b32 v194 offset:2176
    ds_write_addtid_b32 v195 offset:10880
    ds_write_addtid_b32 v196 offset:2448
    ds_write_addtid_b32 v198 offset:2720
    ds_write_addtid_b32 v199 offset:11424
    ds_write_addtid_b32 v200 offset:2992
    ds_write_addtid_b32 v201 offset:11696
    ds_write_addtid_b32 v202 offset:3264
    ds_write_addtid_b32 v204 offset:3536
    ds_write_addtid_b32 v206 offset:3808
    ds_write_addtid_b32 v207 offset:12512
    ds_write_addtid_b32 v208 offset:4080
    ds_write_addtid_b32 v209 offset:12784
    v_pk_mul_f32 v[166:167], v[140:141], v[140:141] op_sel_hi:[1,0]
    v_pk_mul_f32 v[144:145], v[142:143], v[138:139] op_sel_hi:[1,0]
    v_pk_fma_f32 v[166:167], v[140:141], v[140:141], v[166:167] op_sel:[1,1,0] op_sel_hi:[0,1,1] neg_lo:[1,0,0]
    v_cvt_pk_bf16_f32 v194, v142, v143
    v_pk_fma_f32 v[144:145], v[142:143], v[138:139], v[144:145] op_sel:[1,1,0] op_sel_hi:[0,1,1] neg_lo:[1,0,0]
    v_cvt_pk_bf16_f32 v195, v166, -v167
    v_pk_mul_f32 v[168:169], v[160:161], v[140:141] op_sel_hi:[1,0]
    v_pk_mul_f32 v[142:143], v[144:145], v[138:139] op_sel_hi:[1,0]
    v_pk_fma_f32 v[168:169], v[160:161], v[140:141], v[168:169] op_sel:[1,1,0] op_sel_hi:[0,1,1] neg_lo:[1,0,0]
    v_cvt_pk_bf16_f32 v196, v144, v145
    v_pk_fma_f32 v[142:143], v[144:145], v[138:139], v[142:143] op_sel:[1,1,0] op_sel_hi:[0,1,1] neg_lo:[1,0,0]
    v_cvt_pk_bf16_f32 v197, v168, -v169
    v_pk_mul_f32 v[170:171], v[164:165], v[140:141] op_sel_hi:[1,0]
    v_pk_mul_f32 v[144:145], v[142:143], v[138:139] op_sel_hi:[1,0]
    v_pk_fma_f32 v[170:171], v[164:165], v[140:141], v[170:171] op_sel:[1,1,0] op_sel_hi:[0,1,1] neg_lo:[1,0,0]
    v_cvt_pk_bf16_f32 v198, v142, v143
    v_pk_fma_f32 v[144:145], v[142:143], v[138:139], v[144:145] op_sel:[1,1,0] op_sel_hi:[0,1,1] neg_lo:[1,0,0]
    v_cvt_pk_bf16_f32 v199, v170, -v171
    v_pk_mul_f32 v[142:143], v[144:145], v[138:139] op_sel_hi:[1,0]
    v_cvt_pk_bf16_f32 v200, v144, v145
    v_pk_fma_f32 v[142:143], v[144:145], v[138:139], v[142:143] op_sel:[1,1,0] op_sel_hi:[0,1,1] neg_lo:[1,0,0]
    v_pk_mul_f32 v[172:173], v[166:167], v[140:141] op_sel_hi:[1,0]
    v_pk_mul_f32 v[144:145], v[142:143], v[138:139] op_sel_hi:[1,0]
    v_pk_fma_f32 v[172:173], v[166:167], v[140:141], v[172:173] op_sel:[1,1,0] op_sel_hi:[0,1,1] neg_lo:[1,0,0]
    v_cvt_pk_bf16_f32 v202, v142, v143
    v_pk_fma_f32 v[144:145], v[142:143], v[138:139], v[144:145] op_sel:[1,1,0] op_sel_hi:[0,1,1] neg_lo:[1,0,0]
    v_cvt_pk_bf16_f32 v203, v172, -v173
    v_pk_mul_f32 v[174:175], v[168:169], v[140:141] op_sel_hi:[1,0]
    v_pk_mul_f32 v[142:143], v[144:145], v[138:139] op_sel_hi:[1,0]
    v_pk_fma_f32 v[174:175], v[168:169], v[140:141], v[174:175] op_sel:[1,1,0] op_sel_hi:[0,1,1] neg_lo:[1,0,0]
    v_cvt_pk_bf16_f32 v204, v144, v145
    v_pk_fma_f32 v[142:143], v[144:145], v[138:139], v[142:143] op_sel:[1,1,0] op_sel_hi:[0,1,1] neg_lo:[1,0,0]
    v_cvt_pk_bf16_f32 v205, v174, -v175
    v_pk_mul_f32 v[176:177], v[170:171], v[140:141] op_sel_hi:[1,0]
    v_pk_mul_f32 v[144:145], v[142:143], v[138:139] op_sel_hi:[1,0]
    v_pk_fma_f32 v[176:177], v[170:171], v[140:141], v[176:177] op_sel:[1,1,0] op_sel_hi:[0,1,1] neg_lo:[1,0,0]
    v_cvt_pk_bf16_f32 v206, v142, v143
    v_pk_fma_f32 v[144:145], v[142:143], v[138:139], v[144:145] op_sel:[1,1,0] op_sel_hi:[0,1,1] neg_lo:[1,0,0]
    v_cvt_pk_bf16_f32 v207, v176, -v177
    v_pk_mul_f32 v[142:143], v[144:145], v[138:139] op_sel_hi:[1,0]
    v_cvt_pk_bf16_f32 v208, v144, v145
    v_pk_fma_f32 v[142:143], v[144:145], v[138:139], v[142:143] op_sel:[1,1,0] op_sel_hi:[0,1,1] neg_lo:[1,0,0]
    ds_write_addtid_b32 v194 offset:4352
    ds_write_addtid_b32 v195 offset:13056
    ds_write_addtid_b32 v196 offset:4624
    ds_write_addtid_b32 v197 offset:13328
    ds_write_addtid_b32 v198 offset:4896
    ds_write_addtid_b32 v199 offset:13600
    ds_write_addtid_b32 v200 offset:5168
    ds_write_addtid_b32 v202 offset:5440
    ds_write_addtid_b32 v203 offset:14144
    ds_write_addtid_b32 v204 offset:5712
    ds_write_addtid_b32 v205 offset:14416
    ds_write_addtid_b32 v206 offset:5984
    ds_write_addtid_b32 v207 offset:14688
    ds_write_addtid_b32 v208 offset:6256
    v_pk_mul_f32 v[178:179], v[172:173], v[140:141] op_sel_hi:[1,0]
    v_pk_mul_f32 v[144:145], v[142:143], v[138:139] op_sel_hi:[1,0]
    v_pk_fma_f32 v[178:179], v[172:173], v[140:141], v[178:179] op_sel:[1,1,0] op_sel_hi:[0,1,1] neg_lo:[1,0,0]
    v_cvt_pk_bf16_f32 v194, v142, v143
    v_pk_fma_f32 v[144:145], v[142:143], v[138:139], v[144:145] op_sel:[1,1,0] op_sel_hi:[0,1,1] neg_lo:[1,0,0]
    v_cvt_pk_bf16_f32 v195, v178, -v179
    v_pk_mul_f32 v[180:181], v[176:177], v[140:141] op_sel_hi:[1,0]
    v_pk_mul_f32 v[142:143], v[144:145], v[138:139] op_sel_hi:[1,0]
    v_pk_fma_f32 v[180:181], v[176:177], v[140:141], v[180:181] op_sel:[1,1,0] op_sel_hi:[0,1,1] neg_lo:[1,0,0]
    v_cvt_pk_bf16_f32 v196, v144, v145
    v_pk_fma_f32 v[142:143], v[144:145], v[138:139], v[142:143] op_sel:[1,1,0] op_sel_hi:[0,1,1] neg_lo:[1,0,0]
    v_cvt_pk_bf16_f32 v197, v180, -v181
    v_pk_mul_f32 v[182:183], v[178:179], v[140:141] op_sel_hi:[1,0]
    v_pk_mul_f32 v[144:145], v[142:143], v[138:139] op_sel_hi:[1,0]
    v_pk_fma_f32 v[182:183], v[178:179], v[140:141], v[182:183] op_sel:[1,1,0] op_sel_hi:[0,1,1] neg_lo:[1,0,0]
    v_cvt_pk_bf16_f32 v198, v142, v143
    v_pk_fma_f32 v[144:145], v[142:143], v[138:139], v[144:145] op_sel:[1,1,0] op_sel_hi:[0,1,1] neg_lo:[1,0,0]
    v_cvt_pk_bf16_f32 v199, v182, -v183
    v_pk_mul_f32 v[184:185], v[180:181], v[140:141] op_sel_hi:[1,0]
    v_pk_mul_f32 v[142:143], v[144:145], v[138:139] op_sel_hi:[1,0]
    v_pk_fma_f32 v[184:185], v[180:181], v[140:141], v[184:185] op_sel:[1,1,0] op_sel_hi:[0,1,1] neg_lo:[1,0,0]
    v_cvt_pk_bf16_f32 v200, v144, v145
    v_pk_fma_f32 v[142:143], v[144:145], v[138:139], v[142:143] op_sel:[1,1,0] op_sel_hi:[0,1,1] neg_lo:[1,0,0]
    v_cvt_pk_bf16_f32 v201, v184, -v185
    v_pk_mul_f32 v[186:187], v[182:183], v[140:141] op_sel_hi:[1,0]
    v_pk_mul_f32 v[144:145], v[142:143], v[138:139] op_sel_hi:[1,0]
    v_pk_fma_f32 v[186:187], v[182:183], v[140:141], v[186:187] op_sel:[1,1,0] op_sel_hi:[0,1,1] neg_lo:[1,0,0]
    v_cvt_pk_bf16_f32 v202, v142, v143
    v_pk_fma_f32 v[144:145], v[142:143], v[138:139], v[144:145] op_sel:[1,1,0] op_sel_hi:[0,1,1] neg_lo:[1,0,0]
    v_cvt_pk_bf16_f32 v203, v186, -v187
    v_pk_mul_f32 v[188:189], v[184:185], v[140:141] op_sel_hi:[1,0]
    v_pk_mul_f32 v[142:143], v[144:145], v[138:139] op_sel_hi:[1,0]
    v_pk_fma_f32 v[188:189], v[184:185], v[140:141], v[188:189] op_sel:[1,1,0] op_sel_hi:[0,1,1] neg_lo:[1,0,0]
    v_cvt_pk_bf16_f32 v204, v144, v145
    v_pk_fma_f32 v[142:143], v[144:145], v[138:139], v[142:143] op_sel:[1,1,0] op_sel_hi:[0,1,1] neg_lo:[1,0,0]
    v_cvt_pk_bf16_f32 v205, v188, -v189
    v_pk_mul_f32 v[190:191], v[186:187], v[140:141] op_sel_hi:[1,0]
    v_pk_mul_f32 v[144:145], v[142:143], v[138:139] op_sel_hi:[1,0]
    v_pk_fma_f32 v[190:191], v[186:187], v[140:141], v[190:191] op_sel:[1,1,0] op_sel_hi:[0,1,1] neg_lo:[1,0,0]
    v_cvt_pk_bf16_f32 v206, v142, v143
    v_pk_fma_f32 v[144:145], v[142:143], v[138:139], v[144:145] op_sel:[1,1,0] op_sel_hi:[0,1,1] neg_lo:[1,0,0]
    v_cvt_pk_bf16_f32 v207, v190, -v191
    v_pk_mul_f32 v[192:193], v[188:189], v[140:141] op_sel_hi:[1,0]
    v_pk_fma_f32 v[192:193], v[188:189], v[140:141], v[192:193] op_sel:[1,1,0] op_sel_hi:[0,1,1] neg_lo:[1,0,0]
    v_cvt_pk_bf16_f32 v208, v144, v145
    v_cvt_pk_bf16_f32 v209, v192, -v193
    ds_write_addtid_b32 v194 offset:6528
    ds_write_addtid_b32 v195 offset:15232
    ds_write_addtid_b32 v196 offset:6800
    ds_write_addtid_b32 v197 offset:15504
    ds_write_addtid_b32 v198 offset:7072
    ds_write_addtid_b32 v199 offset:15776
    ds_write_addtid_b32 v200 offset:7344
    ds_write_addtid_b32 v201 offset:16048
    ds_write_addtid_b32 v202 offset:7616
    ds_write_addtid_b32 v203 offset:16320
    ds_write_addtid_b32 v204 offset:7888
    ds_write_addtid_b32 v205 offset:16592
    ds_write_addtid_b32 v206 offset:8160
    ds_write_addtid_b32 v207 offset:16864
    ds_write_addtid_b32 v208 offset:8432
    ds_write_addtid_b32 v209 offset:17136
    buffer_load_dwordx2 v[24:25], v6, s[24:27], s17 offen offset:0
    buffer_load_dwordx2 v[26:27], v6, s[24:27], s17 offen offset:1280
    ds_read_b128 v[72:75], v11 offset:8704
    ds_read_b128 v[104:107], v12 offset:0
    ds_read_b128 v[76:79], v11 offset:8736
    ds_read_b128 v[108:111], v12 offset:32
    ds_read_b128 v[80:83], v11 offset:8768
    ds_read_b128 v[112:115], v12 offset:64
    ds_read_b128 v[84:87], v11 offset:8800
    ds_read_b128 v[116:119], v12 offset:96
    ds_read_b128 v[88:91], v11 offset:8832
    ds_read_b128 v[120:123], v12 offset:128
    ds_read_b128 v[92:95], v11 offset:8864
    ds_read_b128 v[124:127], v12 offset:160
    ds_read_b128 v[96:99], v11 offset:8896
    ds_read_b128 v[128:131], v12 offset:192
    ds_read_b128 v[100:103], v11 offset:8928
    ds_read_b128 v[132:135], v12 offset:224
    s_waitcnt vmcnt(7)
    v_mul_f32 v214, s14, v214
    v_exp_f32 v214, v214
    v_mul_f32 v215, v215, v222
    v_mul_f32 v146, s12, v215
    v_fma_f32 v147, v215, s12, -v146
    v_cvt_pk_bf16_f32 v214, 0, v214
    v_fma_f32 v147, v215, s13, v147
    v_mul_f32 v214, v214, v222
    v_fract_f32 v148, v146
    v_mul_f32 v214, s14, v214
    v_mul_f32 v149, s15, v148
    v_mul_f32 v150, s16, v148
    v_add_f32 v148, v148, v147
    v_fract_f32 v149, v149
    v_fract_f32 v150, v150
    v_fma_f32 v149, v147, s15, v149
    v_fma_f32 v150, v147, s16, v150
    v_mul_f32 v152, s15, v214
    v_mul_f32 v154, s16, v214
    v_cos_f32 v138, v149
    v_sin_f32 v139, v149
    v_exp_f32 v152, -v152
    v_cos_f32 v136, v148
    v_sin_f32 v137, v148
    v_exp_f32 v156, -v214
    v_cos_f32 v140, v150
    v_sin_f32 v141, v150
    v_exp_f32 v154, -v154
    v_mul_f32 v142, v216, v223
    v_mul_f32 v143, v217, v223
    v_mul_f32 v138, v138, v152
    v_mul_f32 v139, v139, v152
    v_mul_f32 v136, v136, v156
    v_mul_f32 v137, v137, v156
    v_mul_f32 v140, v140, v154
    v_mul_f32 v141, v141, v154
    v_pk_mul_f32 v[144:145], v[142:143], v[138:139] op_sel_hi:[1,0]
    v_cvt_pk_bf16_f32 v194, v142, v143
    v_pk_fma_f32 v[144:145], v[142:143], v[138:139], v[144:145] op_sel:[1,1,0] op_sel_hi:[0,1,1] neg_lo:[1,0,0]
    v_pk_mul_f32 v[142:143], v[144:145], v[138:139] op_sel_hi:[1,0]
    v_cvt_pk_bf16_f32 v196, v144, v145
    v_pk_fma_f32 v[142:143], v[144:145], v[138:139], v[142:143] op_sel:[1,1,0] op_sel_hi:[0,1,1] neg_lo:[1,0,0]
    v_cvt_pk_bf16_f32 v197, v136, -v137
    v_pk_mul_f32 v[146:147], v[136:137], v[136:137] op_sel_hi:[1,0]
    v_pk_mul_f32 v[144:145], v[142:143], v[138:139] op_sel_hi:[1,0]
    v_pk_fma_f32 v[146:147], v[136:137], v[136:137], v[146:147] op_sel:[1,1,0] op_sel_hi:[0,1,1] neg_lo:[1,0,0]
    v_cvt_pk_bf16_f32 v198, v142, v143
    v_pk_fma_f32 v[144:145], v[142:143], v[138:139], v[144:145] op_sel:[1,1,0] op_sel_hi:[0,1,1] neg_lo:[1,0,0]
    v_cvt_pk_bf16_f32 v199, v146, -v147
    v_pk_mul_f32 v[148:149], v[146:147], v[136:137] op_sel_hi:[1,0]
    v_pk_mul_f32 v[142:143], v[144:145], v[138:139] op_sel_hi:[1,0]
    v_pk_fma_f32 v[148:149], v[146:147], v[136:137], v[148:149] op_sel:[1,1,0] op_sel_hi:[0,1,1] neg_lo:[1,0,0]
    v_cvt_pk_bf16_f32 v200, v144, v145
    v_pk_fma_f32 v[142:143], v[144:145], v[138:139], v[142:143] op_sel:[1,1,0] op_sel_hi:[0,1,1] neg_lo:[1,0,0]
    v_cvt_pk_bf16_f32 v201, v148, -v149
    v_pk_mul_f32 v[150:151], v[148:149], v[136:137] op_sel_hi:[1,0]
    v_pk_mul_f32 v[144:145], v[142:143], v[138:139] op_sel_hi:[1,0]
    v_pk_fma_f32 v[150:151], v[148:149], v[136:137], v[150:151] op_sel:[1,1,0] op_sel_hi:[0,1,1] neg_lo:[1,0,0]
    v_cvt_pk_bf16_f32 v202, v142, v143
    v_pk_fma_f32 v[144:145], v[142:143], v[138:139], v[144:145] op_sel:[1,1,0] op_sel_hi:[0,1,1] neg_lo:[1,0,0]
    v_cvt_pk_bf16_f32 v203, v150, -v151
    v_pk_mul_f32 v[152:153], v[150:151], v[136:137] op_sel_hi:[1,0]
    v_pk_mul_f32 v[142:143], v[144:145], v[138:139] op_sel_hi:[1,0]
    v_pk_fma_f32 v[152:153], v[150:151], v[136:137], v[152:153] op_sel:[1,1,0] op_sel_hi:[0,1,1] neg_lo:[1,0,0]
    v_cvt_pk_bf16_f32 v204, v144, v145
    v_pk_fma_f32 v[142:143], v[144:145], v[138:139], v[142:143] op_sel:[1,1,0] op_sel_hi:[0,1,1] neg_lo:[1,0,0]
    v_cvt_pk_bf16_f32 v205, v152, -v153
    v_pk_mul_f32 v[154:155], v[152:153], v[136:137] op_sel_hi:[1,0]
    v_pk_mul_f32 v[144:145], v[142:143], v[138:139] op_sel_hi:[1,0]
    v_pk_fma_f32 v[154:155], v[152:153], v[136:137], v[154:155] op_sel:[1,1,0] op_sel_hi:[0,1,1] neg_lo:[1,0,0]
    v_cvt_pk_bf16_f32 v206, v142, v143
    v_pk_fma_f32 v[144:145], v[142:143], v[138:139], v[144:145] op_sel:[1,1,0] op_sel_hi:[0,1,1] neg_lo:[1,0,0]
    v_cvt_pk_bf16_f32 v207, v154, -v155
    v_pk_mul_f32 v[156:157], v[154:155], v[136:137] op_sel_hi:[1,0]
    v_pk_mul_f32 v[142:143], v[144:145], v[138:139] op_sel_hi:[1,0]
    v_pk_fma_f32 v[156:157], v[154:155], v[136:137], v[156:157] op_sel:[1,1,0] op_sel_hi:[0,1,1] neg_lo:[1,0,0]
    v_cvt_pk_bf16_f32 v208, v144, v145
    v_pk_fma_f32 v[142:143], v[144:145], v[138:139], v[142:143] op_sel:[1,1,0] op_sel_hi:[0,1,1] neg_lo:[1,0,0]
    v_cvt_pk_bf16_f32 v209, v156, -v157
    s_waitcnt lgkmcnt(0)
    v_mfma_f32_32x32x16_bf16 v[56:71], v[72:75], v[104:107], 0
    ds_write_addtid_b32 v194 offset:0
    ds_write_addtid_b32 v196 offset:272
    ds_write_addtid_b32 v197 offset:8976
    ds_write_addtid_b32 v198 offset:544
    ds_write_addtid_b32 v199 offset:9248
    v_mfma_f32_32x32x16_bf16 v[56:71], v[76:79], v[108:111], v[56:71]
    ds_write_addtid_b32 v200 offset:816
    ds_write_addtid_b32 v201 offset:9520
    ds_write_addtid_b32 v202 offset:1088
    ds_write_addtid_b32 v203 offset:9792
    ds_write_addtid_b32 v204 offset:1360
    v_mfma_f32_32x32x16_bf16 v[56:71], v[80:83], v[112:115], v[56:71]
    ds_write_addtid_b32 v205 offset:10064
    ds_write_addtid_b32 v206 offset:1632
    ds_write_addtid_b32 v207 offset:10336
    ds_write_addtid_b32 v208 offset:1904
    ds_write_addtid_b32 v209 offset:10608
    buffer_load_dwordx2 v[28:29], v6, s[24:27], s17 offen offset:2560
    v_pk_mul_f32 v[144:145], v[142:143], v[138:139] op_sel_hi:[1,0]
    v_cvt_pk_bf16_f32 v194, v142, v143
    v_pk_fma_f32 v[144:145], v[142:143], v[138:139], v[144:145] op_sel:[1,1,0] op_sel_hi:[0,1,1] neg_lo:[1,0,0]
    v_cvt_pk_bf16_f32 v195, v140, -v141
    v_pk_mul_f32 v[142:143], v[144:145], v[138:139] op_sel_hi:[1,0]
    v_cvt_pk_bf16_f32 v196, v144, v145
    v_pk_fma_f32 v[142:143], v[144:145], v[138:139], v[142:143] op_sel:[1,1,0] op_sel_hi:[0,1,1] neg_lo:[1,0,0]
    v_pk_mul_f32 v[158:159], v[146:147], v[140:141] op_sel_hi:[1,0]
    v_pk_mul_f32 v[144:145], v[142:143], v[138:139] op_sel_hi:[1,0]
    v_pk_fma_f32 v[158:159], v[146:147], v[140:141], v[158:159] op_sel:[1,1,0] op_sel_hi:[0,1,1] neg_lo:[1,0,0]
    v_cvt_pk_bf16_f32 v198, v142, v143
    v_pk_fma_f32 v[144:145], v[142:143], v[138:139], v[144:145] op_sel:[1,1,0] op_sel_hi:[0,1,1] neg_lo:[1,0,0]
    v_cvt_pk_bf16_f32 v199, v158, -v159
    v_pk_mul_f32 v[160:161], v[150:151], v[140:141] op_sel_hi:[1,0]
    v_pk_mul_f32 v[142:143], v[144:145], v[138:139] op_sel_hi:[1,0]
    v_pk_fma_f32 v[160:161], v[150:151], v[140:141], v[160:161] op_sel:[1,1,0] op_sel_hi:[0,1,1] neg_lo:[1,0,0]
    v_cvt_pk_bf16_f32 v200, v144, v145
    v_pk_fma_f32 v[142:143], v[144:145], v[138:139], v[142:143] op_sel:[1,1,0] op_sel_hi:[0,1,1] neg_lo:[1,0,0]
    v_cvt_pk_bf16_f32 v201, v160, -v161
    v_pk_mul_f32 v[144:145], v[142:143], v[138:139] op_sel_hi:[1,0]
    v_cvt_pk_bf16_f32 v202, v142, v143
    v_pk_fma_f32 v[144:145], v[142:143], v[138:139], v[144:145] op_sel:[1,1,0] op_sel_hi:[0,1,1] neg_lo:[1,0,0]
    v_pk_mul_f32 v[142:143], v[144:145], v[138:139] op_sel_hi:[1,0]
    v_cvt_pk_bf16_f32 v204, v144, v145
    v_pk_fma_f32 v[142:143], v[144:145], v[138:139], v[142:143] op_sel:[1,1,0] op_sel_hi:[0,1,1] neg_lo:[1,0,0]
    v_pk_mul_f32 v[162:163], v[154:155], v[140:141] op_sel_hi:[1,0]
    v_pk_mul_f32 v[144:145], v[142:143], v[138:139] op_sel_hi:[1,0]
    v_pk_fma_f32 v[162:163], v[154:155], v[140:141], v[162:163] op_sel:[1,1,0] op_sel_hi:[0,1,1] neg_lo:[1,0,0]
    v_cvt_pk_bf16_f32 v206, v142, v143
    v_pk_fma_f32 v[144:145], v[142:143], v[138:139], v[144:145] op_sel:[1,1,0] op_sel_hi:[0,1,1] neg_lo:[1,0,0]
    v_cvt_pk_bf16_f32 v207, v162, -v163
    v_pk_mul_f32 v[164:165], v[138:139], v[140:141] op_sel_hi:[1,0]
    v_pk_mul_f32 v[142:143], v[144:145], v[138:139] op_sel_hi:[1,0]
    v_pk_fma_f32 v[164:165], v[138:139], v[140:141], v[164:165] op_sel:[1,1,0] op_sel_hi:[0,1,1] neg_lo:[1,0,0]
    v_cvt_pk_bf16_f32 v208, v144, v145
    v_pk_fma_f32 v[142:143], v[144:145], v[138:139], v[142:143] op_sel:[1,1,0] op_sel_hi:[0,1,1] neg_lo:[1,0,0]
    v_cvt_pk_bf16_f32 v209, v164, -v165
    v_mfma_f32_32x32x16_bf16 v[56:71], v[84:87], v[116:119], v[56:71]
    ds_write_addtid_b32 v194 offset:2176
    ds_write_addtid_b32 v195 offset:10880
    ds_write_addtid_b32 v196 offset:2448
    ds_write_addtid_b32 v198 offset:2720
    ds_write_addtid_b32 v199 offset:11424
    v_mfma_f32_32x32x16_bf16 v[56:71], v[88:91], v[120:123], v[56:71]
    ds_write_addtid_b32 v200 offset:2992
    ds_write_addtid_b32 v201 offset:11696
    ds_write_addtid_b32 v202 offset:3264
    ds_write_addtid_b32 v204 offset:3536
    ds_write_addtid_b32 v206 offset:3808
    v_mfma_f32_32x32x16_bf16 v[56:71], v[92:95], v[124:127], v[56:71]
    ds_write_addtid_b32 v207 offset:12512
    ds_write_addtid_b32 v208 offset:4080
    ds_write_addtid_b32 v209 offset:12784
    s_add_u32 s17, s17, 3840
    buffer_load_dwordx2 v[30:31], v6, s[24:27], s17 offen offset:0
    v_pk_mul_f32 v[166:167], v[140:141], v[140:141] op_sel_hi:[1,0]
    v_pk_mul_f32 v[144:145], v[142:143], v[138:139] op_sel_hi:[1,0]
    v_pk_fma_f32 v[166:167], v[140:141], v[140:141], v[166:167] op_sel:[1,1,0] op_sel_hi:[0,1,1] neg_lo:[1,0,0]
    v_cvt_pk_bf16_f32 v194, v142, v143
    v_pk_fma_f32 v[144:145], v[142:143], v[138:139], v[144:145] op_sel:[1,1,0] op_sel_hi:[0,1,1] neg_lo:[1,0,0]
    v_cvt_pk_bf16_f32 v195, v166, -v167
    v_pk_mul_f32 v[168:169], v[160:161], v[140:141] op_sel_hi:[1,0]
    v_pk_mul_f32 v[142:143], v[144:145], v[138:139] op_sel_hi:[1,0]
    v_pk_fma_f32 v[168:169], v[160:161], v[140:141], v[168:169] op_sel:[1,1,0] op_sel_hi:[0,1,1] neg_lo:[1,0,0]
    v_cvt_pk_bf16_f32 v196, v144, v145
    v_pk_fma_f32 v[142:143], v[144:145], v[138:139], v[142:143] op_sel:[1,1,0] op_sel_hi:[0,1,1] neg_lo:[1,0,0]
    v_cvt_pk_bf16_f32 v197, v168, -v169
    v_pk_mul_f32 v[170:171], v[164:165], v[140:141] op_sel_hi:[1,0]
    v_pk_mul_f32 v[144:145], v[142:143], v[138:139] op_sel_hi:[1,0]
    v_pk_fma_f32 v[170:171], v[164:165], v[140:141], v[170:171] op_sel:[1,1,0] op_sel_hi:[0,1,1] neg_lo:[1,0,0]
    v_cvt_pk_bf16_f32 v198, v142, v143
    v_pk_fma_f32 v[144:145], v[142:143], v[138:139], v[144:145] op_sel:[1,1,0] op_sel_hi:[0,1,1] neg_lo:[1,0,0]
    v_cvt_pk_bf16_f32 v199, v170, -v171
    v_pk_mul_f32 v[142:143], v[144:145], v[138:139] op_sel_hi:[1,0]
    v_cvt_pk_bf16_f32 v200, v144, v145
    v_pk_fma_f32 v[142:143], v[144:145], v[138:139], v[142:143] op_sel:[1,1,0] op_sel_hi:[0,1,1] neg_lo:[1,0,0]
    v_pk_mul_f32 v[172:173], v[166:167], v[140:141] op_sel_hi:[1,0]
    v_pk_mul_f32 v[144:145], v[142:143], v[138:139] op_sel_hi:[1,0]
    v_pk_fma_f32 v[172:173], v[166:167], v[140:141], v[172:173] op_sel:[1,1,0] op_sel_hi:[0,1,1] neg_lo:[1,0,0]
    v_cvt_pk_bf16_f32 v202, v142, v143
    v_pk_fma_f32 v[144:145], v[142:143], v[138:139], v[144:145] op_sel:[1,1,0] op_sel_hi:[0,1,1] neg_lo:[1,0,0]
    v_cvt_pk_bf16_f32 v203, v172, -v173
    v_pk_mul_f32 v[174:175], v[168:169], v[140:141] op_sel_hi:[1,0]
    v_pk_mul_f32 v[142:143], v[144:145], v[138:139] op_sel_hi:[1,0]
    v_pk_fma_f32 v[174:175], v[168:169], v[140:141], v[174:175] op_sel:[1,1,0] op_sel_hi:[0,1,1] neg_lo:[1,0,0]
    v_cvt_pk_bf16_f32 v204, v144, v145
    v_pk_fma_f32 v[142:143], v[144:145], v[138:139], v[142:143] op_sel:[1,1,0] op_sel_hi:[0,1,1] neg_lo:[1,0,0]
    v_cvt_pk_bf16_f32 v205, v174, -v175
    v_pk_mul_f32 v[176:177], v[170:171], v[140:141] op_sel_hi:[1,0]
    v_pk_mul_f32 v[144:145], v[142:143], v[138:139] op_sel_hi:[1,0]
    v_pk_fma_f32 v[176:177], v[170:171], v[140:141], v[176:177] op_sel:[1,1,0] op_sel_hi:[0,1,1] neg_lo:[1,0,0]
    v_cvt_pk_bf16_f32 v206, v142, v143
    v_pk_fma_f32 v[144:145], v[142:143], v[138:139], v[144:145] op_sel:[1,1,0] op_sel_hi:[0,1,1] neg_lo:[1,0,0]
    v_cvt_pk_bf16_f32 v207, v176, -v177
    v_pk_mul_f32 v[142:143], v[144:145], v[138:139] op_sel_hi:[1,0]
    v_cvt_pk_bf16_f32 v208, v144, v145
    v_pk_fma_f32 v[142:143], v[144:145], v[138:139], v[142:143] op_sel:[1,1,0] op_sel_hi:[0,1,1] neg_lo:[1,0,0]
    v_mfma_f32_32x32x16_bf16 v[56:71], v[96:99], v[128:131], v[56:71]
    ds_write_addtid_b32 v194 offset:4352
    ds_write_addtid_b32 v195 offset:13056
    ds_write_addtid_b32 v196 offset:4624
    ds_write_addtid_b32 v197 offset:13328
    ds_write_addtid_b32 v198 offset:4896
    v_mfma_f32_32x32x16_bf16 v[56:71], v[100:103], v[132:135], v[56:71]
    ds_write_addtid_b32 v199 offset:13600
    ds_write_addtid_b32 v200 offset:5168
    ds_write_addtid_b32 v202 offset:5440
    ds_write_addtid_b32 v203 offset:14144
    ds_write_addtid_b32 v204 offset:5712
    ds_write_addtid_b32 v205 offset:14416
    ds_write_addtid_b32 v206 offset:5984
    ds_write_addtid_b32 v207 offset:14688
    ds_write_addtid_b32 v208 offset:6256
    buffer_load_dwordx2 v[32:33], v6, s[24:27], s17 offen offset:1280
    v_pk_mul_f32 v[178:179], v[172:173], v[140:141] op_sel_hi:[1,0]
    v_pk_mul_f32 v[144:145], v[142:143], v[138:139] op_sel_hi:[1,0]
    v_pk_fma_f32 v[178:179], v[172:173], v[140:141], v[178:179] op_sel:[1,1,0] op_sel_hi:[0,1,1] neg_lo:[1,0,0]
    v_cvt_pk_bf16_f32 v194, v142, v143
    v_pk_fma_f32 v[144:145], v[142:143], v[138:139], v[144:145] op_sel:[1,1,0] op_sel_hi:[0,1,1] neg_lo:[1,0,0]
    v_cvt_pk_bf16_f32 v195, v178, -v179
    v_pk_mul_f32 v[180:181], v[176:177], v[140:141] op_sel_hi:[1,0]
    v_pk_mul_f32 v[142:143], v[144:145], v[138:139] op_sel_hi:[1,0]
    v_pk_fma_f32 v[180:181], v[176:177], v[140:141], v[180:181] op_sel:[1,1,0] op_sel_hi:[0,1,1] neg_lo:[1,0,0]
    v_cvt_pk_bf16_f32 v196, v144, v145
    v_pk_fma_f32 v[142:143], v[144:145], v[138:139], v[142:143] op_sel:[1,1,0] op_sel_hi:[0,1,1] neg_lo:[1,0,0]
    v_cvt_pk_bf16_f32 v197, v180, -v181
    v_pk_mul_f32 v[182:183], v[178:179], v[140:141] op_sel_hi:[1,0]
    v_pk_mul_f32 v[144:145], v[142:143], v[138:139] op_sel_hi:[1,0]
    v_pk_fma_f32 v[182:183], v[178:179], v[140:141], v[182:183] op_sel:[1,1,0] op_sel_hi:[0,1,1] neg_lo:[1,0,0]
    v_cvt_pk_bf16_f32 v198, v142, v143
    v_pk_fma_f32 v[144:145], v[142:143], v[138:139], v[144:145] op_sel:[1,1,0] op_sel_hi:[0,1,1] neg_lo:[1,0,0]
    v_cvt_pk_bf16_f32 v199, v182, -v183
    v_pk_mul_f32 v[184:185], v[180:181], v[140:141] op_sel_hi:[1,0]
    v_pk_mul_f32 v[142:143], v[144:145], v[138:139] op_sel_hi:[1,0]
    v_pk_fma_f32 v[184:185], v[180:181], v[140:141], v[184:185] op_sel:[1,1,0] op_sel_hi:[0,1,1] neg_lo:[1,0,0]
    v_cvt_pk_bf16_f32 v200, v144, v145
    v_pk_fma_f32 v[142:143], v[144:145], v[138:139], v[142:143] op_sel:[1,1,0] op_sel_hi:[0,1,1] neg_lo:[1,0,0]
    v_cvt_pk_bf16_f32 v201, v184, -v185
    v_pk_mul_f32 v[186:187], v[182:183], v[140:141] op_sel_hi:[1,0]
    v_pk_mul_f32 v[144:145], v[142:143], v[138:139] op_sel_hi:[1,0]
    v_pk_fma_f32 v[186:187], v[182:183], v[140:141], v[186:187] op_sel:[1,1,0] op_sel_hi:[0,1,1] neg_lo:[1,0,0]
    v_cvt_pk_bf16_f32 v202, v142, v143
    v_pk_fma_f32 v[144:145], v[142:143], v[138:139], v[144:145] op_sel:[1,1,0] op_sel_hi:[0,1,1] neg_lo:[1,0,0]
    v_cvt_pk_bf16_f32 v203, v186, -v187
    v_pk_mul_f32 v[188:189], v[184:185], v[140:141] op_sel_hi:[1,0]
    v_pk_mul_f32 v[142:143], v[144:145], v[138:139] op_sel_hi:[1,0]
    v_pk_fma_f32 v[188:189], v[184:185], v[140:141], v[188:189] op_sel:[1,1,0] op_sel_hi:[0,1,1] neg_lo:[1,0,0]
    v_cvt_pk_bf16_f32 v204, v144, v145
    v_pk_fma_f32 v[142:143], v[144:145], v[138:139], v[142:143] op_sel:[1,1,0] op_sel_hi:[0,1,1] neg_lo:[1,0,0]
    v_cvt_pk_bf16_f32 v205, v188, -v189
    v_pk_mul_f32 v[190:191], v[186:187], v[140:141] op_sel_hi:[1,0]
    v_pk_mul_f32 v[144:145], v[142:143], v[138:139] op_sel_hi:[1,0]
    v_pk_fma_f32 v[190:191], v[186:187], v[140:141], v[190:191] op_sel:[1,1,0] op_sel_hi:[0,1,1] neg_lo:[1,0,0]
    v_cvt_pk_bf16_f32 v206, v142, v143
    v_pk_fma_f32 v[144:145], v[142:143], v[138:139], v[144:145] op_sel:[1,1,0] op_sel_hi:[0,1,1] neg_lo:[1,0,0]
    v_cvt_pk_bf16_f32 v207, v190, -v191
    v_pk_mul_f32 v[192:193], v[188:189], v[140:141] op_sel_hi:[1,0]
    v_pk_fma_f32 v[192:193], v[188:189], v[140:141], v[192:193] op_sel:[1,1,0] op_sel_hi:[0,1,1] neg_lo:[1,0,0]
    v_cvt_pk_bf16_f32 v208, v144, v145
    v_cvt_pk_bf16_f32 v209, v192, -v193
    ds_write_addtid_b32 v194 offset:6528
    ds_write_addtid_b32 v195 offset:15232
    ds_write_addtid_b32 v196 offset:6800
    ds_write_addtid_b32 v197 offset:15504
    ds_write_addtid_b32 v198 offset:7072
    ds_write_addtid_b32 v199 offset:15776
    ds_write_addtid_b32 v200 offset:7344
    ds_write_addtid_b32 v201 offset:16048
    ds_write_addtid_b32 v202 offset:7616
    ds_write_addtid_b32 v203 offset:16320
    ds_write_addtid_b32 v204 offset:7888
    ds_write_addtid_b32 v205 offset:16592
    ds_write_addtid_b32 v206 offset:8160
    ds_write_addtid_b32 v207 offset:16864
    ds_write_addtid_b32 v208 offset:8432
    ds_write_addtid_b32 v209 offset:17136
    buffer_load_dwordx2 v[34:35], v6, s[24:27], s17 offen offset:2560
    ds_read_b128 v[72:75], v11 offset:8704
    ds_read_b128 v[104:107], v12 offset:0
    ds_read_b128 v[76:79], v11 offset:8736
    ds_read_b128 v[108:111], v12 offset:32
    ds_read_b128 v[80:83], v11 offset:8768
    ds_read_b128 v[112:115], v12 offset:64
    ds_read_b128 v[84:87], v11 offset:8800
    ds_read_b128 v[116:119], v12 offset:96
    ds_read_b128 v[88:91], v11 offset:8832
    ds_read_b128 v[120:123], v12 offset:128
    ds_read_b128 v[92:95], v11 offset:8864
    ds_read_b128 v[124:127], v12 offset:160
    ds_read_b128 v[96:99], v11 offset:8896
    ds_read_b128 v[128:131], v12 offset:192
    ds_read_b128 v[100:103], v11 offset:8928
    ds_read_b128 v[132:135], v12 offset:224
    s_waitcnt vmcnt(7)
    v_mul_f32 v218, s14, v218
    v_exp_f32 v218, v218
    v_mul_f32 v219, v219, v222
    v_mul_f32 v146, s12, v219
    v_fma_f32 v147, v219, s12, -v146
    v_cvt_pk_bf16_f32 v218, 0, v218
    v_fma_f32 v147, v219, s13, v147
    v_mul_f32 v218, v218, v222
    v_fract_f32 v148, v146
    v_mul_f32 v218, s14, v218
    v_mul_f32 v149, s15, v148
    v_mul_f32 v150, s16, v148
    v_add_f32 v148, v148, v147
    v_fract_f32 v149, v149
    v_fract_f32 v150, v150
    v_fma_f32 v149, v147, s15, v149
    v_fma_f32 v150, v147, s16, v150
    v_mul_f32 v152, s15, v218
    v_mul_f32 v154, s16, v218
    v_cos_f32 v138, v149
    v_sin_f32 v139, v149
    v_exp_f32 v152, -v152
    v_cos_f32 v136, v148
    v_sin_f32 v137, v148
    v_exp_f32 v156, -v218
    v_cos_f32 v140, v150
    v_sin_f32 v141, v150
    v_exp_f32 v154, -v154
    v_mul_f32 v142, v220, v223
    v_mul_f32 v143, v221, v223
    v_mul_f32 v138, v138, v152
    v_mul_f32 v139, v139, v152
    v_mul_f32 v136, v136, v156
    v_mul_f32 v137, v137, v156
    v_mul_f32 v140, v140, v154
    v_mul_f32 v141, v141, v154
    v_pk_mul_f32 v[144:145], v[142:143], v[138:139] op_sel_hi:[1,0]
    v_cvt_pk_bf16_f32 v194, v142, v143
    v_pk_fma_f32 v[144:145], v[142:143], v[138:139], v[144:145] op_sel:[1,1,0] op_sel_hi:[0,1,1] neg_lo:[1,0,0]
    v_pk_mul_f32 v[142:143], v[144:145], v[138:139] op_sel_hi:[1,0]
    v_cvt_pk_bf16_f32 v196, v144, v145
    v_pk_fma_f32 v[142:143], v[144:145], v[138:139], v[142:143] op_sel:[1,1,0] op_sel_hi:[0,1,1] neg_lo:[1,0,0]
    v_cvt_pk_bf16_f32 v197, v136, -v137
    v_pk_mul_f32 v[146:147], v[136:137], v[136:137] op_sel_hi:[1,0]
    v_pk_mul_f32 v[144:145], v[142:143], v[138:139] op_sel_hi:[1,0]
    v_pk_fma_f32 v[146:147], v[136:137], v[136:137], v[146:147] op_sel:[1,1,0] op_sel_hi:[0,1,1] neg_lo:[1,0,0]
    v_cvt_pk_bf16_f32 v198, v142, v143
    v_pk_fma_f32 v[144:145], v[142:143], v[138:139], v[144:145] op_sel:[1,1,0] op_sel_hi:[0,1,1] neg_lo:[1,0,0]
    v_cvt_pk_bf16_f32 v199, v146, -v147
    v_pk_mul_f32 v[148:149], v[146:147], v[136:137] op_sel_hi:[1,0]
    v_pk_mul_f32 v[142:143], v[144:145], v[138:139] op_sel_hi:[1,0]
    v_pk_fma_f32 v[148:149], v[146:147], v[136:137], v[148:149] op_sel:[1,1,0] op_sel_hi:[0,1,1] neg_lo:[1,0,0]
    v_cvt_pk_bf16_f32 v200, v144, v145
    v_pk_fma_f32 v[142:143], v[144:145], v[138:139], v[142:143] op_sel:[1,1,0] op_sel_hi:[0,1,1] neg_lo:[1,0,0]
    v_cvt_pk_bf16_f32 v201, v148, -v149
    v_pk_mul_f32 v[150:151], v[148:149], v[136:137] op_sel_hi:[1,0]
    v_pk_mul_f32 v[144:145], v[142:143], v[138:139] op_sel_hi:[1,0]
    v_pk_fma_f32 v[150:151], v[148:149], v[136:137], v[150:151] op_sel:[1,1,0] op_sel_hi:[0,1,1] neg_lo:[1,0,0]
    v_cvt_pk_bf16_f32 v202, v142, v143
    v_pk_fma_f32 v[144:145], v[142:143], v[138:139], v[144:145] op_sel:[1,1,0] op_sel_hi:[0,1,1] neg_lo:[1,0,0]
    v_cvt_pk_bf16_f32 v203, v150, -v151
    v_pk_mul_f32 v[152:153], v[150:151], v[136:137] op_sel_hi:[1,0]
    v_pk_mul_f32 v[142:143], v[144:145], v[138:139] op_sel_hi:[1,0]
    v_pk_fma_f32 v[152:153], v[150:151], v[136:137], v[152:153] op_sel:[1,1,0] op_sel_hi:[0,1,1] neg_lo:[1,0,0]
    v_cvt_pk_bf16_f32 v204, v144, v145
    v_pk_fma_f32 v[142:143], v[144:145], v[138:139], v[142:143] op_sel:[1,1,0] op_sel_hi:[0,1,1] neg_lo:[1,0,0]
    v_cvt_pk_bf16_f32 v205, v152, -v153
    v_pk_mul_f32 v[154:155], v[152:153], v[136:137] op_sel_hi:[1,0]
    v_pk_mul_f32 v[144:145], v[142:143], v[138:139] op_sel_hi:[1,0]
    v_pk_fma_f32 v[154:155], v[152:153], v[136:137], v[154:155] op_sel:[1,1,0] op_sel_hi:[0,1,1] neg_lo:[1,0,0]
    v_cvt_pk_bf16_f32 v206, v142, v143
    v_pk_fma_f32 v[144:145], v[142:143], v[138:139], v[144:145] op_sel:[1,1,0] op_sel_hi:[0,1,1] neg_lo:[1,0,0]
    v_cvt_pk_bf16_f32 v207, v154, -v155
    v_pk_mul_f32 v[156:157], v[154:155], v[136:137] op_sel_hi:[1,0]
    v_pk_mul_f32 v[142:143], v[144:145], v[138:139] op_sel_hi:[1,0]
    v_pk_fma_f32 v[156:157], v[154:155], v[136:137], v[156:157] op_sel:[1,1,0] op_sel_hi:[0,1,1] neg_lo:[1,0,0]
    v_cvt_pk_bf16_f32 v208, v144, v145
    v_pk_fma_f32 v[142:143], v[144:145], v[138:139], v[142:143] op_sel:[1,1,0] op_sel_hi:[0,1,1] neg_lo:[1,0,0]
    v_cvt_pk_bf16_f32 v209, v156, -v157
    s_waitcnt lgkmcnt(0)
    v_mfma_f32_32x32x16_bf16 v[56:71], v[72:75], v[104:107], v[56:71]
    ds_write_addtid_b32 v194 offset:0
    ds_write_addtid_b32 v196 offset:272
    ds_write_addtid_b32 v197 offset:8976
    ds_write_addtid_b32 v198 offset:544
    ds_write_addtid_b32 v199 offset:9248
    v_mfma_f32_32x32x16_bf16 v[56:71], v[76:79], v[108:111], v[56:71]
    ds_write_addtid_b32 v200 offset:816
    ds_write_addtid_b32 v201 offset:9520
    ds_write_addtid_b32 v202 offset:1088
    ds_write_addtid_b32 v203 offset:9792
    ds_write_addtid_b32 v204 offset:1360
    v_mfma_f32_32x32x16_bf16 v[56:71], v[80:83], v[112:115], v[56:71]
    ds_write_addtid_b32 v205 offset:10064
    ds_write_addtid_b32 v206 offset:1632
    ds_write_addtid_b32 v207 offset:10336
    ds_write_addtid_b32 v208 offset:1904
    ds_write_addtid_b32 v209 offset:10608
    s_add_u32 s17, s17, 3840
    buffer_load_dwordx2 v[36:37], v6, s[24:27], s17 offen offset:0
    v_pk_mul_f32 v[144:145], v[142:143], v[138:139] op_sel_hi:[1,0]
    v_cvt_pk_bf16_f32 v194, v142, v143
    v_pk_fma_f32 v[144:145], v[142:143], v[138:139], v[144:145] op_sel:[1,1,0] op_sel_hi:[0,1,1] neg_lo:[1,0,0]
    v_cvt_pk_bf16_f32 v195, v140, -v141
    v_pk_mul_f32 v[142:143], v[144:145], v[138:139] op_sel_hi:[1,0]
    v_cvt_pk_bf16_f32 v196, v144, v145
    v_pk_fma_f32 v[142:143], v[144:145], v[138:139], v[142:143] op_sel:[1,1,0] op_sel_hi:[0,1,1] neg_lo:[1,0,0]
    v_pk_mul_f32 v[158:159], v[146:147], v[140:141] op_sel_hi:[1,0]
    v_pk_mul_f32 v[144:145], v[142:143], v[138:139] op_sel_hi:[1,0]
    v_pk_fma_f32 v[158:159], v[146:147], v[140:141], v[158:159] op_sel:[1,1,0] op_sel_hi:[0,1,1] neg_lo:[1,0,0]
    v_cvt_pk_bf16_f32 v198, v142, v143
    v_pk_fma_f32 v[144:145], v[142:143], v[138:139], v[144:145] op_sel:[1,1,0] op_sel_hi:[0,1,1] neg_lo:[1,0,0]
    v_cvt_pk_bf16_f32 v199, v158, -v159
    v_pk_mul_f32 v[160:161], v[150:151], v[140:141] op_sel_hi:[1,0]
    v_pk_mul_f32 v[142:143], v[144:145], v[138:139] op_sel_hi:[1,0]
    v_pk_fma_f32 v[160:161], v[150:151], v[140:141], v[160:161] op_sel:[1,1,0] op_sel_hi:[0,1,1] neg_lo:[1,0,0]
    v_cvt_pk_bf16_f32 v200, v144, v145
    v_pk_fma_f32 v[142:143], v[144:145], v[138:139], v[142:143] op_sel:[1,1,0] op_sel_hi:[0,1,1] neg_lo:[1,0,0]
    v_cvt_pk_bf16_f32 v201, v160, -v161
    v_pk_mul_f32 v[144:145], v[142:143], v[138:139] op_sel_hi:[1,0]
    v_cvt_pk_bf16_f32 v202, v142, v143
    v_pk_fma_f32 v[144:145], v[142:143], v[138:139], v[144:145] op_sel:[1,1,0] op_sel_hi:[0,1,1] neg_lo:[1,0,0]
    v_pk_mul_f32 v[142:143], v[144:145], v[138:139] op_sel_hi:[1,0]
    v_cvt_pk_bf16_f32 v204, v144, v145
    v_pk_fma_f32 v[142:143], v[144:145], v[138:139], v[142:143] op_sel:[1,1,0] op_sel_hi:[0,1,1] neg_lo:[1,0,0]
    v_pk_mul_f32 v[162:163], v[154:155], v[140:141] op_sel_hi:[1,0]
    v_pk_mul_f32 v[144:145], v[142:143], v[138:139] op_sel_hi:[1,0]
    v_pk_fma_f32 v[162:163], v[154:155], v[140:141], v[162:163] op_sel:[1,1,0] op_sel_hi:[0,1,1] neg_lo:[1,0,0]
    v_cvt_pk_bf16_f32 v206, v142, v143
    v_pk_fma_f32 v[144:145], v[142:143], v[138:139], v[144:145] op_sel:[1,1,0] op_sel_hi:[0,1,1] neg_lo:[1,0,0]
    v_cvt_pk_bf16_f32 v207, v162, -v163
    v_pk_mul_f32 v[164:165], v[138:139], v[140:141] op_sel_hi:[1,0]
    v_pk_mul_f32 v[142:143], v[144:145], v[138:139] op_sel_hi:[1,0]
    v_pk_fma_f32 v[164:165], v[138:139], v[140:141], v[164:165] op_sel:[1,1,0] op_sel_hi:[0,1,1] neg_lo:[1,0,0]
    v_cvt_pk_bf16_f32 v208, v144, v145
    v_pk_fma_f32 v[142:143], v[144:145], v[138:139], v[142:143] op_sel:[1,1,0] op_sel_hi:[0,1,1] neg_lo:[1,0,0]
    v_cvt_pk_bf16_f32 v209, v164, -v165
    v_mfma_f32_32x32x16_bf16 v[56:71], v[84:87], v[116:119], v[56:71]
    ds_write_addtid_b32 v194 offset:2176
    ds_write_addtid_b32 v195 offset:10880
    ds_write_addtid_b32 v196 offset:2448
    ds_write_addtid_b32 v198 offset:2720
    ds_write_addtid_b32 v199 offset:11424
    v_mfma_f32_32x32x16_bf16 v[56:71], v[88:91], v[120:123], v[56:71]
    ds_write_addtid_b32 v200 offset:2992
    ds_write_addtid_b32 v201 offset:11696
    ds_write_addtid_b32 v202 offset:3264
    ds_write_addtid_b32 v204 offset:3536
    ds_write_addtid_b32 v206 offset:3808
    v_mfma_f32_32x32x16_bf16 v[56:71], v[92:95], v[124:127], v[56:71]
    ds_write_addtid_b32 v207 offset:12512
    ds_write_addtid_b32 v208 offset:4080
    ds_write_addtid_b32 v209 offset:12784
    buffer_load_dwordx2 v[38:39], v6, s[24:27], s17 offen offset:1280
    v_pk_mul_f32 v[166:167], v[140:141], v[140:141] op_sel_hi:[1,0]
    v_pk_mul_f32 v[144:145], v[142:143], v[138:139] op_sel_hi:[1,0]
    v_pk_fma_f32 v[166:167], v[140:141], v[140:141], v[166:167] op_sel:[1,1,0] op_sel_hi:[0,1,1] neg_lo:[1,0,0]
    v_cvt_pk_bf16_f32 v194, v142, v143
    v_pk_fma_f32 v[144:145], v[142:143], v[138:139], v[144:145] op_sel:[1,1,0] op_sel_hi:[0,1,1] neg_lo:[1,0,0]
    v_cvt_pk_bf16_f32 v195, v166, -v167
    v_pk_mul_f32 v[168:169], v[160:161], v[140:141] op_sel_hi:[1,0]
    v_pk_mul_f32 v[142:143], v[144:145], v[138:139] op_sel_hi:[1,0]
    v_pk_fma_f32 v[168:169], v[160:161], v[140:141], v[168:169] op_sel:[1,1,0] op_sel_hi:[0,1,1] neg_lo:[1,0,0]
    v_cvt_pk_bf16_f32 v196, v144, v145
    v_pk_fma_f32 v[142:143], v[144:145], v[138:139], v[142:143] op_sel:[1,1,0] op_sel_hi:[0,1,1] neg_lo:[1,0,0]
    v_cvt_pk_bf16_f32 v197, v168, -v169
    v_pk_mul_f32 v[170:171], v[164:165], v[140:141] op_sel_hi:[1,0]
    v_pk_mul_f32 v[144:145], v[142:143], v[138:139] op_sel_hi:[1,0]
    v_pk_fma_f32 v[170:171], v[164:165], v[140:141], v[170:171] op_sel:[1,1,0] op_sel_hi:[0,1,1] neg_lo:[1,0,0]
    v_cvt_pk_bf16_f32 v198, v142, v143
    v_pk_fma_f32 v[144:145], v[142:143], v[138:139], v[144:145] op_sel:[1,1,0] op_sel_hi:[0,1,1] neg_lo:[1,0,0]
    v_cvt_pk_bf16_f32 v199, v170, -v171
    v_pk_mul_f32 v[142:143], v[144:145], v[138:139] op_sel_hi:[1,0]
    v_cvt_pk_bf16_f32 v200, v144, v145
    v_pk_fma_f32 v[142:143], v[144:145], v[138:139], v[142:143] op_sel:[1,1,0] op_sel_hi:[0,1,1] neg_lo:[1,0,0]
    v_pk_mul_f32 v[172:173], v[166:167], v[140:141] op_sel_hi:[1,0]
    v_pk_mul_f32 v[144:145], v[142:143], v[138:139] op_sel_hi:[1,0]
    v_pk_fma_f32 v[172:173], v[166:167], v[140:141], v[172:173] op_sel:[1,1,0] op_sel_hi:[0,1,1] neg_lo:[1,0,0]
    v_cvt_pk_bf16_f32 v202, v142, v143
    v_pk_fma_f32 v[144:145], v[142:143], v[138:139], v[144:145] op_sel:[1,1,0] op_sel_hi:[0,1,1] neg_lo:[1,0,0]
    v_cvt_pk_bf16_f32 v203, v172, -v173
    v_pk_mul_f32 v[174:175], v[168:169], v[140:141] op_sel_hi:[1,0]
    v_pk_mul_f32 v[142:143], v[144:145], v[138:139] op_sel_hi:[1,0]
    v_pk_fma_f32 v[174:175], v[168:169], v[140:141], v[174:175] op_sel:[1,1,0] op_sel_hi:[0,1,1] neg_lo:[1,0,0]
    v_cvt_pk_bf16_f32 v204, v144, v145
    v_pk_fma_f32 v[142:143], v[144:145], v[138:139], v[142:143] op_sel:[1,1,0] op_sel_hi:[0,1,1] neg_lo:[1,0,0]
    v_cvt_pk_bf16_f32 v205, v174, -v175
    v_pk_mul_f32 v[176:177], v[170:171], v[140:141] op_sel_hi:[1,0]
    v_pk_mul_f32 v[144:145], v[142:143], v[138:139] op_sel_hi:[1,0]
    v_pk_fma_f32 v[176:177], v[170:171], v[140:141], v[176:177] op_sel:[1,1,0] op_sel_hi:[0,1,1] neg_lo:[1,0,0]
    v_cvt_pk_bf16_f32 v206, v142, v143
    v_pk_fma_f32 v[144:145], v[142:143], v[138:139], v[144:145] op_sel:[1,1,0] op_sel_hi:[0,1,1] neg_lo:[1,0,0]
    v_cvt_pk_bf16_f32 v207, v176, -v177
    v_pk_mul_f32 v[142:143], v[144:145], v[138:139] op_sel_hi:[1,0]
    v_cvt_pk_bf16_f32 v208, v144, v145
    v_pk_fma_f32 v[142:143], v[144:145], v[138:139], v[142:143] op_sel:[1,1,0] op_sel_hi:[0,1,1] neg_lo:[1,0,0]
    v_mfma_f32_32x32x16_bf16 v[56:71], v[96:99], v[128:131], v[56:71]
    ds_write_addtid_b32 v194 offset:4352
    ds_write_addtid_b32 v195 offset:13056
    ds_write_addtid_b32 v196 offset:4624
    ds_write_addtid_b32 v197 offset:13328
    ds_write_addtid_b32 v198 offset:4896
    v_mfma_f32_32x32x16_bf16 v[56:71], v[100:103], v[132:135], v[56:71]
    ds_write_addtid_b32 v199 offset:13600
    ds_write_addtid_b32 v200 offset:5168
    ds_write_addtid_b32 v202 offset:5440
    ds_write_addtid_b32 v203 offset:14144
    ds_write_addtid_b32 v204 offset:5712
    ds_write_addtid_b32 v205 offset:14416
    ds_write_addtid_b32 v206 offset:5984
    ds_write_addtid_b32 v207 offset:14688
    ds_write_addtid_b32 v208 offset:6256
    v_pk_mul_f32 v[178:179], v[172:173], v[140:141] op_sel_hi:[1,0]
    v_pk_mul_f32 v[144:145], v[142:143], v[138:139] op_sel_hi:[1,0]
    v_pk_fma_f32 v[178:179], v[172:173], v[140:141], v[178:179] op_sel:[1,1,0] op_sel_hi:[0,1,1] neg_lo:[1,0,0]
    v_cvt_pk_bf16_f32 v194, v142, v143
    v_pk_fma_f32 v[144:145], v[142:143], v[138:139], v[144:145] op_sel:[1,1,0] op_sel_hi:[0,1,1] neg_lo:[1,0,0]
    v_cvt_pk_bf16_f32 v195, v178, -v179
    v_pk_mul_f32 v[180:181], v[176:177], v[140:141] op_sel_hi:[1,0]
    v_pk_mul_f32 v[142:143], v[144:145], v[138:139] op_sel_hi:[1,0]
    v_pk_fma_f32 v[180:181], v[176:177], v[140:141], v[180:181] op_sel:[1,1,0] op_sel_hi:[0,1,1] neg_lo:[1,0,0]
    v_cvt_pk_bf16_f32 v196, v144, v145
    v_pk_fma_f32 v[142:143], v[144:145], v[138:139], v[142:143] op_sel:[1,1,0] op_sel_hi:[0,1,1] neg_lo:[1,0,0]
    v_cvt_pk_bf16_f32 v197, v180, -v181
    v_pk_mul_f32 v[182:183], v[178:179], v[140:141] op_sel_hi:[1,0]
    v_pk_mul_f32 v[144:145], v[142:143], v[138:139] op_sel_hi:[1,0]
    v_pk_fma_f32 v[182:183], v[178:179], v[140:141], v[182:183] op_sel:[1,1,0] op_sel_hi:[0,1,1] neg_lo:[1,0,0]
    v_cvt_pk_bf16_f32 v198, v142, v143
    v_pk_fma_f32 v[144:145], v[142:143], v[138:139], v[144:145] op_sel:[1,1,0] op_sel_hi:[0,1,1] neg_lo:[1,0,0]
    v_cvt_pk_bf16_f32 v199, v182, -v183
    v_pk_mul_f32 v[184:185], v[180:181], v[140:141] op_sel_hi:[1,0]
    v_pk_mul_f32 v[142:143], v[144:145], v[138:139] op_sel_hi:[1,0]
    v_pk_fma_f32 v[184:185], v[180:181], v[140:141], v[184:185] op_sel:[1,1,0] op_sel_hi:[0,1,1] neg_lo:[1,0,0]
    v_cvt_pk_bf16_f32 v200, v144, v145
    v_pk_fma_f32 v[142:143], v[144:145], v[138:139], v[142:143] op_sel:[1,1,0] op_sel_hi:[0,1,1] neg_lo:[1,0,0]
    v_cvt_pk_bf16_f32 v201, v184, -v185
    v_pk_mul_f32 v[186:187], v[182:183], v[140:141] op_sel_hi:[1,0]
    v_pk_mul_f32 v[144:145], v[142:143], v[138:139] op_sel_hi:[1,0]
    v_pk_fma_f32 v[186:187], v[182:183], v[140:141], v[186:187] op_sel:[1,1,0] op_sel_hi:[0,1,1] neg_lo:[1,0,0]
    v_cvt_pk_bf16_f32 v202, v142, v143
    v_pk_fma_f32 v[144:145], v[142:143], v[138:139], v[144:145] op_sel:[1,1,0] op_sel_hi:[0,1,1] neg_lo:[1,0,0]
    v_cvt_pk_bf16_f32 v203, v186, -v187
    v_pk_mul_f32 v[188:189], v[184:185], v[140:141] op_sel_hi:[1,0]
    v_pk_mul_f32 v[142:143], v[144:145], v[138:139] op_sel_hi:[1,0]
    v_pk_fma_f32 v[188:189], v[184:185], v[140:141], v[188:189] op_sel:[1,1,0] op_sel_hi:[0,1,1] neg_lo:[1,0,0]
    v_cvt_pk_bf16_f32 v204, v144, v145
    v_pk_fma_f32 v[142:143], v[144:145], v[138:139], v[142:143] op_sel:[1,1,0] op_sel_hi:[0,1,1] neg_lo:[1,0,0]
    v_cvt_pk_bf16_f32 v205, v188, -v189
    v_pk_mul_f32 v[190:191], v[186:187], v[140:141] op_sel_hi:[1,0]
    v_pk_mul_f32 v[144:145], v[142:143], v[138:139] op_sel_hi:[1,0]
    v_pk_fma_f32 v[190:191], v[186:187], v[140:141], v[190:191] op_sel:[1,1,0] op_sel_hi:[0,1,1] neg_lo:[1,0,0]
    v_cvt_pk_bf16_f32 v206, v142, v143
    v_pk_fma_f32 v[144:145], v[142:143], v[138:139], v[144:145] op_sel:[1,1,0] op_sel_hi:[0,1,1] neg_lo:[1,0,0]
    v_cvt_pk_bf16_f32 v207, v190, -v191
    v_pk_mul_f32 v[192:193], v[188:189], v[140:141] op_sel_hi:[1,0]
    v_pk_fma_f32 v[192:193], v[188:189], v[140:141], v[192:193] op_sel:[1,1,0] op_sel_hi:[0,1,1] neg_lo:[1,0,0]
    v_cvt_pk_bf16_f32 v208, v144, v145
    v_cvt_pk_bf16_f32 v209, v192, -v193
    ds_write_addtid_b32 v194 offset:6528
    ds_write_addtid_b32 v195 offset:15232
    ds_write_addtid_b32 v196 offset:6800
    ds_write_addtid_b32 v197 offset:15504
    ds_write_addtid_b32 v198 offset:7072
    ds_write_addtid_b32 v199 offset:15776
    ds_write_addtid_b32 v200 offset:7344
    ds_write_addtid_b32 v201 offset:16048
    ds_write_addtid_b32 v202 offset:7616
    ds_write_addtid_b32 v203 offset:16320
    ds_write_addtid_b32 v204 offset:7888
    ds_write_addtid_b32 v205 offset:16592
    ds_write_addtid_b32 v206 offset:8160
    ds_write_addtid_b32 v207 offset:16864
    ds_write_addtid_b32 v208 offset:8432
    ds_write_addtid_b32 v209 offset:17136
    ds_read_b128 v[72:75], v11 offset:8704
    ds_read_b128 v[104:107], v12 offset:0
    ds_read_b128 v[76:79], v11 offset:8736
    ds_read_b128 v[108:111], v12 offset:32
    ds_read_b128 v[80:83], v11 offset:8768
    ds_read_b128 v[112:115], v12 offset:64
    ds_read_b128 v[84:87], v11 offset:8800
    ds_read_b128 v[116:119], v12 offset:96
    ds_read_b128 v[88:91], v11 offset:8832
    ds_read_b128 v[120:123], v12 offset:128
    ds_read_b128 v[92:95], v11 offset:8864
    ds_read_b128 v[124:127], v12 offset:160
    ds_read_b128 v[96:99], v11 offset:8896
    ds_read_b128 v[128:131], v12 offset:192
    ds_read_b128 v[100:103], v11 offset:8928
    ds_read_b128 v[132:135], v12 offset:224
    s_mov_b32 s12, 0x05040100
    s_mov_b32 s13, 0x07060302
    s_waitcnt lgkmcnt(14)
    v_mfma_f32_32x32x16_bf16 v[56:71], v[72:75], v[104:107], v[56:71]
    s_waitcnt lgkmcnt(12)
    v_mfma_f32_32x32x16_bf16 v[56:71], v[76:79], v[108:111], v[56:71]
    s_waitcnt lgkmcnt(10)
    v_mfma_f32_32x32x16_bf16 v[56:71], v[80:83], v[112:115], v[56:71]
    s_waitcnt lgkmcnt(8)
    v_mfma_f32_32x32x16_bf16 v[56:71], v[84:87], v[116:119], v[56:71]
    s_waitcnt lgkmcnt(6)
    v_mfma_f32_32x32x16_bf16 v[56:71], v[88:91], v[120:123], v[56:71]
    s_waitcnt lgkmcnt(4)
    v_mfma_f32_32x32x16_bf16 v[56:71], v[92:95], v[124:127], v[56:71]
    s_waitcnt lgkmcnt(2)
    v_mfma_f32_32x32x16_bf16 v[56:71], v[96:99], v[128:131], v[56:71]
    s_waitcnt lgkmcnt(0)
    v_mfma_f32_32x32x16_bf16 v[56:71], v[100:103], v[132:135], v[56:71]
    v_add_u32 v5, 17696, v20
    v_mov_b32 v72, 0
    v_mov_b32 v73, 0
    v_lshl_add_u32 v2, v1, 3, s32
    v_bfe_u32 v3, v1, 4, 1
    v_mul_u32_u24 v3, 4224, v3
    v_and_b32 v4, 15, v1
    v_lshl_add_u32 v3, v4, 3, v3
    v_add_u32 v3, s32, v3
    ds_write_b64 v2, v[72:73]
    ds_write_b64 v2, v[72:73] offset:4640
    ds_write_b64 v3, v[72:73] offset:9248
    s_nop 7
    v_add_f32 v56, v56, v23
    v_cndmask_b32 v2, v68, v69, s[68:69]
    v_cndmask_b32 v3, v70, v71, s[68:69]
    v_cvt_pk_bf16_f32 v104, v59, v58
    v_cvt_pk_bf16_f32 v105, v57, v56
    v_cvt_pk_bf16_f32 v106, v63, v62
    v_cvt_pk_bf16_f32 v107, v61, v60
    v_cvt_pk_bf16_f32 v108, v58, v57
    v_cvt_pk_bf16_f32 v109, v56, 0
    v_cvt_pk_bf16_f32 v110, v62, v61
    v_cvt_pk_bf16_f32 v111, v60, v60
    v_cvt_pk_bf16_f32 v112, v66, v66
    v_cvt_pk_bf16_f32 v113, v65, v65
    v_cvt_pk_bf16_f32 v114, v65, v64
    v_cvt_pk_bf16_f32 v115, v64, v64
    v_cvt_pk_bf16_f32 v116, v66, v65
    v_cvt_pk_bf16_f32 v117, v65, v65
    v_cvt_pk_bf16_f32 v118, v64, v64
    v_cvt_pk_bf16_f32 v119, v64, v64
    v_cvt_pk_bf16_f32 v120, v69, v69
    v_cvt_pk_bf16_f32 v121, v69, v2
    v_cvt_pk_bf16_f32 v122, v68, v68
    v_cvt_pk_bf16_f32 v123, v68, v68
    v_cvt_pk_bf16_f32 v124, v69, v69
    v_cvt_pk_bf16_f32 v125, v2, v68
    v_cvt_pk_bf16_f32 v126, v68, v68
    v_cvt_pk_bf16_f32 v127, v68, v68
    v_cvt_pk_bf16_f32 v128, v71, v71
    v_cvt_pk_bf16_f32 v129, v71, v3
    v_cvt_pk_bf16_f32 v130, v70, v70
    v_cvt_pk_bf16_f32 v131, v70, v70
    v_cvt_pk_bf16_f32 v132, v71, v71
    v_cvt_pk_bf16_f32 v133, v3, v70
    v_cvt_pk_bf16_f32 v134, v70, v70
    v_cvt_pk_bf16_f32 v135, v70, v70
    ds_write_b64 v13, v[104:105] offset:4640
    ds_write_b64 v13, v[106:107] offset:5152
    ds_write_b64 v13, v[108:109]
    ds_write_b64 v13, v[110:111] offset:512
    ds_write_b16 v16, v104
    ds_write_b128 v14, v[112:115] offset:5664
    ds_write_b128 v14, v[116:119] offset:1024
    ds_write_b128 v15, v[120:123] offset:6688
    ds_write_b128 v15, v[124:127] offset:2048
    ds_write_b128 v15, v[128:131] offset:7200
    ds_write_b128 v15, v[132:135] offset:2560
    buffer_load_dwordx4 v[40:43], v21, s[64:67], 0 offen offset:0 sc1
    buffer_load_dwordx4 v[44:47], v21, s[64:67], 0 offen offset:1024 sc1
    buffer_load_dwordx4 v[48:51], v21, s[64:67], 0 offen offset:2048 sc1
    buffer_load_dwordx4 v[52:55], v21, s[64:67], 0 offen offset:3072 sc1
    s_waitcnt lgkmcnt(0)
    s_barrier
    s_waitcnt vmcnt(4)
    v_perm_b32 v194, v28, v24, s12
    v_perm_b32 v195, v36, v32, s12
    v_perm_b32 v196, v30, v26, s12
    v_perm_b32 v197, v38, v34, s12
    v_perm_b32 v198, v28, v24, s13
    v_perm_b32 v199, v36, v32, s13
    v_perm_b32 v200, v30, v26, s13
    v_perm_b32 v201, v38, v34, s13
    ds_write_b128 v5, v[194:197] offset:0
    v_perm_b32 v202, v29, v25, s12
    v_perm_b32 v203, v37, v33, s12
    v_perm_b32 v204, v31, v27, s12
    v_perm_b32 v205, v39, v35, s12
    ds_write_b128 v5, v[198:201] offset:21792
    v_perm_b32 v206, v29, v25, s13
    v_perm_b32 v207, v37, v33, s13
    v_perm_b32 v208, v31, v27, s13
    v_perm_b32 v209, v39, v35, s13
    ds_write_b128 v5, v[202:205] offset:43584
    v_lshlrev_b32 v146, 16, v24
    v_and_b32 v147, 0xffff0000, v24
    v_lshlrev_b32 v148, 16, v25
    v_and_b32 v149, 0xffff0000, v25
    ds_write_b128 v5, v[206:209] offset:65376
    v_lshlrev_b32 v150, 16, v26
    v_and_b32 v151, 0xffff0000, v26
    v_lshlrev_b32 v152, 16, v27
    v_and_b32 v153, 0xffff0000, v27
    v_lshlrev_b32 v154, 16, v28
    v_and_b32 v155, 0xffff0000, v28
    v_lshlrev_b32 v156, 16, v29
    v_and_b32 v157, 0xffff0000, v29
    v_lshlrev_b32 v158, 16, v30
    v_and_b32 v159, 0xffff0000, v30
    v_lshlrev_b32 v160, 16, v31
    v_and_b32 v161, 0xffff0000, v31
    v_lshlrev_b32 v162, 16, v32
    v_and_b32 v163, 0xffff0000, v32
    v_lshlrev_b32 v164, 16, v33
    v_and_b32 v165, 0xffff0000, v33
    v_lshlrev_b32 v166, 16, v34
    v_and_b32 v167, 0xffff0000, v34
    v_lshlrev_b32 v168, 16, v35
    v_and_b32 v169, 0xffff0000, v35
    v_lshlrev_b32 v170, 16, v36
    v_and_b32 v171, 0xffff0000, v36
    v_lshlrev_b32 v172, 16, v37
    v_and_b32 v173, 0xffff0000, v37
    v_lshlrev_b32 v174, 16, v38
    v_and_b32 v175, 0xffff0000, v38
    v_lshlrev_b32 v176, 16, v39
    v_and_b32 v177, 0xffff0000, v39
    s_movk_i32 s58, 0x7fff
SL_1:
    s_waitcnt vmcnt(0)
    v_xor_b32 v41, s59, v41
    v_xor_b32 v43, s59, v43
    v_xor_b32 v45, s59, v45
    v_xor_b32 v47, s59, v47
    v_xor_b32 v49, s59, v49
    v_xor_b32 v51, s59, v51
    v_xor_b32 v53, s59, v53
    v_xor_b32 v55, s59, v55
    v_or3_b32 v2, v41, v43, v45
    v_or3_b32 v3, v47, v49, v51
    v_or3_b32 v2, v2, v53, v55
    v_or_b32 v2, v2, v3
    v_cmp_ne_u32 vcc, 0, v2
    s_cbranch_vccz SD_2
    buffer_load_dwordx4 v[40:43], v21, s[64:67], 0 offen offset:0 sc1
    buffer_load_dwordx4 v[44:47], v21, s[64:67], 0 offen offset:1024 sc1
    buffer_load_dwordx4 v[48:51], v21, s[64:67], 0 offen offset:2048 sc1
    buffer_load_dwordx4 v[52:55], v21, s[64:67], 0 offen offset:3072 sc1
    s_sub_u32 s58, s58, 1
    s_cbranch_scc0 SL_1
    s_waitcnt vmcnt(0)
SD_2:
    v_and_b32 v41, 0xffff0000, v40
    v_lshlrev_b32 v40, 16, v40
    v_and_b32 v43, 0xffff0000, v42
    v_lshlrev_b32 v42, 16, v42
    v_and_b32 v45, 0xffff0000, v44
    v_lshlrev_b32 v44, 16, v44
    v_and_b32 v47, 0xffff0000, v46
    v_lshlrev_b32 v46, 16, v46
    v_and_b32 v49, 0xffff0000, v48
    v_lshlrev_b32 v48, 16, v48
    v_and_b32 v51, 0xffff0000, v50
    v_lshlrev_b32 v50, 16, v50
    v_and_b32 v53, 0xffff0000, v52
    v_lshlrev_b32 v52, 16, v52
    v_and_b32 v55, 0xffff0000, v54
    v_lshlrev_b32 v54, 16, v54
    v_pk_add_f32 v[146:147], v[146:147], v[40:41] op_sel_hi:[1,0] neg_lo:[0,1] neg_hi:[0,1]
    v_pk_add_f32 v[148:149], v[148:149], v[40:41] op_sel_hi:[1,0] neg_lo:[0,1] neg_hi:[0,1]
    v_rcp_f32 v41, v41
    v_pk_add_f32 v[150:151], v[150:151], v[42:43] op_sel_hi:[1,0] neg_lo:[0,1] neg_hi:[0,1]
    v_pk_add_f32 v[152:153], v[152:153], v[42:43] op_sel_hi:[1,0] neg_lo:[0,1] neg_hi:[0,1]
    v_rcp_f32 v43, v43
    v_pk_add_f32 v[154:155], v[154:155], v[44:45] op_sel_hi:[1,0] neg_lo:[0,1] neg_hi:[0,1]
    v_pk_add_f32 v[156:157], v[156:157], v[44:45] op_sel_hi:[1,0] neg_lo:[0,1] neg_hi:[0,1]
    v_rcp_f32 v45, v45
    v_pk_add_f32 v[158:159], v[158:159], v[46:47] op_sel_hi:[1,0] neg_lo:[0,1] neg_hi:[0,1]
    v_pk_add_f32 v[160:161], v[160:161], v[46:47] op_sel_hi:[1,0] neg_lo:[0,1] neg_hi:[0,1]
    v_rcp_f32 v47, v47
    v_pk_add_f32 v[162:163], v[162:163], v[48:49] op_sel_hi:[1,0] neg_lo:[0,1] neg_hi:[0,1]
    v_pk_add_f32 v[164:165], v[164:165], v[48:49] op_sel_hi:[1,0] neg_lo:[0,1] neg_hi:[0,1]
    v_rcp_f32 v49, v49
    v_pk_add_f32 v[166:167], v[166:167], v[50:51] op_sel_hi:[1,0] neg_lo:[0,1] neg_hi:[0,1]
    v_pk_add_f32 v[168:169], v[168:169], v[50:51] op_sel_hi:[1,0] neg_lo:[0,1] neg_hi:[0,1]
    v_rcp_f32 v51, v51
    v_pk_add_f32 v[170:171], v[170:171], v[52:53] op_sel_hi:[1,0] neg_lo:[0,1] neg_hi:[0,1]
    v_pk_add_f32 v[172:173], v[172:173], v[52:53] op_sel_hi:[1,0] neg_lo:[0,1] neg_hi:[0,1]
    v_rcp_f32 v53, v53
    v_pk_add_f32 v[174:175], v[174:175], v[54:55] op_sel_hi:[1,0] neg_lo:[0,1] neg_hi:[0,1]
    v_pk_add_f32 v[176:177], v[176:177], v[54:55] op_sel_hi:[1,0] neg_lo:[0,1] neg_hi:[0,1]
    v_rcp_f32 v55, v55
    v_cvt_pk_bf16_f32 v146, 0, v146
    v_cvt_pk_bf16_f32 v147, 0, v147
    v_cvt_pk_bf16_f32 v148, 0, v148
    v_cvt_pk_bf16_f32 v149, 0, v149
    v_cvt_pk_bf16_f32 v150, 0, v150
    v_cvt_pk_bf16_f32 v151, 0, v151
    v_cvt_pk_bf16_f32 v152, 0, v152
    v_cvt_pk_bf16_f32 v153, 0, v153
    v_cvt_pk_bf16_f32 v154, 0, v154
    v_cvt_pk_bf16_f32 v155, 0, v155
    v_cvt_pk_bf16_f32 v156, 0, v156
    v_cvt_pk_bf16_f32 v157, 0, v157
    v_cvt_pk_bf16_f32 v158, 0, v158
    v_cvt_pk_bf16_f32 v159, 0, v159
    v_cvt_pk_bf16_f32 v160, 0, v160
    v_cvt_pk_bf16_f32 v161, 0, v161
    v_cvt_pk_bf16_f32 v162, 0, v162
    v_cvt_pk_bf16_f32 v163, 0, v163
    v_cvt_pk_bf16_f32 v164, 0, v164
    v_cvt_pk_bf16_f32 v165, 0, v165
    v_cvt_pk_bf16_f32 v166, 0, v166
    v_cvt_pk_bf16_f32 v167, 0, v167
    v_cvt_pk_bf16_f32 v168, 0, v168
    v_cvt_pk_bf16_f32 v169, 0, v169
    v_cvt_pk_bf16_f32 v170, 0, v170
    v_cvt_pk_bf16_f32 v171, 0, v171
    v_cvt_pk_bf16_f32 v172, 0, v172
    v_cvt_pk_bf16_f32 v173, 0, v173
    v_cvt_pk_bf16_f32 v174, 0, v174
    v_cvt_pk_bf16_f32 v175, 0, v175
    v_cvt_pk_bf16_f32 v176, 0, v176
    v_cvt_pk_bf16_f32 v177, 0, v177
    v_pk_mul_f32 v[146:147], v[146:147], v[40:41] op_sel:[0,1] op_sel_hi:[1,1]
    v_pk_mul_f32 v[148:149], v[148:149], v[40:41] op_sel:[0,1] op_sel_hi:[1,1]
    v_pk_mul_f32 v[150:151], v[150:151], v[42:43] op_sel:[0,1] op_sel_hi:[1,1]
    v_pk_mul_f32 v[152:153], v[152:153], v[42:43] op_sel:[0,1] op_sel_hi:[1,1]
    v_pk_mul_f32 v[154:155], v[154:155], v[44:45] op_sel:[0,1] op_sel_hi:[1,1]
    v_pk_mul_f32 v[156:157], v[156:157], v[44:45] op_sel:[0,1] op_sel_hi:[1,1]
    v_pk_mul_f32 v[158:159], v[158:159], v[46:47] op_sel:[0,1] op_sel_hi:[1,1]
    v_pk_mul_f32 v[160:161], v[160:161], v[46:47] op_sel:[0,1] op_sel_hi:[1,1]
    v_pk_mul_f32 v[162:163], v[162:163], v[48:49] op_sel:[0,1] op_sel_hi:[1,1]
    v_pk_mul_f32 v[164:165], v[164:165], v[48:49] op_sel:[0,1] op_sel_hi:[1,1]
    v_pk_mul_f32 v[166:167], v[166:167], v[50:51] op_sel:[0,1] op_sel_hi:[1,1]
    v_pk_mul_f32 v[168:169], v[168:169], v[50:51] op_sel:[0,1] op_sel_hi:[1,1]
    v_pk_mul_f32 v[170:171], v[170:171], v[52:53] op_sel:[0,1] op_sel_hi:[1,1]
    v_pk_mul_f32 v[172:173], v[172:173], v[52:53] op_sel:[0,1] op_sel_hi:[1,1]
    v_pk_mul_f32 v[174:175], v[174:175], v[54:55] op_sel:[0,1] op_sel_hi:[1,1]
    v_pk_mul_f32 v[176:177], v[176:177], v[54:55] op_sel:[0,1] op_sel_hi:[1,1]
    v_cvt_pk_bf16_f32 v72, v146, v150
    v_cvt_pk_bf16_f32 v73, v154, v158
    v_cvt_pk_bf16_f32 v74, v162, v166
    v_cvt_pk_bf16_f32 v75, v170, v174
    v_cvt_pk_bf16_f32 v76, v154, v158
    v_cvt_pk_bf16_f32 v77, v162, v166
    v_cvt_pk_bf16_f32 v78, v147, v151
    v_cvt_pk_bf16_f32 v79, v155, v159
    v_cvt_pk_bf16_f32 v80, v163, v167
    v_cvt_pk_bf16_f32 v81, v171, v175
    v_cvt_pk_bf16_f32 v82, v155, v159
    v_cvt_pk_bf16_f32 v83, v163, v167
    v_cvt_pk_bf16_f32 v84, v148, v152
    v_cvt_pk_bf16_f32 v85, v156, v160
    v_cvt_pk_bf16_f32 v86, v164, v168
    v_cvt_pk_bf16_f32 v87, v172, v176
    v_cvt_pk_bf16_f32 v88, v156, v160
    v_cvt_pk_bf16_f32 v89, v164, v168
    v_cvt_pk_bf16_f32 v90, v149, v153
    v_cvt_pk_bf16_f32 v91, v157, v161
    v_cvt_pk_bf16_f32 v92, v165, v169
    v_cvt_pk_bf16_f32 v93, v173, v177
    v_cvt_pk_bf16_f32 v94, v157, v161
    v_cvt_pk_bf16_f32 v95, v165, v169
    v_add_u32 v2, 9312, v20
    v_add_u32 v24, 13536, v20
    v_add_u32 v25, 35328, v20
    v_add_u32 v26, 57120, v20
    v_add_u32 v27, 78912, v20
    ds_write_b128 v2, v[72:75] offset:0
    ds_write_b64 v24, v[76:77] offset:8
    ds_write2_b32 v24, v72, v75 offset0:1 offset1:4
    ds_write_b128 v2, v[78:81] offset:21792
    ds_write_b64 v25, v[82:83] offset:8
    ds_write2_b32 v25, v78, v81 offset0:1 offset1:4
    ds_write_b128 v2, v[84:87] offset:43584
    ds_write_b64 v26, v[88:89] offset:8
    ds_write2_b32 v26, v84, v87 offset0:1 offset1:4
    ds_write_b128 v2, v[90:93] offset:65376
    ds_write_b64 v27, v[94:95] offset:8
    ds_write2_b32 v27, v90, v93 offset0:1 offset1:4
    s_add_u32 s12, s4, 0xc00000
    s_addc_u32 s13, s5, 0
    s_mov_b32 s14, 0x3c0000
    s_mov_b32 s15, 0x20000
    s_mul_i32 s57, s61, 245760
    s_mul_i32 s31, s28, 3072
    s_add_u32 s57, s57, s31
    s_add_u32 s56, s57, 245760
    s_mul_i32 s39, s3, 12288
    s_add_u32 s39, s39, s57
    v_min_u32 v22, 19, v1
    v_add_u32 v22, s3, v22
    v_subrev_u32 v9, 20, v22
    v_min_u32 v22, v22, v9
    v_lshlrev_b32 v22, 10, v22
    s_lshl_b32 s31, s61, 6
    s_add_u32 s31, s31, 32768
    v_add_u32 v22, s31, v22
    v_lshlrev_b32 v9, 4, v1
    s_lshl_b32 s33, s30, 12
    s_bfe_u32 s16, s29, 0x20001
    s_mul_i32 s16, s16, 40
    s_lshr_b32 s17, s29, 3
    s_lshl_b32 s17, s17, 1
    s_add_u32 s16, s16, s17
    s_and_b32 s17, s29, 1
    s_add_u32 s16, s16, s17
    s_lshl_b32 s16, s16, 7
    s_add_u32 s16, s16, 655360
    v_mul_u32_u24 v20, 20480, v1
    v_mov_b32 v21, s59
    v_lshrrev_b32 v20, 3, v1
    v_mul_u32_u24 v20, 20352, v20
    v_lshl_add_u32 v20, v1, 4, v20
    v_not_b32 v240, s59
    v_not_b32 v241, s59
    v_not_b32 v242, s59
    v_not_b32 v243, s59
    s_cmp_lg_u32 s28, 0
    s_cbranch_scc1 C_NP
    buffer_store_dwordx4 v[240:243], v20, s[64:67], s16 offen sc1
C_NP:
    s_cmp_lg_u32 s28, 1
    s_cbranch_scc1 C_NQ
    s_cmp_ge_u32 s2, 128
    s_cbranch_scc1 C_NQ
    s_lshl_b32 s17, s2, 10
    s_add_u32 s17, s17, 131072
    buffer_store_dwordx4 v[240:243], v9, s[64:67], s17 offen sc1
C_NQ:
    v_mov_b32 v244, s59
    v_mov_b32 v245, s59
    v_mov_b32 v246, s59
    v_mov_b32 v247, s59
    s_waitcnt lgkmcnt(0)
    s_barrier
    ds_read_b128 v[88:91], v18 offset:448
    ds_read_b64 v[56:57], v17 offset:0
    ds_read_b64 v[58:59], v17 offset:8
    ds_read_b128 v[92:95], v18 offset:960
    ds_read_b64 v[60:61], v17 offset:512
    ds_read_b64 v[62:63], v17 offset:520
    ds_read_b128 v[96:99], v18 offset:1472
    ds_read_b64 v[64:65], v17 offset:1024
    ds_read_b64 v[66:67], v17 offset:1032
    ds_read_b128 v[100:103], v18 offset:1984
    ds_read_b64 v[68:69], v17 offset:1536
    ds_read_b64 v[70:71], v17 offset:1544
    ds_read_b128 v[104:107], v18 offset:2496
    ds_read_b64 v[72:73], v17 offset:2048
    ds_read_b64 v[74:75], v17 offset:2056
    ds_read_b128 v[108:111], v18 offset:3008
    ds_read_b64 v[76:77], v17 offset:2560
    ds_read_b64 v[78:79], v17 offset:2568
    ds_read_b128 v[112:115], v18 offset:3520
    ds_read_b64 v[80:81], v17 offset:3072
    ds_read_b64 v[82:83], v17 offset:3080
    ds_read_b128 v[116:119], v18 offset:4032
    ds_read_b64 v[84:85], v17 offset:3584
    ds_read_b64 v[86:87], v17 offset:3592
    s_mov_b32 s70, 0
    s_waitcnt lgkmcnt(0)
    v_mfma_f32_16x16x32_bf16 v[24:27], v[56:59], v[88:91], 0
    ds_read_b128 v[152:155], v18 offset:384
    v_mfma_f32_16x16x32_bf16 v[28:31], v[56:59], v[92:95], 0
    ds_read_b64 v[120:121], v17 offset:64
    v_mfma_f32_16x16x32_bf16 v[32:35], v[56:59], v[96:99], 0
    ds_read_b64 v[122:123], v17 offset:72
    v_mfma_f32_16x16x32_bf16 v[36:39], v[56:59], v[100:103], 0
    ds_read_b128 v[156:159], v18 offset:896
    v_mfma_f32_16x16x32_bf16 v[40:43], v[56:59], v[104:107], 0
    ds_read_b64 v[124:125], v17 offset:576
    v_mfma_f32_16x16x32_bf16 v[44:47], v[56:59], v[108:111], 0
    ds_read_b64 v[126:127], v17 offset:584
    v_mfma_f32_16x16x32_bf16 v[48:51], v[56:59], v[112:115], 0
    ds_read_b128 v[160:163], v18 offset:1408
    v_mfma_f32_16x16x32_bf16 v[52:55], v[56:59], v[116:119], 0
    ds_read_b64 v[128:129], v17 offset:1088
    v_mfma_f32_16x16x32_bf16 v[28:31], v[60:63], v[88:91], v[28:31]
    ds_read_b64 v[130:131], v17 offset:1096
    v_mfma_f32_16x16x32_bf16 v[32:35], v[60:63], v[92:95], v[32:35]
    ds_read_b128 v[164:167], v18 offset:1920
    v_mfma_f32_16x16x32_bf16 v[36:39], v[60:63], v[96:99], v[36:39]
    ds_read_b64 v[132:133], v17 offset:1600
    v_mfma_f32_16x16x32_bf16 v[40:43], v[60:63], v[100:103], v[40:43]
    ds_read_b64 v[134:135], v17 offset:1608
    v_mfma_f32_16x16x32_bf16 v[44:47], v[60:63], v[104:107], v[44:47]
    ds_read_b128 v[168:171], v18 offset:2432
    v_mfma_f32_16x16x32_bf16 v[48:51], v[60:63], v[108:111], v[48:51]
    ds_read_b64 v[136:137], v17 offset:2112
    v_mfma_f32_16x16x32_bf16 v[52:55], v[60:63], v[112:115], v[52:55]
    ds_read_b64 v[138:139], v17 offset:2120
    v_mfma_f32_16x16x32_bf16 v[32:35], v[64:67], v[88:91], v[32:35]
    ds_read_b128 v[172:175], v18 offset:2944
    v_mfma_f32_16x16x32_bf16 v[36:39], v[64:67], v[92:95], v[36:39]
    ds_read_b64 v[140:141], v17 offset:2624
    v_mfma_f32_16x16x32_bf16 v[40:43], v[64:67], v[96:99], v[40:43]
    ds_read_b64 v[142:143], v17 offset:2632
    v_mfma_f32_16x16x32_bf16 v[44:47], v[64:67], v[100:103], v[44:47]
    ds_read_b128 v[176:179], v18 offset:3456
    v_mfma_f32_16x16x32_bf16 v[48:51], v[64:67], v[104:107], v[48:51]
    ds_read_b64 v[144:145], v17 offset:3136
    v_mfma_f32_16x16x32_bf16 v[52:55], v[64:67], v[108:111], v[52:55]
    ds_read_b64 v[146:147], v17 offset:3144
    v_mfma_f32_16x16x32_bf16 v[36:39], v[68:71], v[88:91], v[36:39]
    ds_read_b128 v[180:183], v18 offset:3968
    v_mfma_f32_16x16x32_bf16 v[40:43], v[68:71], v[92:95], v[40:43]
    ds_read_b64 v[148:149], v17 offset:3648
    v_mfma_f32_16x16x32_bf16 v[44:47], v[68:71], v[96:99], v[44:47]
    ds_read_b64 v[150:151], v17 offset:3656
    v_mfma_f32_16x16x32_bf16 v[48:51], v[68:71], v[100:103], v[48:51]
    v_mfma_f32_16x16x32_bf16 v[52:55], v[68:71], v[104:107], v[52:55]
    v_mfma_f32_16x16x32_bf16 v[40:43], v[72:75], v[88:91], v[40:43]
    buffer_store_dwordx4 v[252:255], v9, s[8:11], s7 offen offset:0 sc1
    v_mfma_f32_16x16x32_bf16 v[44:47], v[72:75], v[92:95], v[44:47]
    v_mfma_f32_16x16x32_bf16 v[48:51], v[72:75], v[96:99], v[48:51]
    buffer_store_dwordx4 v[252:255], v9, s[8:11], s7 offen offset:1024 sc1
    v_mfma_f32_16x16x32_bf16 v[52:55], v[72:75], v[100:103], v[52:55]
    v_mfma_f32_16x16x32_bf16 v[44:47], v[76:79], v[88:91], v[44:47]
    buffer_store_dwordx4 v[252:255], v9, s[8:11], s7 offen offset:2048 sc1
    v_mfma_f32_16x16x32_bf16 v[48:51], v[76:79], v[92:95], v[48:51]
    v_mfma_f32_16x16x32_bf16 v[52:55], v[76:79], v[96:99], v[52:55]
    buffer_store_dwordx4 v[252:255], v9, s[8:11], s7 offen offset:3072 sc1
    v_mfma_f32_16x16x32_bf16 v[48:51], v[80:83], v[88:91], v[48:51]
    v_mfma_f32_16x16x32_bf16 v[52:55], v[80:83], v[92:95], v[52:55]
    v_mfma_f32_16x16x32_bf16 v[52:55], v[84:87], v[88:91], v[52:55]
    s_waitcnt lgkmcnt(0)
    v_mfma_f32_16x16x32_bf16 v[24:27], v[120:123], v[152:155], v[24:27]
    ds_read_b128 v[88:91], v18 offset:320
    v_mfma_f32_16x16x32_bf16 v[28:31], v[120:123], v[156:159], v[28:31]
    ds_read_b64 v[56:57], v17 offset:128
    v_mfma_f32_16x16x32_bf16 v[32:35], v[120:123], v[160:163], v[32:35]
    ds_read_b64 v[58:59], v17 offset:136
    v_mfma_f32_16x16x32_bf16 v[36:39], v[120:123], v[164:167], v[36:39]
    ds_read_b128 v[92:95], v18 offset:832
    v_mfma_f32_16x16x32_bf16 v[40:43], v[120:123], v[168:171], v[40:43]
    ds_read_b64 v[60:61], v17 offset:640
    v_mfma_f32_16x16x32_bf16 v[44:47], v[120:123], v[172:175], v[44:47]
    ds_read_b64 v[62:63], v17 offset:648
    v_mfma_f32_16x16x32_bf16 v[48:51], v[120:123], v[176:179], v[48:51]
    ds_read_b128 v[96:99], v18 offset:1344
    v_mfma_f32_16x16x32_bf16 v[52:55], v[120:123], v[180:183], v[52:55]
    ds_read_b64 v[64:65], v17 offset:1152
    v_mfma_f32_16x16x32_bf16 v[28:31], v[124:127], v[152:155], v[28:31]
    ds_read_b64 v[66:67], v17 offset:1160
    v_mfma_f32_16x16x32_bf16 v[32:35], v[124:127], v[156:159], v[32:35]
    ds_read_b128 v[100:103], v18 offset:1856
    v_mfma_f32_16x16x32_bf16 v[36:39], v[124:127], v[160:163], v[36:39]
    ds_read_b64 v[68:69], v17 offset:1664
    v_mfma_f32_16x16x32_bf16 v[40:43], v[124:127], v[164:167], v[40:43]
    ds_read_b64 v[70:71], v17 offset:1672
    v_mfma_f32_16x16x32_bf16 v[44:47], v[124:127], v[168:171], v[44:47]
    ds_read_b128 v[104:107], v18 offset:2368
    v_mfma_f32_16x16x32_bf16 v[48:51], v[124:127], v[172:175], v[48:51]
    ds_read_b64 v[72:73], v17 offset:2176
    v_mfma_f32_16x16x32_bf16 v[52:55], v[124:127], v[176:179], v[52:55]
    ds_read_b64 v[74:75], v17 offset:2184
    v_mfma_f32_16x16x32_bf16 v[32:35], v[128:131], v[152:155], v[32:35]
    ds_read_b128 v[108:111], v18 offset:2880
    v_mfma_f32_16x16x32_bf16 v[36:39], v[128:131], v[156:159], v[36:39]
    ds_read_b64 v[76:77], v17 offset:2688
    v_mfma_f32_16x16x32_bf16 v[40:43], v[128:131], v[160:163], v[40:43]
    ds_read_b64 v[78:79], v17 offset:2696
    v_mfma_f32_16x16x32_bf16 v[44:47], v[128:131], v[164:167], v[44:47]
    ds_read_b128 v[112:115], v18 offset:3392
    v_mfma_f32_16x16x32_bf16 v[48:51], v[128:131], v[168:171], v[48:51]
    ds_read_b64 v[80:81], v17 offset:3200
    v_mfma_f32_16x16x32_bf16 v[52:55], v[128:131], v[172:175], v[52:55]
    ds_read_b64 v[82:83], v17 offset:3208
    v_mfma_f32_16x16x32_bf16 v[36:39], v[132:135], v[152:155], v[36:39]
    ds_read_b128 v[116:119], v18 offset:3904
    v_mfma_f32_16x16x32_bf16 v[40:43], v[132:135], v[156:159], v[40:43]
    ds_read_b64 v[84:85], v17 offset:3712
    v_mfma_f32_16x16x32_bf16 v[44:47], v[132:135], v[160:163], v[44:47]
    ds_read_b64 v[86:87], v17 offset:3720
    v_mfma_f32_16x16x32_bf16 v[48:51], v[132:135], v[164:167], v[48:51]
    v_mfma_f32_16x16x32_bf16 v[52:55], v[132:135], v[168:171], v[52:55]
    v_mfma_f32_16x16x32_bf16 v[40:43], v[136:139], v[152:155], v[40:43]
    v_mfma_f32_16x16x32_bf16 v[44:47], v[136:139], v[156:159], v[44:47]
    v_mfma_f32_16x16x32_bf16 v[48:51], v[136:139], v[160:163], v[48:51]
    v_mfma_f32_16x16x32_bf16 v[52:55], v[136:139], v[164:167], v[52:55]
    v_mfma_f32_16x16x32_bf16 v[44:47], v[140:143], v[152:155], v[44:47]
    v_mfma_f32_16x16x32_bf16 v[48:51], v[140:143], v[156:159], v[48:51]
    v_mfma_f32_16x16x32_bf16 v[52:55], v[140:143], v[160:163], v[52:55]
    v_mfma_f32_16x16x32_bf16 v[48:51], v[144:147], v[152:155], v[48:51]
    v_mfma_f32_16x16x32_bf16 v[52:55], v[144:147], v[156:159], v[52:55]
    v_mfma_f32_16x16x32_bf16 v[52:55], v[148:151], v[152:155], v[52:55]
    s_waitcnt lgkmcnt(0)
    v_mfma_f32_16x16x32_bf16 v[24:27], v[56:59], v[88:91], v[24:27]
    ds_read_b128 v[152:155], v18 offset:256
    v_mfma_f32_16x16x32_bf16 v[28:31], v[56:59], v[92:95], v[28:31]
    ds_read_b64 v[120:121], v17 offset:192
    v_mfma_f32_16x16x32_bf16 v[32:35], v[56:59], v[96:99], v[32:35]
    ds_read_b64 v[122:123], v17 offset:200
    v_mfma_f32_16x16x32_bf16 v[36:39], v[56:59], v[100:103], v[36:39]
    ds_read_b128 v[156:159], v18 offset:768
    v_mfma_f32_16x16x32_bf16 v[40:43], v[56:59], v[104:107], v[40:43]
    ds_read_b64 v[124:125], v17 offset:704
    v_mfma_f32_16x16x32_bf16 v[44:47], v[56:59], v[108:111], v[44:47]
    ds_read_b64 v[126:127], v17 offset:712
    v_mfma_f32_16x16x32_bf16 v[48:51], v[56:59], v[112:115], v[48:51]
    ds_read_b128 v[160:163], v18 offset:1280
    v_mfma_f32_16x16x32_bf16 v[52:55], v[56:59], v[116:119], v[52:55]
    ds_read_b64 v[128:129], v17 offset:1216
    v_mfma_f32_16x16x32_bf16 v[28:31], v[60:63], v[88:91], v[28:31]
    ds_read_b64 v[130:131], v17 offset:1224
    v_mfma_f32_16x16x32_bf16 v[32:35], v[60:63], v[92:95], v[32:35]
    ds_read_b128 v[164:167], v18 offset:1792
    v_mfma_f32_16x16x32_bf16 v[36:39], v[60:63], v[96:99], v[36:39]
    ds_read_b64 v[132:133], v17 offset:1728
    v_mfma_f32_16x16x32_bf16 v[40:43], v[60:63], v[100:103], v[40:43]
    ds_read_b64 v[134:135], v17 offset:1736
    v_mfma_f32_16x16x32_bf16 v[44:47], v[60:63], v[104:107], v[44:47]
    ds_read_b128 v[168:171], v18 offset:2304
    v_mfma_f32_16x16x32_bf16 v[48:51], v[60:63], v[108:111], v[48:51]
    ds_read_b64 v[136:137], v17 offset:2240
    v_mfma_f32_16x16x32_bf16 v[52:55], v[60:63], v[112:115], v[52:55]
    ds_read_b64 v[138:139], v17 offset:2248
    v_mfma_f32_16x16x32_bf16 v[32:35], v[64:67], v[88:91], v[32:35]
    ds_read_b128 v[172:175], v18 offset:2816
    v_mfma_f32_16x16x32_bf16 v[36:39], v[64:67], v[92:95], v[36:39]
    ds_read_b64 v[140:141], v17 offset:2752
    v_mfma_f32_16x16x32_bf16 v[40:43], v[64:67], v[96:99], v[40:43]
    ds_read_b64 v[142:143], v17 offset:2760
    v_mfma_f32_16x16x32_bf16 v[44:47], v[64:67], v[100:103], v[44:47]
    ds_read_b128 v[176:179], v18 offset:3328
    v_mfma_f32_16x16x32_bf16 v[48:51], v[64:67], v[104:107], v[48:51]
    ds_read_b64 v[144:145], v17 offset:3264
    v_mfma_f32_16x16x32_bf16 v[52:55], v[64:67], v[108:111], v[52:55]
    ds_read_b64 v[146:147], v17 offset:3272
    v_mfma_f32_16x16x32_bf16 v[36:39], v[68:71], v[88:91], v[36:39]
    ds_read_b128 v[180:183], v18 offset:3840
    v_mfma_f32_16x16x32_bf16 v[40:43], v[68:71], v[92:95], v[40:43]
    ds_read_b64 v[148:149], v17 offset:3776
    v_mfma_f32_16x16x32_bf16 v[44:47], v[68:71], v[96:99], v[44:47]
    ds_read_b64 v[150:151], v17 offset:3784
    v_mfma_f32_16x16x32_bf16 v[48:51], v[68:71], v[100:103], v[48:51]
    v_mfma_f32_16x16x32_bf16 v[52:55], v[68:71], v[104:107], v[52:55]
    s_mov_b64 exec, 0xf
    buffer_load_dword v23, v22, s[64:67], 0 offen sc1
    s_mov_b64 exec, -1
    v_mfma_f32_16x16x32_bf16 v[40:43], v[72:75], v[88:91], v[40:43]
    v_mfma_f32_16x16x32_bf16 v[44:47], v[72:75], v[92:95], v[44:47]
    v_mfma_f32_16x16x32_bf16 v[48:51], v[72:75], v[96:99], v[48:51]
    v_mfma_f32_16x16x32_bf16 v[52:55], v[72:75], v[100:103], v[52:55]
    v_mfma_f32_16x16x32_bf16 v[44:47], v[76:79], v[88:91], v[44:47]
    v_mfma_f32_16x16x32_bf16 v[48:51], v[76:79], v[92:95], v[48:51]
    v_mfma_f32_16x16x32_bf16 v[52:55], v[76:79], v[96:99], v[52:55]
    v_mfma_f32_16x16x32_bf16 v[48:51], v[80:83], v[88:91], v[48:51]
    v_mfma_f32_16x16x32_bf16 v[52:55], v[80:83], v[92:95], v[52:55]
    v_mfma_f32_16x16x32_bf16 v[52:55], v[84:87], v[88:91], v[52:55]
    s_waitcnt lgkmcnt(0)
    v_mfma_f32_16x16x32_bf16 v[24:27], v[120:123], v[152:155], v[24:27]
    ds_read_b128 v[88:91], v18 offset:192
    v_mfma_f32_16x16x32_bf16 v[28:31], v[120:123], v[156:159], v[28:31]
    ds_read_b64 v[56:57], v17 offset:256
    v_mfma_f32_16x16x32_bf16 v[32:35], v[120:123], v[160:163], v[32:35]
    ds_read_b64 v[58:59], v17 offset:264
    v_mfma_f32_16x16x32_bf16 v[36:39], v[120:123], v[164:167], v[36:39]
    ds_read_b128 v[92:95], v18 offset:704
    v_mfma_f32_16x16x32_bf16 v[40:43], v[120:123], v[168:171], v[40:43]
    ds_read_b64 v[60:61], v17 offset:768
    v_mfma_f32_16x16x32_bf16 v[44:47], v[120:123], v[172:175], v[44:47]
    ds_read_b64 v[62:63], v17 offset:776
    v_mfma_f32_16x16x32_bf16 v[48:51], v[120:123], v[176:179], v[48:51]
    ds_read_b128 v[96:99], v18 offset:1216
    v_mfma_f32_16x16x32_bf16 v[52:55], v[120:123], v[180:183], v[52:55]
    ds_read_b64 v[64:65], v17 offset:1280
    v_mfma_f32_16x16x32_bf16 v[28:31], v[124:127], v[152:155], v[28:31]
    ds_read_b64 v[66:67], v17 offset:1288
    v_mfma_f32_16x16x32_bf16 v[32:35], v[124:127], v[156:159], v[32:35]
    ds_read_b128 v[100:103], v18 offset:1728
    v_mfma_f32_16x16x32_bf16 v[36:39], v[124:127], v[160:163], v[36:39]
    ds_read_b64 v[68:69], v17 offset:1792
    v_mfma_f32_16x16x32_bf16 v[40:43], v[124:127], v[164:167], v[40:43]
    ds_read_b64 v[70:71], v17 offset:1800
    v_mfma_f32_16x16x32_bf16 v[44:47], v[124:127], v[168:171], v[44:47]
    ds_read_b128 v[104:107], v18 offset:2240
    v_mfma_f32_16x16x32_bf16 v[48:51], v[124:127], v[172:175], v[48:51]
    ds_read_b64 v[72:73], v17 offset:2304
    v_mfma_f32_16x16x32_bf16 v[52:55], v[124:127], v[176:179], v[52:55]
    ds_read_b64 v[74:75], v17 offset:2312
    v_mfma_f32_16x16x32_bf16 v[32:35], v[128:131], v[152:155], v[32:35]
    ds_read_b128 v[108:111], v18 offset:2752
    v_mfma_f32_16x16x32_bf16 v[36:39], v[128:131], v[156:159], v[36:39]
    ds_read_b64 v[76:77], v17 offset:2816
    v_mfma_f32_16x16x32_bf16 v[40:43], v[128:131], v[160:163], v[40:43]
    ds_read_b64 v[78:79], v17 offset:2824
    v_mfma_f32_16x16x32_bf16 v[44:47], v[128:131], v[164:167], v[44:47]
    ds_read_b128 v[112:115], v18 offset:3264
    v_mfma_f32_16x16x32_bf16 v[48:51], v[128:131], v[168:171], v[48:51]
    ds_read_b64 v[80:81], v17 offset:3328
    v_mfma_f32_16x16x32_bf16 v[52:55], v[128:131], v[172:175], v[52:55]
    ds_read_b64 v[82:83], v17 offset:3336
    v_mfma_f32_16x16x32_bf16 v[36:39], v[132:135], v[152:155], v[36:39]
    ds_read_b128 v[116:119], v18 offset:3776
    v_mfma_f32_16x16x32_bf16 v[40:43], v[132:135], v[156:159], v[40:43]
    ds_read_b64 v[84:85], v17 offset:3840
    v_mfma_f32_16x16x32_bf16 v[44:47], v[132:135], v[160:163], v[44:47]
    ds_read_b64 v[86:87], v17 offset:3848
    v_mfma_f32_16x16x32_bf16 v[48:51], v[132:135], v[164:167], v[48:51]
    v_mfma_f32_16x16x32_bf16 v[52:55], v[132:135], v[168:171], v[52:55]
    v_mfma_f32_16x16x32_bf16 v[40:43], v[136:139], v[152:155], v[40:43]
    v_mfma_f32_16x16x32_bf16 v[44:47], v[136:139], v[156:159], v[44:47]
    v_mfma_f32_16x16x32_bf16 v[48:51], v[136:139], v[160:163], v[48:51]
    v_mfma_f32_16x16x32_bf16 v[52:55], v[136:139], v[164:167], v[52:55]
    v_mfma_f32_16x16x32_bf16 v[44:47], v[140:143], v[152:155], v[44:47]
    s_mov_b64 exec, 0xffff0
    buffer_load_dword v23, v22, s[64:67], 0 offen sc1
    s_mov_b64 exec, -1
    v_mfma_f32_16x16x32_bf16 v[48:51], v[140:143], v[156:159], v[48:51]
    v_mfma_f32_16x16x32_bf16 v[52:55], v[140:143], v[160:163], v[52:55]
    v_mfma_f32_16x16x32_bf16 v[48:51], v[144:147], v[152:155], v[48:51]
    s_waitcnt vmcnt(1)
    v_cmp_ne_u32 vcc, s59, v23
    v_mfma_f32_16x16x32_bf16 v[52:55], v[144:147], v[156:159], v[52:55]
    s_and_b32 s71, vcc_lo, 0xf
    s_or_b32 s70, s70, s71
    v_mfma_f32_16x16x32_bf16 v[52:55], v[148:151], v[152:155], v[52:55]
    s_waitcnt lgkmcnt(0)
    v_mfma_f32_16x16x32_bf16 v[24:27], v[56:59], v[88:91], v[24:27]
    ds_read_b128 v[152:155], v18 offset:128
    v_mfma_f32_16x16x32_bf16 v[28:31], v[56:59], v[92:95], v[28:31]
    ds_read_b64 v[120:121], v17 offset:320
    buffer_load_dwordx4 a[0:3], v9, s[12:15], s39 offen offset:0 sc1
    v_mfma_f32_16x16x32_bf16 v[32:35], v[56:59], v[96:99], v[32:35]
    ds_read_b64 v[122:123], v17 offset:328
    v_mfma_f32_16x16x32_bf16 v[36:39], v[56:59], v[100:103], v[36:39]
    ds_read_b128 v[156:159], v18 offset:640
    v_mfma_f32_16x16x32_bf16 v[40:43], v[56:59], v[104:107], v[40:43]
    ds_read_b64 v[124:125], v17 offset:832
    buffer_load_dwordx4 a[4:7], v9, s[12:15], s39 offen offset:1024 sc1
    v_mfma_f32_16x16x32_bf16 v[44:47], v[56:59], v[108:111], v[44:47]
    ds_read_b64 v[126:127], v17 offset:840
    v_mfma_f32_16x16x32_bf16 v[48:51], v[56:59], v[112:115], v[48:51]
    ds_read_b128 v[160:163], v18 offset:1152
    v_mfma_f32_16x16x32_bf16 v[52:55], v[56:59], v[116:119], v[52:55]
    ds_read_b64 v[128:129], v17 offset:1344
    buffer_load_dwordx4 a[8:11], v9, s[12:15], s39 offen offset:2048 sc1
    s_add_u32 s39, s39, 12288
    s_cmp_eq_u32 s39, s56
    s_cselect_b32 s39, s57, s39
    v_mfma_f32_16x16x32_bf16 v[28:31], v[60:63], v[88:91], v[28:31]
    ds_read_b64 v[130:131], v17 offset:1352
    v_mfma_f32_16x16x32_bf16 v[32:35], v[60:63], v[92:95], v[32:35]
    ds_read_b128 v[164:167], v18 offset:1664
    v_mfma_f32_16x16x32_bf16 v[36:39], v[60:63], v[96:99], v[36:39]
    ds_read_b64 v[132:133], v17 offset:1856
    buffer_load_dwordx4 a[12:15], v9, s[12:15], s39 offen offset:0 sc1
    v_mfma_f32_16x16x32_bf16 v[40:43], v[60:63], v[100:103], v[40:43]
    ds_read_b64 v[134:135], v17 offset:1864
    v_mfma_f32_16x16x32_bf16 v[44:47], v[60:63], v[104:107], v[44:47]
    ds_read_b128 v[168:171], v18 offset:2176
    v_mfma_f32_16x16x32_bf16 v[48:51], v[60:63], v[108:111], v[48:51]
    ds_read_b64 v[136:137], v17 offset:2368
    buffer_load_dwordx4 a[16:19], v9, s[12:15], s39 offen offset:1024 sc1
    v_mfma_f32_16x16x32_bf16 v[52:55], v[60:63], v[112:115], v[52:55]
    ds_read_b64 v[138:139], v17 offset:2376
    v_mfma_f32_16x16x32_bf16 v[32:35], v[64:67], v[88:91], v[32:35]
    ds_read_b128 v[172:175], v18 offset:2688
    v_mfma_f32_16x16x32_bf16 v[36:39], v[64:67], v[92:95], v[36:39]
    ds_read_b64 v[140:141], v17 offset:2880
    buffer_load_dwordx4 a[20:23], v9, s[12:15], s39 offen offset:2048 sc1
    s_add_u32 s39, s39, 12288
    s_cmp_eq_u32 s39, s56
    s_cselect_b32 s39, s57, s39
    v_mfma_f32_16x16x32_bf16 v[40:43], v[64:67], v[96:99], v[40:43]
    ds_read_b64 v[142:143], v17 offset:2888
    v_mfma_f32_16x16x32_bf16 v[44:47], v[64:67], v[100:103], v[44:47]
    ds_read_b128 v[176:179], v18 offset:3200
    v_mfma_f32_16x16x32_bf16 v[48:51], v[64:67], v[104:107], v[48:51]
    ds_read_b64 v[144:145], v17 offset:3392
    buffer_load_dwordx4 a[24:27], v9, s[12:15], s39 offen offset:0 sc1
    v_mfma_f32_16x16x32_bf16 v[52:55], v[64:67], v[108:111], v[52:55]
    ds_read_b64 v[146:147], v17 offset:3400
    v_mfma_f32_16x16x32_bf16 v[36:39], v[68:71], v[88:91], v[36:39]
    ds_read_b128 v[180:183], v18 offset:3712
    v_mfma_f32_16x16x32_bf16 v[40:43], v[68:71], v[92:95], v[40:43]
    ds_read_b64 v[148:149], v17 offset:3904
    buffer_load_dwordx4 a[28:31], v9, s[12:15], s39 offen offset:1024 sc1
    v_mfma_f32_16x16x32_bf16 v[44:47], v[68:71], v[96:99], v[44:47]
    ds_read_b64 v[150:151], v17 offset:3912
    v_mfma_f32_16x16x32_bf16 v[48:51], v[68:71], v[100:103], v[48:51]
    v_mfma_f32_16x16x32_bf16 v[52:55], v[68:71], v[104:107], v[52:55]
    buffer_load_dwordx4 a[32:35], v9, s[12:15], s39 offen offset:2048 sc1
    s_add_u32 s39, s39, 12288
    s_cmp_eq_u32 s39, s56
    s_cselect_b32 s39, s57, s39
    v_mfma_f32_16x16x32_bf16 v[40:43], v[72:75], v[88:91], v[40:43]
    v_mfma_f32_16x16x32_bf16 v[44:47], v[72:75], v[92:95], v[44:47]
    v_mfma_f32_16x16x32_bf16 v[48:51], v[72:75], v[96:99], v[48:51]
    buffer_load_dwordx4 a[36:39], v9, s[12:15], s39 offen offset:0 sc1
    v_mfma_f32_16x16x32_bf16 v[52:55], v[72:75], v[100:103], v[52:55]
    v_mfma_f32_16x16x32_bf16 v[44:47], v[76:79], v[88:91], v[44:47]
    v_mfma_f32_16x16x32_bf16 v[48:51], v[76:79], v[92:95], v[48:51]
    buffer_load_dwordx4 a[40:43], v9, s[12:15], s39 offen offset:1024 sc1
    v_mfma_f32_16x16x32_bf16 v[52:55], v[76:79], v[96:99], v[52:55]
    v_mfma_f32_16x16x32_bf16 v[48:51], v[80:83], v[88:91], v[48:51]
    s_waitcnt vmcnt(11)
    v_cmp_ne_u32 vcc, s59, v23
    v_mfma_f32_16x16x32_bf16 v[52:55], v[80:83], v[92:95], v[52:55]
    s_and_b32 s71, vcc_lo, 0xffff0
    s_or_b32 s70, s70, s71
    buffer_load_dwordx4 a[44:47], v9, s[12:15], s39 offen offset:2048 sc1
    s_add_u32 s39, s39, 12288
    s_cmp_eq_u32 s39, s56
    s_cselect_b32 s39, s57, s39
    v_mfma_f32_16x16x32_bf16 v[52:55], v[84:87], v[88:91], v[52:55]
    s_waitcnt lgkmcnt(0)
    v_mfma_f32_16x16x32_bf16 v[24:27], v[120:123], v[152:155], v[24:27]
    ds_read_b128 v[88:91], v18 offset:64
    v_mfma_f32_16x16x32_bf16 v[28:31], v[120:123], v[156:159], v[28:31]
    ds_read_b64 v[56:57], v17 offset:384
    buffer_load_dwordx4 a[48:51], v9, s[12:15], s39 offen offset:0 sc1
    v_mfma_f32_16x16x32_bf16 v[32:35], v[120:123], v[160:163], v[32:35]
    ds_read_b64 v[58:59], v17 offset:392
    v_mfma_f32_16x16x32_bf16 v[36:39], v[120:123], v[164:167], v[36:39]
    ds_read_b128 v[92:95], v18 offset:576
    v_mfma_f32_16x16x32_bf16 v[40:43], v[120:123], v[168:171], v[40:43]
    ds_read_b64 v[60:61], v17 offset:896
    buffer_load_dwordx4 a[52:55], v9, s[12:15], s39 offen offset:1024 sc1
    v_mfma_f32_16x16x32_bf16 v[44:47], v[120:123], v[172:175], v[44:47]
    ds_read_b64 v[62:63], v17 offset:904
    v_mfma_f32_16x16x32_bf16 v[48:51], v[120:123], v[176:179], v[48:51]
    ds_read_b128 v[96:99], v18 offset:1088
    v_mfma_f32_16x16x32_bf16 v[52:55], v[120:123], v[180:183], v[52:55]
    ds_read_b64 v[64:65], v17 offset:1408
    buffer_load_dwordx4 a[56:59], v9, s[12:15], s39 offen offset:2048 sc1
    s_add_u32 s39, s39, 12288
    s_cmp_eq_u32 s39, s56
    s_cselect_b32 s39, s57, s39
    v_mfma_f32_16x16x32_bf16 v[28:31], v[124:127], v[152:155], v[28:31]
    ds_read_b64 v[66:67], v17 offset:1416
    v_mfma_f32_16x16x32_bf16 v[32:35], v[124:127], v[156:159], v[32:35]
    ds_read_b128 v[100:103], v18 offset:1600
    v_mfma_f32_16x16x32_bf16 v[36:39], v[124:127], v[160:163], v[36:39]
    ds_read_b64 v[68:69], v17 offset:1920
    buffer_load_dwordx4 a[60:63], v9, s[12:15], s39 offen offset:0 sc1
    v_mfma_f32_16x16x32_bf16 v[40:43], v[124:127], v[164:167], v[40:43]
    ds_read_b64 v[70:71], v17 offset:1928
    v_mfma_f32_16x16x32_bf16 v[44:47], v[124:127], v[168:171], v[44:47]
    ds_read_b128 v[104:107], v18 offset:2112
    v_mfma_f32_16x16x32_bf16 v[48:51], v[124:127], v[172:175], v[48:51]
    ds_read_b64 v[72:73], v17 offset:2432
    buffer_load_dwordx4 a[64:67], v9, s[12:15], s39 offen offset:1024 sc1
    v_mfma_f32_16x16x32_bf16 v[52:55], v[124:127], v[176:179], v[52:55]
    ds_read_b64 v[74:75], v17 offset:2440
    v_mfma_f32_16x16x32_bf16 v[32:35], v[128:131], v[152:155], v[32:35]
    ds_read_b128 v[108:111], v18 offset:2624
    v_mfma_f32_16x16x32_bf16 v[36:39], v[128:131], v[156:159], v[36:39]
    ds_read_b64 v[76:77], v17 offset:2944
    buffer_load_dwordx4 a[68:71], v9, s[12:15], s39 offen offset:2048 sc1
    s_add_u32 s39, s39, 12288
    s_cmp_eq_u32 s39, s56
    s_cselect_b32 s39, s57, s39
    v_mfma_f32_16x16x32_bf16 v[40:43], v[128:131], v[160:163], v[40:43]
    ds_read_b64 v[78:79], v17 offset:2952
    v_mfma_f32_16x16x32_bf16 v[44:47], v[128:131], v[164:167], v[44:47]
    ds_read_b128 v[112:115], v18 offset:3136
    v_mfma_f32_16x16x32_bf16 v[48:51], v[128:131], v[168:171], v[48:51]
    ds_read_b64 v[80:81], v17 offset:3456
    buffer_load_dwordx4 a[72:75], v9, s[12:15], s39 offen offset:0 sc1
    v_mfma_f32_16x16x32_bf16 v[52:55], v[128:131], v[172:175], v[52:55]
    ds_read_b64 v[82:83], v17 offset:3464
    v_mfma_f32_16x16x32_bf16 v[36:39], v[132:135], v[152:155], v[36:39]
    ds_read_b128 v[116:119], v18 offset:3648
    v_mfma_f32_16x16x32_bf16 v[40:43], v[132:135], v[156:159], v[40:43]
    ds_read_b64 v[84:85], v17 offset:3968
    buffer_load_dwordx4 a[76:79], v9, s[12:15], s39 offen offset:1024 sc1
    v_mfma_f32_16x16x32_bf16 v[44:47], v[132:135], v[160:163], v[44:47]
    ds_read_b64 v[86:87], v17 offset:3976
    v_mfma_f32_16x16x32_bf16 v[48:51], v[132:135], v[164:167], v[48:51]
    v_mfma_f32_16x16x32_bf16 v[52:55], v[132:135], v[168:171], v[52:55]
    buffer_load_dwordx4 a[80:83], v9, s[12:15], s39 offen offset:2048 sc1
    s_add_u32 s39, s39, 12288
    s_cmp_eq_u32 s39, s56
    s_cselect_b32 s39, s57, s39
    v_mfma_f32_16x16x32_bf16 v[40:43], v[136:139], v[152:155], v[40:43]
    v_mfma_f32_16x16x32_bf16 v[44:47], v[136:139], v[156:159], v[44:47]
    v_mfma_f32_16x16x32_bf16 v[48:51], v[136:139], v[160:163], v[48:51]
    buffer_load_dwordx4 a[84:87], v9, s[12:15], s39 offen offset:0 sc1
    v_mfma_f32_16x16x32_bf16 v[52:55], v[136:139], v[164:167], v[52:55]
    v_mfma_f32_16x16x32_bf16 v[44:47], v[140:143], v[152:155], v[44:47]
    v_mfma_f32_16x16x32_bf16 v[48:51], v[140:143], v[156:159], v[48:51]
    buffer_load_dwordx4 a[88:91], v9, s[12:15], s39 offen offset:1024 sc1
    v_mfma_f32_16x16x32_bf16 v[52:55], v[140:143], v[160:163], v[52:55]
    v_mfma_f32_16x16x32_bf16 v[48:51], v[144:147], v[152:155], v[48:51]
    v_mfma_f32_16x16x32_bf16 v[52:55], v[144:147], v[156:159], v[52:55]
    buffer_load_dwordx4 a[92:95], v9, s[12:15], s39 offen offset:2048 sc1
    s_add_u32 s39, s39, 12288
    s_cmp_eq_u32 s39, s56
    s_cselect_b32 s39, s57, s39
    v_mfma_f32_16x16x32_bf16 v[52:55], v[148:151], v[152:155], v[52:55]
    s_waitcnt lgkmcnt(0)
    v_mfma_f32_16x16x32_bf16 v[24:27], v[56:59], v[88:91], v[24:27]
    ds_read_b128 v[152:155], v18 offset:0
    v_mfma_f32_16x16x32_bf16 v[28:31], v[56:59], v[92:95], v[28:31]
    ds_read_b64 v[120:121], v17 offset:448
    buffer_load_dwordx4 a[96:99], v9, s[12:15], s39 offen offset:0 sc1
    v_mfma_f32_16x16x32_bf16 v[32:35], v[56:59], v[96:99], v[32:35]
    ds_read_b64 v[122:123], v17 offset:456
    v_mfma_f32_16x16x32_bf16 v[36:39], v[56:59], v[100:103], v[36:39]
    ds_read_b128 v[156:159], v18 offset:512
    v_mfma_f32_16x16x32_bf16 v[40:43], v[56:59], v[104:107], v[40:43]
    ds_read_b64 v[124:125], v17 offset:960
    buffer_load_dwordx4 a[100:103], v9, s[12:15], s39 offen offset:1024 sc1
    v_mfma_f32_16x16x32_bf16 v[44:47], v[56:59], v[108:111], v[44:47]
    ds_read_b64 v[126:127], v17 offset:968
    v_mfma_f32_16x16x32_bf16 v[48:51], v[56:59], v[112:115], v[48:51]
    ds_read_b128 v[160:163], v18 offset:1024
    v_mfma_f32_16x16x32_bf16 v[52:55], v[56:59], v[116:119], v[52:55]
    ds_read_b64 v[128:129], v17 offset:1472
    buffer_load_dwordx4 a[104:107], v9, s[12:15], s39 offen offset:2048 sc1
    s_add_u32 s39, s39, 12288
    s_cmp_eq_u32 s39, s56
    s_cselect_b32 s39, s57, s39
    v_mfma_f32_16x16x32_bf16 v[28:31], v[60:63], v[88:91], v[28:31]
    ds_read_b64 v[130:131], v17 offset:1480
    v_mfma_f32_16x16x32_bf16 v[32:35], v[60:63], v[92:95], v[32:35]
    ds_read_b128 v[164:167], v18 offset:1536
    v_mfma_f32_16x16x32_bf16 v[36:39], v[60:63], v[96:99], v[36:39]
    ds_read_b64 v[132:133], v17 offset:1984
    buffer_load_dwordx4 a[108:111], v9, s[12:15], s39 offen offset:0 sc1
    v_mfma_f32_16x16x32_bf16 v[40:43], v[60:63], v[100:103], v[40:43]
    ds_read_b64 v[134:135], v17 offset:1992
    v_mfma_f32_16x16x32_bf16 v[44:47], v[60:63], v[104:107], v[44:47]
    ds_read_b128 v[168:171], v18 offset:2048
    v_mfma_f32_16x16x32_bf16 v[48:51], v[60:63], v[108:111], v[48:51]
    ds_read_b64 v[136:137], v17 offset:2496
    buffer_load_dwordx4 a[112:115], v9, s[12:15], s39 offen offset:1024 sc1
    v_mfma_f32_16x16x32_bf16 v[52:55], v[60:63], v[112:115], v[52:55]
    ds_read_b64 v[138:139], v17 offset:2504
    v_mfma_f32_16x16x32_bf16 v[32:35], v[64:67], v[88:91], v[32:35]
    ds_read_b128 v[172:175], v18 offset:2560
    v_mfma_f32_16x16x32_bf16 v[36:39], v[64:67], v[92:95], v[36:39]
    ds_read_b64 v[140:141], v17 offset:3008
    buffer_load_dwordx4 a[116:119], v9, s[12:15], s39 offen offset:2048 sc1
    s_add_u32 s39, s39, 12288
    s_cmp_eq_u32 s39, s56
    s_cselect_b32 s39, s57, s39
    v_mfma_f32_16x16x32_bf16 v[40:43], v[64:67], v[96:99], v[40:43]
    ds_read_b64 v[142:143], v17 offset:3016
    v_mfma_f32_16x16x32_bf16 v[44:47], v[64:67], v[100:103], v[44:47]
    ds_read_b128 v[176:179], v18 offset:3072
    v_mfma_f32_16x16x32_bf16 v[48:51], v[64:67], v[104:107], v[48:51]
    ds_read_b64 v[144:145], v17 offset:3520
    buffer_load_dwordx4 a[120:123], v9, s[12:15], s39 offen offset:0 sc1
    v_mfma_f32_16x16x32_bf16 v[52:55], v[64:67], v[108:111], v[52:55]
    ds_read_b64 v[146:147], v17 offset:3528
    v_mfma_f32_16x16x32_bf16 v[36:39], v[68:71], v[88:91], v[36:39]
    ds_read_b128 v[180:183], v18 offset:3584
    v_mfma_f32_16x16x32_bf16 v[40:43], v[68:71], v[92:95], v[40:43]
    ds_read_b64 v[148:149], v17 offset:4032
    buffer_load_dwordx4 a[124:127], v9, s[12:15], s39 offen offset:1024 sc1
    v_mfma_f32_16x16x32_bf16 v[44:47], v[68:71], v[96:99], v[44:47]
    ds_read_b64 v[150:151], v17 offset:4040
    v_mfma_f32_16x16x32_bf16 v[48:51], v[68:71], v[100:103], v[48:51]
    ds_read_b64 v[184:185], v19 offset:0
    v_mfma_f32_16x16x32_bf16 v[52:55], v[68:71], v[104:107], v[52:55]
    buffer_load_dwordx4 a[128:131], v9, s[12:15], s39 offen offset:2048 sc1
    s_add_u32 s39, s39, 12288
    s_cmp_eq_u32 s39, s56
    s_cselect_b32 s39, s57, s39
    ds_read_b64 v[186:187], v19 offset:512
    v_mfma_f32_16x16x32_bf16 v[40:43], v[72:75], v[88:91], v[40:43]
    ds_read_b64 v[188:189], v19 offset:1024
    v_mfma_f32_16x16x32_bf16 v[44:47], v[72:75], v[92:95], v[44:47]
    ds_read_b64 v[190:191], v19 offset:1536
    v_mfma_f32_16x16x32_bf16 v[48:51], v[72:75], v[96:99], v[48:51]
    buffer_load_dwordx4 a[132:135], v9, s[12:15], s39 offen offset:0 sc1
    ds_read_b64 v[192:193], v19 offset:2048
    v_mfma_f32_16x16x32_bf16 v[52:55], v[72:75], v[100:103], v[52:55]
    ds_read_b64 v[194:195], v19 offset:2560
    v_mfma_f32_16x16x32_bf16 v[44:47], v[76:79], v[88:91], v[44:47]
    ds_read_b64 v[196:197], v19 offset:3072
    v_mfma_f32_16x16x32_bf16 v[48:51], v[76:79], v[92:95], v[48:51]
    buffer_load_dwordx4 a[136:139], v9, s[12:15], s39 offen offset:1024 sc1
    ds_read_b64 v[198:199], v19 offset:3584
    v_mfma_f32_16x16x32_bf16 v[52:55], v[76:79], v[96:99], v[52:55]
    v_mfma_f32_16x16x32_bf16 v[48:51], v[80:83], v[88:91], v[48:51]
    v_mfma_f32_16x16x32_bf16 v[52:55], v[80:83], v[92:95], v[52:55]
    buffer_load_dwordx4 a[140:143], v9, s[12:15], s39 offen offset:2048 sc1
    s_add_u32 s39, s39, 12288
    s_cmp_eq_u32 s39, s56
    s_cselect_b32 s39, s57, s39
    v_mfma_f32_16x16x32_bf16 v[52:55], v[84:87], v[88:91], v[52:55]
    s_waitcnt lgkmcnt(0)
    v_mfma_f32_16x16x32_bf16 v[24:27], v[120:123], v[152:155], v[24:27]
    v_lshlrev_b32 v200, 16, v184
    v_and_b32 v201, 0xffff0000, v184
    v_mfma_f32_16x16x32_bf16 v[28:31], v[120:123], v[156:159], v[28:31]
    v_lshlrev_b32 v202, 16, v185
    v_and_b32 v203, 0xffff0000, v185
    v_mfma_f32_16x16x32_bf16 v[32:35], v[120:123], v[160:163], v[32:35]
    v_lshlrev_b32 v204, 16, v186
    v_and_b32 v205, 0xffff0000, v186
    v_mfma_f32_16x16x32_bf16 v[36:39], v[120:123], v[164:167], v[36:39]
    v_lshlrev_b32 v206, 16, v187
    v_and_b32 v207, 0xffff0000, v187
    v_mfma_f32_16x16x32_bf16 v[40:43], v[120:123], v[168:171], v[40:43]
    v_lshlrev_b32 v208, 16, v188
    v_and_b32 v209, 0xffff0000, v188
    v_mfma_f32_16x16x32_bf16 v[44:47], v[120:123], v[172:175], v[44:47]
    v_lshlrev_b32 v210, 16, v189
    v_and_b32 v211, 0xffff0000, v189
    v_mfma_f32_16x16x32_bf16 v[48:51], v[120:123], v[176:179], v[48:51]
    buffer_load_dwordx4 a[144:147], v9, s[12:15], s39 offen offset:0 sc1
    v_lshlrev_b32 v212, 16, v190
    v_and_b32 v213, 0xffff0000, v190
    v_mfma_f32_16x16x32_bf16 v[52:55], v[120:123], v[180:183], v[52:55]
    v_lshlrev_b32 v214, 16, v191
    v_and_b32 v215, 0xffff0000, v191
    v_mfma_f32_16x16x32_bf16 v[28:31], v[124:127], v[152:155], v[28:31]
    v_lshlrev_b32 v216, 16, v192
    v_and_b32 v217, 0xffff0000, v192
    v_mfma_f32_16x16x32_bf16 v[32:35], v[124:127], v[156:159], v[32:35]
    v_lshlrev_b32 v218, 16, v193
    v_and_b32 v219, 0xffff0000, v193
    v_mfma_f32_16x16x32_bf16 v[36:39], v[124:127], v[160:163], v[36:39]
    v_lshlrev_b32 v220, 16, v194
    v_and_b32 v221, 0xffff0000, v194
    v_mfma_f32_16x16x32_bf16 v[40:43], v[124:127], v[164:167], v[40:43]
    v_lshlrev_b32 v222, 16, v195
    v_and_b32 v223, 0xffff0000, v195
    v_mfma_f32_16x16x32_bf16 v[44:47], v[124:127], v[168:171], v[44:47]
    v_lshlrev_b32 v224, 16, v196
    v_and_b32 v225, 0xffff0000, v196
    v_mfma_f32_16x16x32_bf16 v[48:51], v[124:127], v[172:175], v[48:51]
    v_lshlrev_b32 v226, 16, v197
    v_and_b32 v227, 0xffff0000, v197
    v_mfma_f32_16x16x32_bf16 v[52:55], v[124:127], v[176:179], v[52:55]
    v_lshlrev_b32 v228, 16, v198
    v_and_b32 v229, 0xffff0000, v198
    v_mfma_f32_16x16x32_bf16 v[32:35], v[128:131], v[152:155], v[32:35]
    v_lshlrev_b32 v230, 16, v199
    v_and_b32 v231, 0xffff0000, v199
    v_mfma_f32_16x16x32_bf16 v[36:39], v[128:131], v[156:159], v[36:39]
    v_add_f32 v24, v24, v200
    v_add_f32 v25, v25, v201
    v_mfma_f32_16x16x32_bf16 v[40:43], v[128:131], v[160:163], v[40:43]
    v_add_f32 v26, v26, v202
    v_add_f32 v27, v27, v203
    v_mfma_f32_16x16x32_bf16 v[44:47], v[128:131], v[164:167], v[44:47]
    buffer_load_dwordx4 a[148:151], v9, s[12:15], s39 offen offset:1024 sc1
    v_cvt_pk_bf16_f32 v184, v24, v25
    v_cvt_pk_bf16_f32 v185, v26, v27
    v_mfma_f32_16x16x32_bf16 v[48:51], v[128:131], v[168:171], v[48:51]
    v_add_f32 v28, v28, v204
    v_add_f32 v29, v29, v205
    v_mfma_f32_16x16x32_bf16 v[52:55], v[128:131], v[172:175], v[52:55]
    v_add_f32 v30, v30, v206
    v_add_f32 v31, v31, v207
    v_mfma_f32_16x16x32_bf16 v[36:39], v[132:135], v[152:155], v[36:39]
    v_cvt_pk_bf16_f32 v186, v28, v29
    v_cvt_pk_bf16_f32 v187, v30, v31
    v_mfma_f32_16x16x32_bf16 v[40:43], v[132:135], v[156:159], v[40:43]
    v_mfma_f32_16x16x32_bf16 v[44:47], v[132:135], v[160:163], v[44:47]
    v_add_f32 v32, v32, v208
    v_add_f32 v33, v33, v209
    v_mfma_f32_16x16x32_bf16 v[48:51], v[132:135], v[164:167], v[48:51]
    v_add_f32 v34, v34, v210
    v_add_f32 v35, v35, v211
    v_mfma_f32_16x16x32_bf16 v[52:55], v[132:135], v[168:171], v[52:55]
    v_cvt_pk_bf16_f32 v188, v32, v33
    v_cvt_pk_bf16_f32 v189, v34, v35
    v_mfma_f32_16x16x32_bf16 v[40:43], v[136:139], v[152:155], v[40:43]
    v_mfma_f32_16x16x32_bf16 v[44:47], v[136:139], v[156:159], v[44:47]
    v_mfma_f32_16x16x32_bf16 v[48:51], v[136:139], v[160:163], v[48:51]
    v_mfma_f32_16x16x32_bf16 v[52:55], v[136:139], v[164:167], v[52:55]
    v_add_f32 v36, v36, v212
    v_add_f32 v37, v37, v213
    v_mfma_f32_16x16x32_bf16 v[44:47], v[140:143], v[152:155], v[44:47]
    buffer_load_dwordx4 a[152:155], v9, s[12:15], s39 offen offset:2048 sc1
    s_add_u32 s39, s39, 12288
    s_cmp_eq_u32 s39, s56
    s_cselect_b32 s39, s57, s39
    v_add_f32 v38, v38, v214
    v_add_f32 v39, v39, v215
    v_mfma_f32_16x16x32_bf16 v[48:51], v[140:143], v[156:159], v[48:51]
    v_cvt_pk_bf16_f32 v190, v36, v37
    v_cvt_pk_bf16_f32 v191, v38, v39
    v_mfma_f32_16x16x32_bf16 v[52:55], v[140:143], v[160:163], v[52:55]
    v_mfma_f32_16x16x32_bf16 v[48:51], v[144:147], v[152:155], v[48:51]
    v_mfma_f32_16x16x32_bf16 v[52:55], v[144:147], v[156:159], v[52:55]
    v_mfma_f32_16x16x32_bf16 v[52:55], v[148:151], v[152:155], v[52:55]
    s_waitcnt vmcnt(39)
    buffer_store_dwordx4 v[184:187], v9, s[8:11], s33 offen offset:0 sc1
    buffer_store_dwordx4 v[188:191], v9, s[8:11], s33 offen offset:1024 sc1
    v_pk_add_f32 v[40:41], v[40:41], v[216:217]
    v_pk_add_f32 v[42:43], v[42:43], v[218:219]
    v_cvt_pk_bf16_f32 v192, v40, v41
    v_cvt_pk_bf16_f32 v193, v42, v43
    v_pk_add_f32 v[44:45], v[44:45], v[220:221]
    v_pk_add_f32 v[46:47], v[46:47], v[222:223]
    v_cvt_pk_bf16_f32 v194, v44, v45
    v_cvt_pk_bf16_f32 v195, v46, v47
    buffer_store_dwordx4 v[192:195], v9, s[8:11], s33 offen offset:2048 sc1
    s_nop 0
    v_pk_add_f32 v[48:49], v[48:49], v[224:225]
    v_pk_add_f32 v[50:51], v[50:51], v[226:227]
    v_cvt_pk_bf16_f32 v196, v48, v49
    v_cvt_pk_bf16_f32 v197, v50, v51
    v_pk_add_f32 v[52:53], v[52:53], v[228:229]
    v_pk_add_f32 v[54:55], v[54:55], v[230:231]
    v_cvt_pk_bf16_f32 v198, v52, v53
    v_cvt_pk_bf16_f32 v199, v54, v55
    buffer_store_dwordx4 v[196:199], v9, s[8:11], s33 offen offset:3072 sc1
    s_lshl_b32 s31, s29, 7
    s_add_u32 s31, s31, 65536
    s_barrier
    s_cmp_lg_u32 s28, 0
    s_cbranch_scc1 M_NF
    buffer_store_dwordx4 v[244:247], v20, s[64:67], s16 offen sc1
M_NF:
    s_cmp_eq_u32 s70, 0
    s_cbranch_scc1 P_MID
    s_or_b32 s70, s70, 0xfe000
    s_branch W_L0
P_HELP:
    s_sub_u32 s29, s2, 160
    v_lshrrev_b32 v3, 4, v1
    v_bfe_u32 v2, v1, 3, 1
    v_lshl_add_u32 v2, v3, 3, v2
    v_and_b32 v3, 7, v1
    v_lshlrev_b32 v3, 4, v3
    s_movk_i32 s33, 1280
    v_mad_u32_u24 v11, v2, s33, v3
    s_lshl_b32 s30, s29, 2
    s_add_u32 s30, s30, s28
    s_mov_b32 s46, s30
    s_movk_i32 s34, 40
    s_movk_i32 s56, 320
    s_cmp_lt_u32 s29, 32
    s_cbranch_scc1 H_RJ
    s_lshr_b32 s34, s29, 3
    s_mul_i32 s34, s34, 5
    s_sub_u32 s34, s34, 16
    s_lshr_b32 s31, s34, 1
    s_lshl_b32 s31, s31, 3
    s_and_b32 s33, s29, 7
    s_add_u32 s31, s31, s33
    s_lshl_b32 s31, s31, 1
    s_and_b32 s33, s34, 1
    s_add_u32 s31, s31, s33
    s_cmp_eq_u32 s28, 3
    s_cselect_b32 s56, s31, 320
    s_add_u32 s34, s34, s28
    s_sub_u32 s34, s34, 4
    s_movk_i32 s46, 128
    s_lshl_b32 s30, s29, 1
    s_add_u32 s30, s30, s28
    s_add_u32 s30, s30, 64
    s_cmp_lt_u32 s28, 2
    s_cselect_b32 s30, s30, 256
H_RJ:
    s_lshr_b32 s31, s34, 1
    s_lshl_b32 s31, s31, 3
    s_and_b32 s33, s29, 7
    s_add_u32 s31, s31, s33
    s_lshl_b32 s31, s31, 1
    s_and_b32 s34, s34, 1
    s_add_u32 s34, s34, s31
    s_load_dwordx2 s[44:45], s[0:1], 80
    s_mul_i32 s31, s30, 10240
    s_mul_i32 s32, s28, 21792
    s_and_b32 s33, s30, 3
    s_mul_i32 s33, s33, 7680
    s_sub_u32 s31, s31, s33
    v_mul_u32_u24 v3, 5462, v1
    v_lshrrev_b32 v3, 16, v3
    v_mul_u32_u24 v3, 2880, v3
    v_lshl_add_u32 v6, v1, 4, v3
    v_add_u32 v2, 64, v1
    v_mul_u32_u24 v3, 5462, v2
    v_lshrrev_b32 v3, 16, v3
    v_mul_u32_u24 v3, 2880, v3
    v_lshl_add_u32 v7, v1, 4, v3
    v_add_u32 v2, 128, v1
    v_mul_u32_u24 v3, 5462, v2
    v_lshrrev_b32 v3, 16, v3
    v_mul_u32_u24 v3, 2880, v3
    v_lshl_add_u32 v8, v1, 4, v3
    s_waitcnt lgkmcnt(0)
    s_add_u32 s64, s4, 28311552
    s_addc_u32 s65, s5, 0
    s_load_dword s59, s[64:65], 0
    s_mov_b32 s66, 0x200000
    s_mov_b32 s67, 0x20000
    s_mov_b32 s24, s8
    s_mov_b32 s25, s9
    s_mov_b32 s26, 0x280000
    s_mov_b32 s27, 0x20000
    s_mov_b32 s12, s40
    s_mov_b32 s13, s41
    s_mov_b32 s14, 0x1e0000
    s_mov_b32 s15, 0x20000
    s_mov_b32 s16, s42
    s_mov_b32 s17, s43
    s_mov_b32 s18, 0x1e0000
    s_mov_b32 s19, 0x20000
    s_cmp_ge_u32 s30, 256
    s_cbranch_scc1 H_NX
    buffer_load_dwordx4 v[36:39], v11, s[24:27], s31 offen offset:0 nt
    buffer_load_dwordx4 v[40:43], v11, s[24:27], s31 offen offset:128 nt
    buffer_load_dwordx4 v[44:47], v11, s[24:27], s31 offen offset:256 nt
    buffer_load_dwordx4 v[48:51], v11, s[24:27], s31 offen offset:384 nt
    buffer_load_dwordx4 v[52:55], v11, s[24:27], s31 offen offset:512 nt
    buffer_load_dwordx4 v[56:59], v11, s[24:27], s31 offen offset:640 nt
    buffer_load_dwordx4 v[60:63], v11, s[24:27], s31 offen offset:768 nt
    buffer_load_dwordx4 v[64:67], v11, s[24:27], s31 offen offset:896 nt
    buffer_load_dwordx4 v[68:71], v11, s[24:27], s31 offen offset:1024 nt
    buffer_load_dwordx4 v[72:75], v11, s[24:27], s31 offen offset:1152 nt
H_NX:
    s_waitcnt lgkmcnt(0)
    s_barrier
    s_add_u32 s59, s59, 1
    s_lshr_b32 s47, s30, 6
    s_lshl_b32 s47, s47, 12
    s_and_b32 s33, s30, 3
    s_lshl_b32 s33, s33, 10
    s_add_u32 s47, s47, s33
    s_bfe_u32 s33, s30, 0x40002
    s_lshl_b32 s33, s33, 6
    s_add_u32 s47, s47, s33
    s_add_u32 s47, s47, 4096
    s_lshl_b32 s48, s34, 6
    s_add_u32 s48, s48, 32768
    s_lshl_b32 s49, s46, 6
    s_add_u32 s49, s49, 53248
    s_cmp_lt_u32 s34, 320
    s_cselect_b32 s48, s48, s49
    s_cmp_lt_u32 s46, 128
    s_cselect_b32 s49, s49, s48
    s_cmp_lt_u32 s30, 256
    s_cselect_b32 s47, s47, s48
    s_lshl_b32 s50, s56, 6
    s_add_u32 s50, s50, 32768
    s_cmp_lt_u32 s56, 320
    s_cselect_b32 s49, s50, s49
    v_mov_b32 v2, s47
    v_mov_b32 v3, s48
    v_mov_b32 v4, s49
    v_cmp_gt_u32 vcc, 4, v1
    v_cndmask_b32 v3, v4, v3, vcc
    v_cmp_gt_u32 vcc, 8, v1
    v_cndmask_b32 v3, v2, v3, vcc
    v_and_b32 v2, 3, v1
    v_lshl_add_u32 v17, v2, 4, v3
    v_not_b32 v240, s59
    v_not_b32 v241, s59
    v_not_b32 v242, s59
    v_not_b32 v243, s59
    s_mov_b64 exec, 4095
    buffer_store_dwordx4 v[240:243], v17, s[64:67], 0 offen sc1
    s_mov_b64 exec, -1
    s_cmp_ge_u32 s34, 320
    s_cbranch_scc1 H_NW
    s_cmp_lt_u32 s30, 256
    s_cbranch_scc1 H_B2
    s_barrier
H_B2:
    s_lshr_b32 s35, s34, 4
    s_and_b32 s36, s34, 15
    s_mul_i32 s37, s35, 98304
    s_mul_i32 s38, s36, 192
    s_add_u32 s37, s37, s38
    s_add_u32 s38, s37, 49152
    s_add_u32 m0, s32, 0
    s_nop 0
    buffer_load_dwordx4 v6, s[12:15], s37 offen offset:0 nt lds
    buffer_load_dwordx4 v7, s[12:15], s37 offen offset:1024 nt lds
    buffer_load_dwordx4 v8, s[12:15], s37 offen offset:2048 nt lds
    s_add_u32 m0, s32, 3072
    s_nop 0
    buffer_load_dwordx4 v6, s[12:15], s38 offen offset:0 nt lds
    buffer_load_dwordx4 v7, s[12:15], s38 offen offset:1024 nt lds
    buffer_load_dwordx4 v8, s[12:15], s38 offen offset:2048 nt lds
    s_add_u32 m0, s32, 6144
    s_nop 0
    buffer_load_dwordx4 v6, s[16:19], s37 offen offset:0 nt lds
    buffer_load_dwordx4 v7, s[16:19], s37 offen offset:1024 nt lds
    buffer_load_dwordx4 v8, s[16:19], s37 offen offset:2048 nt lds
    s_add_u32 m0, s32, 9216
    s_nop 0
    buffer_load_dwordx4 v6, s[16:19], s38 offen offset:0 nt lds
    buffer_load_dwordx4 v7, s[16:19], s38 offen offset:1024 nt lds
    buffer_load_dwordx4 v8, s[16:19], s38 offen offset:2048 nt lds
    s_mul_i32 s36, s36, 245760
    s_mul_i32 s35, s35, 12288
    s_add_u32 s35, s35, s36
    s_cmp_ge_u32 s30, 256
    s_cbranch_scc1 H_B3
    s_barrier
H_B3:
    s_cmp_ge_u32 s56, 320
    s_cbranch_scc1 H_J1
    s_mov_b32 s51, 87296
    s_lshr_b32 s57, s56, 4
    s_and_b32 s36, s56, 15
    s_mul_i32 s37, s57, 98304
    s_mul_i32 s38, s36, 192
    s_add_u32 s37, s37, s38
    s_add_u32 s38, s37, 49152
    s_add_u32 m0, s51, 0
    s_nop 0
    buffer_load_dwordx4 v6, s[12:15], s37 offen offset:0 nt lds
    buffer_load_dwordx4 v7, s[12:15], s37 offen offset:1024 nt lds
    buffer_load_dwordx4 v8, s[12:15], s37 offen offset:2048 nt lds
    s_add_u32 m0, s51, 3072
    s_nop 0
    buffer_load_dwordx4 v6, s[12:15], s38 offen offset:0 nt lds
    buffer_load_dwordx4 v7, s[12:15], s38 offen offset:1024 nt lds
    buffer_load_dwordx4 v8, s[12:15], s38 offen offset:2048 nt lds
    s_add_u32 m0, s51, 6144
    s_nop 0
    buffer_load_dwordx4 v6, s[16:19], s37 offen offset:0 nt lds
    buffer_load_dwordx4 v7, s[16:19], s37 offen offset:1024 nt lds
    buffer_load_dwordx4 v8, s[16:19], s37 offen offset:2048 nt lds
    s_add_u32 m0, s51, 9216
    s_nop 0
    buffer_load_dwordx4 v6, s[16:19], s38 offen offset:0 nt lds
    buffer_load_dwordx4 v7, s[16:19], s38 offen offset:1024 nt lds
    buffer_load_dwordx4 v8, s[16:19], s38 offen offset:2048 nt lds
    s_mul_i32 s36, s36, 245760
    s_mul_i32 s57, s57, 12288
    s_add_u32 s57, s57, s36
    s_branch H_J1
H_NW:
    s_waitcnt vmcnt(0)
H_J1:
    s_cmp_ge_u32 s30, 256
    s_cbranch_scc1 H_NOST
    s_waitcnt vmcnt(22)
    v_lshlrev_b32 v76, 16, v36
    v_and_b32 v77, 0xffff0000, v36
    v_lshlrev_b32 v78, 16, v37
    v_and_b32 v79, 0xffff0000, v37
    v_lshlrev_b32 v80, 16, v38
    v_and_b32 v81, 0xffff0000, v38
    v_lshlrev_b32 v82, 16, v39
    v_and_b32 v83, 0xffff0000, v39
    s_waitcnt vmcnt(21)
    v_lshlrev_b32 v84, 16, v40
    v_and_b32 v85, 0xffff0000, v40
    v_lshlrev_b32 v86, 16, v41
    v_and_b32 v87, 0xffff0000, v41
    v_lshlrev_b32 v88, 16, v42
    v_and_b32 v89, 0xffff0000, v42
    v_lshlrev_b32 v90, 16, v43
    v_and_b32 v91, 0xffff0000, v43
    v_pk_add_f32 v[24:25], v[76:77], v[84:85]
    v_pk_add_f32 v[26:27], v[78:79], v[86:87]
    v_pk_add_f32 v[28:29], v[80:81], v[88:89]
    v_pk_add_f32 v[30:31], v[82:83], v[90:91]
    s_waitcnt vmcnt(20)
    v_lshlrev_b32 v92, 16, v44
    v_and_b32 v93, 0xffff0000, v44
    v_lshlrev_b32 v94, 16, v45
    v_and_b32 v95, 0xffff0000, v45
    v_lshlrev_b32 v96, 16, v46
    v_and_b32 v97, 0xffff0000, v46
    v_lshlrev_b32 v98, 16, v47
    v_and_b32 v99, 0xffff0000, v47
    v_pk_add_f32 v[24:25], v[24:25], v[92:93]
    v_pk_add_f32 v[26:27], v[26:27], v[94:95]
    v_pk_add_f32 v[28:29], v[28:29], v[96:97]
    v_pk_add_f32 v[30:31], v[30:31], v[98:99]
    s_waitcnt vmcnt(19)
    v_lshlrev_b32 v100, 16, v48
    v_and_b32 v101, 0xffff0000, v48
    v_lshlrev_b32 v102, 16, v49
    v_and_b32 v103, 0xffff0000, v49
    v_lshlrev_b32 v104, 16, v50
    v_and_b32 v105, 0xffff0000, v50
    v_lshlrev_b32 v106, 16, v51
    v_and_b32 v107, 0xffff0000, v51
    v_pk_add_f32 v[24:25], v[24:25], v[100:101]
    v_pk_add_f32 v[26:27], v[26:27], v[102:103]
    v_pk_add_f32 v[28:29], v[28:29], v[104:105]
    v_pk_add_f32 v[30:31], v[30:31], v[106:107]
    s_waitcnt vmcnt(18)
    v_lshlrev_b32 v108, 16, v52
    v_and_b32 v109, 0xffff0000, v52
    v_lshlrev_b32 v110, 16, v53
    v_and_b32 v111, 0xffff0000, v53
    v_lshlrev_b32 v112, 16, v54
    v_and_b32 v113, 0xffff0000, v54
    v_lshlrev_b32 v114, 16, v55
    v_and_b32 v115, 0xffff0000, v55
    v_pk_add_f32 v[24:25], v[24:25], v[108:109]
    v_pk_add_f32 v[26:27], v[26:27], v[110:111]
    v_pk_add_f32 v[28:29], v[28:29], v[112:113]
    v_pk_add_f32 v[30:31], v[30:31], v[114:115]
    s_waitcnt vmcnt(17)
    v_lshlrev_b32 v116, 16, v56
    v_and_b32 v117, 0xffff0000, v56
    v_lshlrev_b32 v118, 16, v57
    v_and_b32 v119, 0xffff0000, v57
    v_lshlrev_b32 v120, 16, v58
    v_and_b32 v121, 0xffff0000, v58
    v_lshlrev_b32 v122, 16, v59
    v_and_b32 v123, 0xffff0000, v59
    v_pk_add_f32 v[24:25], v[24:25], v[116:117]
    v_pk_add_f32 v[26:27], v[26:27], v[118:119]
    v_pk_add_f32 v[28:29], v[28:29], v[120:121]
    v_pk_add_f32 v[30:31], v[30:31], v[122:123]
    s_waitcnt vmcnt(16)
    v_lshlrev_b32 v124, 16, v60
    v_and_b32 v125, 0xffff0000, v60
    v_lshlrev_b32 v126, 16, v61
    v_and_b32 v127, 0xffff0000, v61
    v_lshlrev_b32 v128, 16, v62
    v_and_b32 v129, 0xffff0000, v62
    v_lshlrev_b32 v130, 16, v63
    v_and_b32 v131, 0xffff0000, v63
    v_pk_add_f32 v[24:25], v[24:25], v[124:125]
    v_pk_add_f32 v[26:27], v[26:27], v[126:127]
    v_pk_add_f32 v[28:29], v[28:29], v[128:129]
    v_pk_add_f32 v[30:31], v[30:31], v[130:131]
    s_waitcnt vmcnt(15)
    v_lshlrev_b32 v132, 16, v64
    v_and_b32 v133, 0xffff0000, v64
    v_lshlrev_b32 v134, 16, v65
    v_and_b32 v135, 0xffff0000, v65
    v_lshlrev_b32 v136, 16, v66
    v_and_b32 v137, 0xffff0000, v66
    v_lshlrev_b32 v138, 16, v67
    v_and_b32 v139, 0xffff0000, v67
    v_pk_add_f32 v[24:25], v[24:25], v[132:133]
    v_pk_add_f32 v[26:27], v[26:27], v[134:135]
    v_pk_add_f32 v[28:29], v[28:29], v[136:137]
    v_pk_add_f32 v[30:31], v[30:31], v[138:139]
    s_waitcnt vmcnt(14)
    v_lshlrev_b32 v140, 16, v68
    v_and_b32 v141, 0xffff0000, v68
    v_lshlrev_b32 v142, 16, v69
    v_and_b32 v143, 0xffff0000, v69
    v_lshlrev_b32 v144, 16, v70
    v_and_b32 v145, 0xffff0000, v70
    v_lshlrev_b32 v146, 16, v71
    v_and_b32 v147, 0xffff0000, v71
    v_pk_add_f32 v[24:25], v[24:25], v[140:141]
    v_pk_add_f32 v[26:27], v[26:27], v[142:143]
    v_pk_add_f32 v[28:29], v[28:29], v[144:145]
    v_pk_add_f32 v[30:31], v[30:31], v[146:147]
    s_waitcnt vmcnt(13)
    v_lshlrev_b32 v148, 16, v72
    v_and_b32 v149, 0xffff0000, v72
    v_lshlrev_b32 v150, 16, v73
    v_and_b32 v151, 0xffff0000, v73
    v_lshlrev_b32 v152, 16, v74
    v_and_b32 v153, 0xffff0000, v74
    v_lshlrev_b32 v154, 16, v75
    v_and_b32 v155, 0xffff0000, v75
    v_pk_add_f32 v[24:25], v[24:25], v[148:149]
    v_pk_add_f32 v[26:27], v[26:27], v[150:151]
    v_pk_add_f32 v[28:29], v[28:29], v[152:153]
    v_pk_add_f32 v[30:31], v[30:31], v[154:155]
    v_pk_add_f32 v[24:25], v[24:25], v[26:27]
    v_pk_add_f32 v[28:29], v[28:29], v[30:31]
    v_pk_add_f32 v[24:25], v[24:25], v[28:29]
    v_add_f32 v24, v24, v25
    s_nop 1
    v_add_f32_dpp v24, v24, v24 quad_perm:[1,0,3,2] row_mask:0xf bank_mask:0xf
    s_nop 1
    v_add_f32_dpp v24, v24, v24 quad_perm:[2,3,0,1] row_mask:0xf bank_mask:0xf
    s_nop 1
    v_add_f32_dpp v24, v24, v24 row_half_mirror row_mask:0xf bank_mask:0xf
    v_mul_f32 v24, 0x3acccccd, v24
    v_mov_b32 v32, v24
    v_pk_add_f32 v[76:77], v[76:77], v[32:33] op_sel_hi:[1,0] neg_lo:[0,1] neg_hi:[0,1]
    v_pk_add_f32 v[78:79], v[78:79], v[32:33] op_sel_hi:[1,0] neg_lo:[0,1] neg_hi:[0,1]
    v_pk_mul_f32 v[24:25], v[76:77], v[76:77]
    v_pk_add_f32 v[80:81], v[80:81], v[32:33] op_sel_hi:[1,0] neg_lo:[0,1] neg_hi:[0,1]
    v_pk_mul_f32 v[26:27], v[78:79], v[78:79]
    v_pk_add_f32 v[82:83], v[82:83], v[32:33] op_sel_hi:[1,0] neg_lo:[0,1] neg_hi:[0,1]
    v_pk_mul_f32 v[28:29], v[80:81], v[80:81]
    v_pk_add_f32 v[84:85], v[84:85], v[32:33] op_sel_hi:[1,0] neg_lo:[0,1] neg_hi:[0,1]
    v_pk_mul_f32 v[30:31], v[82:83], v[82:83]
    v_pk_add_f32 v[86:87], v[86:87], v[32:33] op_sel_hi:[1,0] neg_lo:[0,1] neg_hi:[0,1]
    v_pk_fma_f32 v[24:25], v[84:85], v[84:85], v[24:25]
    v_pk_add_f32 v[88:89], v[88:89], v[32:33] op_sel_hi:[1,0] neg_lo:[0,1] neg_hi:[0,1]
    v_pk_fma_f32 v[26:27], v[86:87], v[86:87], v[26:27]
    v_pk_add_f32 v[90:91], v[90:91], v[32:33] op_sel_hi:[1,0] neg_lo:[0,1] neg_hi:[0,1]
    v_pk_fma_f32 v[28:29], v[88:89], v[88:89], v[28:29]
    v_pk_add_f32 v[92:93], v[92:93], v[32:33] op_sel_hi:[1,0] neg_lo:[0,1] neg_hi:[0,1]
    v_pk_fma_f32 v[30:31], v[90:91], v[90:91], v[30:31]
    v_pk_add_f32 v[94:95], v[94:95], v[32:33] op_sel_hi:[1,0] neg_lo:[0,1] neg_hi:[0,1]
    v_pk_fma_f32 v[24:25], v[92:93], v[92:93], v[24:25]
    v_pk_add_f32 v[96:97], v[96:97], v[32:33] op_sel_hi:[1,0] neg_lo:[0,1] neg_hi:[0,1]
    v_pk_fma_f32 v[26:27], v[94:95], v[94:95], v[26:27]
    v_pk_add_f32 v[98:99], v[98:99], v[32:33] op_sel_hi:[1,0] neg_lo:[0,1] neg_hi:[0,1]
    v_pk_fma_f32 v[28:29], v[96:97], v[96:97], v[28:29]
    v_pk_add_f32 v[100:101], v[100:101], v[32:33] op_sel_hi:[1,0] neg_lo:[0,1] neg_hi:[0,1]
    v_pk_fma_f32 v[30:31], v[98:99], v[98:99], v[30:31]
    v_pk_add_f32 v[102:103], v[102:103], v[32:33] op_sel_hi:[1,0] neg_lo:[0,1] neg_hi:[0,1]
    v_pk_fma_f32 v[24:25], v[100:101], v[100:101], v[24:25]
    v_pk_add_f32 v[104:105], v[104:105], v[32:33] op_sel_hi:[1,0] neg_lo:[0,1] neg_hi:[0,1]
    v_pk_fma_f32 v[26:27], v[102:103], v[102:103], v[26:27]
    v_pk_add_f32 v[106:107], v[106:107], v[32:33] op_sel_hi:[1,0] neg_lo:[0,1] neg_hi:[0,1]
    v_pk_fma_f32 v[28:29], v[104:105], v[104:105], v[28:29]
    v_pk_add_f32 v[108:109], v[108:109], v[32:33] op_sel_hi:[1,0] neg_lo:[0,1] neg_hi:[0,1]
    v_pk_fma_f32 v[30:31], v[106:107], v[106:107], v[30:31]
    v_pk_add_f32 v[110:111], v[110:111], v[32:33] op_sel_hi:[1,0] neg_lo:[0,1] neg_hi:[0,1]
    v_pk_fma_f32 v[24:25], v[108:109], v[108:109], v[24:25]
    v_pk_add_f32 v[112:113], v[112:113], v[32:33] op_sel_hi:[1,0] neg_lo:[0,1] neg_hi:[0,1]
    v_pk_fma_f32 v[26:27], v[110:111], v[110:111], v[26:27]
    v_pk_add_f32 v[114:115], v[114:115], v[32:33] op_sel_hi:[1,0] neg_lo:[0,1] neg_hi:[0,1]
    v_pk_fma_f32 v[28:29], v[112:113], v[112:113], v[28:29]
    v_pk_add_f32 v[116:117], v[116:117], v[32:33] op_sel_hi:[1,0] neg_lo:[0,1] neg_hi:[0,1]
    v_pk_fma_f32 v[30:31], v[114:115], v[114:115], v[30:31]
    v_pk_add_f32 v[118:119], v[118:119], v[32:33] op_sel_hi:[1,0] neg_lo:[0,1] neg_hi:[0,1]
    v_pk_fma_f32 v[24:25], v[116:117], v[116:117], v[24:25]
    v_pk_add_f32 v[120:121], v[120:121], v[32:33] op_sel_hi:[1,0] neg_lo:[0,1] neg_hi:[0,1]
    v_pk_fma_f32 v[26:27], v[118:119], v[118:119], v[26:27]
    v_pk_add_f32 v[122:123], v[122:123], v[32:33] op_sel_hi:[1,0] neg_lo:[0,1] neg_hi:[0,1]
    v_pk_fma_f32 v[28:29], v[120:121], v[120:121], v[28:29]
    v_pk_add_f32 v[124:125], v[124:125], v[32:33] op_sel_hi:[1,0] neg_lo:[0,1] neg_hi:[0,1]
    v_pk_fma_f32 v[30:31], v[122:123], v[122:123], v[30:31]
    v_pk_add_f32 v[126:127], v[126:127], v[32:33] op_sel_hi:[1,0] neg_lo:[0,1] neg_hi:[0,1]
    v_pk_fma_f32 v[24:25], v[124:125], v[124:125], v[24:25]
    v_pk_add_f32 v[128:129], v[128:129], v[32:33] op_sel_hi:[1,0] neg_lo:[0,1] neg_hi:[0,1]
    v_pk_fma_f32 v[26:27], v[126:127], v[126:127], v[26:27]
    v_pk_add_f32 v[130:131], v[130:131], v[32:33] op_sel_hi:[1,0] neg_lo:[0,1] neg_hi:[0,1]
    v_pk_fma_f32 v[28:29], v[128:129], v[128:129], v[28:29]
    v_pk_add_f32 v[132:133], v[132:133], v[32:33] op_sel_hi:[1,0] neg_lo:[0,1] neg_hi:[0,1]
    v_pk_fma_f32 v[30:31], v[130:131], v[130:131], v[30:31]
    v_pk_add_f32 v[134:135], v[134:135], v[32:33] op_sel_hi:[1,0] neg_lo:[0,1] neg_hi:[0,1]
    v_pk_fma_f32 v[24:25], v[132:133], v[132:133], v[24:25]
    v_pk_add_f32 v[136:137], v[136:137], v[32:33] op_sel_hi:[1,0] neg_lo:[0,1] neg_hi:[0,1]
    v_pk_fma_f32 v[26:27], v[134:135], v[134:135], v[26:27]
    v_pk_add_f32 v[138:139], v[138:139], v[32:33] op_sel_hi:[1,0] neg_lo:[0,1] neg_hi:[0,1]
    v_pk_fma_f32 v[28:29], v[136:137], v[136:137], v[28:29]
    v_pk_add_f32 v[140:141], v[140:141], v[32:33] op_sel_hi:[1,0] neg_lo:[0,1] neg_hi:[0,1]
    v_pk_fma_f32 v[30:31], v[138:139], v[138:139], v[30:31]
    v_pk_add_f32 v[142:143], v[142:143], v[32:33] op_sel_hi:[1,0] neg_lo:[0,1] neg_hi:[0,1]
    v_pk_fma_f32 v[24:25], v[140:141], v[140:141], v[24:25]
    v_pk_add_f32 v[144:145], v[144:145], v[32:33] op_sel_hi:[1,0] neg_lo:[0,1] neg_hi:[0,1]
    v_pk_fma_f32 v[26:27], v[142:143], v[142:143], v[26:27]
    v_pk_add_f32 v[146:147], v[146:147], v[32:33] op_sel_hi:[1,0] neg_lo:[0,1] neg_hi:[0,1]
    v_pk_fma_f32 v[28:29], v[144:145], v[144:145], v[28:29]
    v_pk_add_f32 v[148:149], v[148:149], v[32:33] op_sel_hi:[1,0] neg_lo:[0,1] neg_hi:[0,1]
    v_pk_fma_f32 v[30:31], v[146:147], v[146:147], v[30:31]
    v_pk_add_f32 v[150:151], v[150:151], v[32:33] op_sel_hi:[1,0] neg_lo:[0,1] neg_hi:[0,1]
    v_pk_fma_f32 v[24:25], v[148:149], v[148:149], v[24:25]
    v_pk_add_f32 v[152:153], v[152:153], v[32:33] op_sel_hi:[1,0] neg_lo:[0,1] neg_hi:[0,1]
    v_pk_fma_f32 v[26:27], v[150:151], v[150:151], v[26:27]
    v_pk_add_f32 v[154:155], v[154:155], v[32:33] op_sel_hi:[1,0] neg_lo:[0,1] neg_hi:[0,1]
    v_pk_fma_f32 v[28:29], v[152:153], v[152:153], v[28:29]
    v_pk_fma_f32 v[30:31], v[154:155], v[154:155], v[30:31]
    v_pk_add_f32 v[24:25], v[24:25], v[26:27]
    v_pk_add_f32 v[28:29], v[28:29], v[30:31]
    v_pk_add_f32 v[24:25], v[24:25], v[28:29]
    v_add_f32 v24, v24, v25
    s_nop 1
    v_add_f32_dpp v24, v24, v24 quad_perm:[1,0,3,2] row_mask:0xf bank_mask:0xf
    s_nop 1
    v_add_f32_dpp v24, v24, v24 quad_perm:[2,3,0,1] row_mask:0xf bank_mask:0xf
    s_nop 1
    v_add_f32_dpp v24, v24, v24 row_half_mirror row_mask:0xf bank_mask:0xf
    v_mul_f32 v24, 0x3acccccd, v24
    v_cvt_pk_bf16_f32 v24, 0, v24
    v_add_f32 v24, 0x3727c5ac, v24
    v_cvt_pk_bf16_f32 v24, 0, v24
    v_sqrt_f32 v24, v24
    v_mov_b32 v27, s59
    v_cvt_pk_bf16_f32 v26, v32, v24
    s_lshl_b32 s31, s30, 6
    s_add_u32 s31, s31, 4096
    s_lshr_b32 s31, s30, 6
    s_lshl_b32 s31, s31, 12
    s_and_b32 s33, s30, 3
    s_lshl_b32 s33, s33, 10
    s_add_u32 s31, s31, s33
    s_bfe_u32 s33, s30, 0x40002
    s_lshl_b32 s33, s33, 6
    s_add_u32 s31, s31, s33
    s_add_u32 s31, s31, 4096
    s_waitcnt vmcnt(12)
    s_mov_b32 exec_lo, 0x01010101
    s_mov_b32 exec_hi, 0x01010101
    buffer_store_dwordx2 v[26:27], v1, s[64:67], s31 offen sc1
    s_mov_b64 exec, -1
H_NOST:
    v_lshlrev_b32 v11, 4, v1
    s_cmp_ge_u32 s34, 320
    s_cbranch_scc1 H_W2D
    v_lshrrev_b32 v2, 2, v1
    v_mul_u32_u24 v2, 192, v2
    v_add_u32 v2, s32, v2
    v_and_b32 v3, 3, v1
    v_lshl_add_u32 v9, v3, 3, v2
    v_bfe_u32 v3, v1, 1, 1
    v_mul_u32_u24 v3, 6128, v3
    v_add3_u32 v10, v9, v3, 32
    s_add_u32 s12, s4, 0xc00000
    s_addc_u32 s13, s5, 0
    s_mov_b32 s14, 0x3c0000
    s_mov_b32 s15, 0x20000
    s_cmp_ge_u32 s56, 320
    s_cbranch_scc1 H_ONE
    s_waitcnt vmcnt(12)
    ds_read_b64_tr_b16 v[76:77], v9 offset:0
    ds_read_b64_tr_b16 v[78:79], v9 offset:3072
    ds_read_b64_tr_b16 v[80:81], v9 offset:6144
    ds_read_b64_tr_b16 v[82:83], v9 offset:9216
    ds_read_b64_tr_b16 v[84:85], v10 offset:0
    ds_read_b64_tr_b16 v[86:87], v10 offset:3072
    ds_read_b64_tr_b16 v[88:89], v9 offset:48
    ds_read_b64_tr_b16 v[90:91], v9 offset:3120
    ds_read_b64_tr_b16 v[92:93], v9 offset:6192
    ds_read_b64_tr_b16 v[94:95], v9 offset:9264
    ds_read_b64_tr_b16 v[96:97], v10 offset:48
    ds_read_b64_tr_b16 v[98:99], v10 offset:3120
    s_waitcnt lgkmcnt(3)
    ds_read_b64_tr_b16 v[100:101], v9 offset:96
    ds_read_b64_tr_b16 v[102:103], v9 offset:3168
    ds_read_b64_tr_b16 v[104:105], v9 offset:6240
    ds_read_b64_tr_b16 v[106:107], v9 offset:9312
    ds_read_b64_tr_b16 v[108:109], v10 offset:96
    ds_read_b64_tr_b16 v[110:111], v10 offset:3168
    ds_read_b64_tr_b16 v[112:113], v9 offset:144
    ds_read_b64_tr_b16 v[114:115], v9 offset:3216
    ds_read_b64_tr_b16 v[116:117], v9 offset:6288
    ds_read_b64_tr_b16 v[118:119], v9 offset:9360
    ds_read_b64_tr_b16 v[120:121], v10 offset:144
    ds_read_b64_tr_b16 v[122:123], v10 offset:3216
    s_waitcnt lgkmcnt(12)
    buffer_store_dwordx4 v[76:79], v11, s[12:15], s35 offen offset:0 sc1
    buffer_store_dwordx4 v[80:83], v11, s[12:15], s35 offen offset:1024 sc1
    buffer_store_dwordx4 v[84:87], v11, s[12:15], s35 offen offset:2048 sc1
    s_waitcnt lgkmcnt(12)
    buffer_store_dwordx4 v[88:91], v11, s[12:15], s35 offen offset:3072 sc1
    s_add_u32 s35, s35, 4096
    buffer_store_dwordx4 v[92:95], v11, s[12:15], s35 offen offset:0 sc1
    buffer_store_dwordx4 v[96:99], v11, s[12:15], s35 offen offset:1024 sc1
    s_waitcnt lgkmcnt(6)
    buffer_store_dwordx4 v[100:103], v11, s[12:15], s35 offen offset:2048 sc1
    buffer_store_dwordx4 v[104:107], v11, s[12:15], s35 offen offset:3072 sc1
    s_add_u32 s35, s35, 4096
    buffer_store_dwordx4 v[108:111], v11, s[12:15], s35 offen offset:0 sc1
    s_waitcnt lgkmcnt(0)
    buffer_store_dwordx4 v[112:115], v11, s[12:15], s35 offen offset:1024 sc1
    buffer_store_dwordx4 v[116:119], v11, s[12:15], s35 offen offset:2048 sc1
    buffer_store_dwordx4 v[120:123], v11, s[12:15], s35 offen offset:3072 sc1
    s_add_u32 s35, s35, 4096
    v_lshrrev_b32 v2, 2, v1
    v_mul_u32_u24 v2, 192, v2
    v_add_u32 v2, s51, v2
    v_and_b32 v3, 3, v1
    v_lshl_add_u32 v9, v3, 3, v2
    v_bfe_u32 v3, v1, 1, 1
    v_mul_u32_u24 v3, 6128, v3
    v_add3_u32 v10, v9, v3, 32
    s_waitcnt vmcnt(12)
    ds_read_b64_tr_b16 v[24:25], v9 offset:0
    ds_read_b64_tr_b16 v[26:27], v9 offset:3072
    ds_read_b64_tr_b16 v[28:29], v9 offset:6144
    ds_read_b64_tr_b16 v[30:31], v9 offset:9216
    ds_read_b64_tr_b16 v[32:33], v10 offset:0
    ds_read_b64_tr_b16 v[34:35], v10 offset:3072
    ds_read_b64_tr_b16 v[36:37], v9 offset:48
    ds_read_b64_tr_b16 v[38:39], v9 offset:3120
    ds_read_b64_tr_b16 v[40:41], v9 offset:6192
    ds_read_b64_tr_b16 v[42:43], v9 offset:9264
    ds_read_b64_tr_b16 v[44:45], v10 offset:48
    ds_read_b64_tr_b16 v[46:47], v10 offset:3120
    s_waitcnt lgkmcnt(3)
    ds_read_b64_tr_b16 v[48:49], v9 offset:96
    ds_read_b64_tr_b16 v[50:51], v9 offset:3168
    ds_read_b64_tr_b16 v[52:53], v9 offset:6240
    ds_read_b64_tr_b16 v[54:55], v9 offset:9312
    ds_read_b64_tr_b16 v[56:57], v10 offset:96
    ds_read_b64_tr_b16 v[58:59], v10 offset:3168
    ds_read_b64_tr_b16 v[60:61], v9 offset:144
    ds_read_b64_tr_b16 v[62:63], v9 offset:3216
    ds_read_b64_tr_b16 v[64:65], v9 offset:6288
    ds_read_b64_tr_b16 v[66:67], v9 offset:9360
    ds_read_b64_tr_b16 v[68:69], v10 offset:144
    ds_read_b64_tr_b16 v[70:71], v10 offset:3216
    s_waitcnt lgkmcnt(12)
    buffer_store_dwordx4 v[24:27], v11, s[12:15], s57 offen offset:0 sc1
    buffer_store_dwordx4 v[28:31], v11, s[12:15], s57 offen offset:1024 sc1
    buffer_store_dwordx4 v[32:35], v11, s[12:15], s57 offen offset:2048 sc1
    s_waitcnt lgkmcnt(12)
    buffer_store_dwordx4 v[36:39], v11, s[12:15], s57 offen offset:3072 sc1
    s_add_u32 s57, s57, 4096
    buffer_store_dwordx4 v[40:43], v11, s[12:15], s57 offen offset:0 sc1
    buffer_store_dwordx4 v[44:47], v11, s[12:15], s57 offen offset:1024 sc1
    s_waitcnt lgkmcnt(6)
    buffer_store_dwordx4 v[48:51], v11, s[12:15], s57 offen offset:2048 sc1
    buffer_store_dwordx4 v[52:55], v11, s[12:15], s57 offen offset:3072 sc1
    s_add_u32 s57, s57, 4096
    buffer_store_dwordx4 v[56:59], v11, s[12:15], s57 offen offset:0 sc1
    s_waitcnt lgkmcnt(0)
    buffer_store_dwordx4 v[60:63], v11, s[12:15], s57 offen offset:1024 sc1
    buffer_store_dwordx4 v[64:67], v11, s[12:15], s57 offen offset:2048 sc1
    buffer_store_dwordx4 v[68:71], v11, s[12:15], s57 offen offset:3072 sc1
    s_add_u32 s57, s57, 4096
    s_lshl_b32 s34, s34, 6
    s_add_u32 s34, s34, 32768
    s_waitcnt vmcnt(12)
    v_lshlrev_b32 v2, 4, v1
    v_mov_b32 v244, s59
    v_mov_b32 v245, s59
    v_mov_b32 v246, s59
    v_mov_b32 v247, s59
    s_mov_b64 exec, 15
    buffer_store_dwordx4 v[244:247], v2, s[64:67], s34 offen sc1
    s_mov_b64 exec, -1
    s_mov_b32 s34, s56
    s_branch H_FIN
H_ONE:
    s_waitcnt vmcnt(0)
    ds_read_b64_tr_b16 v[24:25], v9 offset:0
    ds_read_b64_tr_b16 v[26:27], v9 offset:3072
    ds_read_b64_tr_b16 v[28:29], v9 offset:6144
    ds_read_b64_tr_b16 v[30:31], v9 offset:9216
    ds_read_b64_tr_b16 v[32:33], v10 offset:0
    ds_read_b64_tr_b16 v[34:35], v10 offset:3072
    ds_read_b64_tr_b16 v[36:37], v9 offset:48
    ds_read_b64_tr_b16 v[38:39], v9 offset:3120
    ds_read_b64_tr_b16 v[40:41], v9 offset:6192
    ds_read_b64_tr_b16 v[42:43], v9 offset:9264
    ds_read_b64_tr_b16 v[44:45], v10 offset:48
    ds_read_b64_tr_b16 v[46:47], v10 offset:3120
    s_waitcnt lgkmcnt(3)
    ds_read_b64_tr_b16 v[48:49], v9 offset:96
    ds_read_b64_tr_b16 v[50:51], v9 offset:3168
    ds_read_b64_tr_b16 v[52:53], v9 offset:6240
    ds_read_b64_tr_b16 v[54:55], v9 offset:9312
    ds_read_b64_tr_b16 v[56:57], v10 offset:96
    ds_read_b64_tr_b16 v[58:59], v10 offset:3168
    ds_read_b64_tr_b16 v[60:61], v9 offset:144
    ds_read_b64_tr_b16 v[62:63], v9 offset:3216
    ds_read_b64_tr_b16 v[64:65], v9 offset:6288
    ds_read_b64_tr_b16 v[66:67], v9 offset:9360
    ds_read_b64_tr_b16 v[68:69], v10 offset:144
    ds_read_b64_tr_b16 v[70:71], v10 offset:3216
    s_waitcnt lgkmcnt(12)
    buffer_store_dwordx4 v[24:27], v11, s[12:15], s35 offen offset:0 sc1
    buffer_store_dwordx4 v[28:31], v11, s[12:15], s35 offen offset:1024 sc1
    buffer_store_dwordx4 v[32:35], v11, s[12:15], s35 offen offset:2048 sc1
    s_waitcnt lgkmcnt(12)
    buffer_store_dwordx4 v[36:39], v11, s[12:15], s35 offen offset:3072 sc1
    s_add_u32 s35, s35, 4096
    buffer_store_dwordx4 v[40:43], v11, s[12:15], s35 offen offset:0 sc1
    buffer_store_dwordx4 v[44:47], v11, s[12:15], s35 offen offset:1024 sc1
    s_waitcnt lgkmcnt(6)
    buffer_store_dwordx4 v[48:51], v11, s[12:15], s35 offen offset:2048 sc1
    buffer_store_dwordx4 v[52:55], v11, s[12:15], s35 offen offset:3072 sc1
    s_add_u32 s35, s35, 4096
    buffer_store_dwordx4 v[56:59], v11, s[12:15], s35 offen offset:0 sc1
    s_waitcnt lgkmcnt(0)
    buffer_store_dwordx4 v[60:63], v11, s[12:15], s35 offen offset:1024 sc1
    buffer_store_dwordx4 v[64:67], v11, s[12:15], s35 offen offset:2048 sc1
    buffer_store_dwordx4 v[68:71], v11, s[12:15], s35 offen offset:3072 sc1
    s_add_u32 s35, s35, 4096
H_FIN:
    s_lshl_b32 s34, s34, 6
    s_add_u32 s34, s34, 32768
    s_waitcnt vmcnt(0)
    v_lshlrev_b32 v2, 4, v1
    v_mov_b32 v244, s59
    v_mov_b32 v245, s59
    v_mov_b32 v246, s59
    v_mov_b32 v247, s59
    s_mov_b64 exec, 15
    buffer_store_dwordx4 v[244:247], v2, s[64:67], s34 offen sc1
    s_mov_b64 exec, -1
H_W2B:
    s_cmp_ge_u32 s46, 128
    s_cbranch_scc1 H_J2
    s_mov_b32 s52, s44
    s_mov_b32 s53, s45
    s_mov_b32 s54, 0x1e0000
    s_mov_b32 s55, 0x20000
    s_lshr_b32 s48, s46, 3
    s_and_b32 s47, s46, 7
    s_mul_i32 s49, s48, 122880
    s_mul_i32 s50, s47, 160
    s_add_u32 s49, s49, s50
    s_mul_i32 s51, s28, 15360
    s_add_u32 s51, s51, 87296
    s_mul_i32 s50, s28, 30560
    s_add_u32 s49, s49, s50
    v_add_u32 v2, 0, v1
    v_mul_u32_u24 v3, 1639, v2
    v_lshrrev_b32 v3, 16, v3
    v_mul_u32_u24 v3, 640, v3
    v_lshl_add_u32 v12, v2, 4, v3
    v_add_u32 v2, 64, v1
    v_mul_u32_u24 v3, 1639, v2
    v_lshrrev_b32 v3, 16, v3
    v_mul_u32_u24 v3, 640, v3
    v_lshl_add_u32 v13, v2, 4, v3
    v_add_u32 v2, 128, v1
    v_mul_u32_u24 v3, 1639, v2
    v_lshrrev_b32 v3, 16, v3
    v_mul_u32_u24 v3, 640, v3
    v_lshl_add_u32 v14, v2, 4, v3
    v_add_u32 v2, 192, v1
    v_mul_u32_u24 v3, 1639, v2
    v_lshrrev_b32 v3, 16, v3
    v_mul_u32_u24 v3, 640, v3
    v_lshl_add_u32 v15, v2, 4, v3
    v_add_u32 v2, 256, v1
    v_mul_u32_u24 v3, 1639, v2
    v_lshrrev_b32 v3, 16, v3
    v_mul_u32_u24 v3, 640, v3
    v_lshl_add_u32 v16, v2, 4, v3
    s_add_u32 m0, s51, 0
    s_nop 0
    buffer_load_dwordx4 v12, s[52:55], s49 offen nt lds
    s_add_u32 m0, s51, 1024
    s_nop 0
    buffer_load_dwordx4 v13, s[52:55], s49 offen nt lds
    s_add_u32 m0, s51, 2048
    s_nop 0
    buffer_load_dwordx4 v14, s[52:55], s49 offen nt lds
    s_add_u32 m0, s51, 3072
    s_nop 0
    buffer_load_dwordx4 v15, s[52:55], s49 offen nt lds
    s_add_u32 m0, s51, 4096
    s_nop 0
    buffer_load_dwordx4 v16, s[52:55], s49 offen nt lds
    s_add_u32 s49, s49, 10240
    s_add_u32 m0, s51, 5120
    s_nop 0
    buffer_load_dwordx4 v12, s[52:55], s49 offen nt lds
    s_add_u32 m0, s51, 6144
    s_nop 0
    buffer_load_dwordx4 v13, s[52:55], s49 offen nt lds
    s_add_u32 m0, s51, 7168
    s_nop 0
    buffer_load_dwordx4 v14, s[52:55], s49 offen nt lds
    s_add_u32 m0, s51, 8192
    s_nop 0
    buffer_load_dwordx4 v15, s[52:55], s49 offen nt lds
    s_add_u32 m0, s51, 9216
    s_nop 0
    buffer_load_dwordx4 v16, s[52:55], s49 offen nt lds
    s_add_u32 s49, s49, 10240
    s_add_u32 m0, s51, 10240
    s_nop 0
    buffer_load_dwordx4 v12, s[52:55], s49 offen nt lds
    s_add_u32 m0, s51, 11264
    s_nop 0
    buffer_load_dwordx4 v13, s[52:55], s49 offen nt lds
    s_add_u32 m0, s51, 12288
    s_nop 0
    buffer_load_dwordx4 v14, s[52:55], s49 offen nt lds
    s_add_u32 m0, s51, 13312
    s_nop 0
    buffer_load_dwordx4 v15, s[52:55], s49 offen nt lds
    s_add_u32 m0, s51, 14336
    s_nop 0
    buffer_load_dwordx4 v16, s[52:55], s49 offen nt lds
    s_add_u32 s49, s49, 10240
    s_branch H_W2C
H_W2D:
    s_mov_b32 s52, s44
    s_mov_b32 s53, s45
    s_mov_b32 s54, 0x1e0000
    s_mov_b32 s55, 0x20000
    s_lshr_b32 s48, s46, 3
    s_and_b32 s47, s46, 7
    s_mul_i32 s49, s48, 122880
    s_mul_i32 s50, s47, 160
    s_add_u32 s49, s49, s50
    s_mul_i32 s51, s28, 15360
    s_add_u32 s51, s51, 87296
    s_mul_i32 s50, s28, 30560
    s_add_u32 s49, s49, s50
    v_add_u32 v2, 0, v1
    v_mul_u32_u24 v3, 1639, v2
    v_lshrrev_b32 v3, 16, v3
    v_mul_u32_u24 v3, 640, v3
    v_lshl_add_u32 v12, v2, 4, v3
    v_add_u32 v2, 64, v1
    v_mul_u32_u24 v3, 1639, v2
    v_lshrrev_b32 v3, 16, v3
    v_mul_u32_u24 v3, 640, v3
    v_lshl_add_u32 v13, v2, 4, v3
    v_add_u32 v2, 128, v1
    v_mul_u32_u24 v3, 1639, v2
    v_lshrrev_b32 v3, 16, v3
    v_mul_u32_u24 v3, 640, v3
    v_lshl_add_u32 v14, v2, 4, v3
    v_add_u32 v2, 192, v1
    v_mul_u32_u24 v3, 1639, v2
    v_lshrrev_b32 v3, 16, v3
    v_mul_u32_u24 v3, 640, v3
    v_lshl_add_u32 v15, v2, 4, v3
    v_add_u32 v2, 256, v1
    v_mul_u32_u24 v3, 1639, v2
    v_lshrrev_b32 v3, 16, v3
    v_mul_u32_u24 v3, 640, v3
    v_lshl_add_u32 v16, v2, 4, v3
    s_add_u32 m0, s51, 0
    s_nop 0
    buffer_load_dwordx4 v12, s[52:55], s49 offen nt lds
    s_add_u32 m0, s51, 1024
    s_nop 0
    buffer_load_dwordx4 v13, s[52:55], s49 offen nt lds
    s_add_u32 m0, s51, 2048
    s_nop 0
    buffer_load_dwordx4 v14, s[52:55], s49 offen nt lds
    s_add_u32 m0, s51, 3072
    s_nop 0
    buffer_load_dwordx4 v15, s[52:55], s49 offen nt lds
    s_add_u32 m0, s51, 4096
    s_nop 0
    buffer_load_dwordx4 v16, s[52:55], s49 offen nt lds
    s_add_u32 s49, s49, 10240
    s_add_u32 m0, s51, 5120
    s_nop 0
    buffer_load_dwordx4 v12, s[52:55], s49 offen nt lds
    s_add_u32 m0, s51, 6144
    s_nop 0
    buffer_load_dwordx4 v13, s[52:55], s49 offen nt lds
    s_add_u32 m0, s51, 7168
    s_nop 0
    buffer_load_dwordx4 v14, s[52:55], s49 offen nt lds
    s_add_u32 m0, s51, 8192
    s_nop 0
    buffer_load_dwordx4 v15, s[52:55], s49 offen nt lds
    s_add_u32 m0, s51, 9216
    s_nop 0
    buffer_load_dwordx4 v16, s[52:55], s49 offen nt lds
    s_add_u32 s49, s49, 10240
    s_add_u32 m0, s51, 10240
    s_nop 0
    buffer_load_dwordx4 v12, s[52:55], s49 offen nt lds
    s_add_u32 m0, s51, 11264
    s_nop 0
    buffer_load_dwordx4 v13, s[52:55], s49 offen nt lds
    s_add_u32 m0, s51, 12288
    s_nop 0
    buffer_load_dwordx4 v14, s[52:55], s49 offen nt lds
    s_add_u32 m0, s51, 13312
    s_nop 0
    buffer_load_dwordx4 v15, s[52:55], s49 offen nt lds
    s_add_u32 m0, s51, 14336
    s_nop 0
    buffer_load_dwordx4 v16, s[52:55], s49 offen nt lds
    s_add_u32 s49, s49, 10240
H_W2C:
    s_mul_i32 s35, s47, 245760
    s_mul_i32 s36, s48, 15360
    s_add_u32 s35, s35, s36
    s_add_u32 s12, s4, 0x1000000
    s_addc_u32 s13, s5, 0
    s_mov_b32 s14, 0x1e0000
    s_mov_b32 s15, 0x20000
    v_lshrrev_b32 v2, 4, v1
    v_lshlrev_b32 v2, 3, v2
    v_bfe_u32 v3, v1, 2, 2
    v_and_b32 v4, 3, v1
    v_lshlrev_b32 v4, 3, v4
    s_movk_i32 s33, 160
    s_movk_i32 s33, 640
    s_mul_i32 s51, s28, 160
    s_add_u32 s51, s51, 87296
    s_mov_b32 s36, 0x18100400
    v_bfe_u32 v5, s36, v2, 8
    v_add_u32 v5, v5, v3
    v_mad_u32_u24 v5, v5, s33, v4
    v_add_u32 v13, s51, v5
    v_add_u32 v12, v13, v4
    s_mov_b32 s36, 0x20140c08
    v_bfe_u32 v5, s36, v2, 8
    v_add_u32 v5, v5, v3
    v_mad_u32_u24 v5, v5, s33, v4
    v_add_u32 v15, s51, v5
    v_add_u32 v14, v15, v4
    s_mov_b32 s36, 0x3430281c
    v_bfe_u32 v5, s36, v2, 8
    v_add_u32 v5, v5, v3
    v_mad_u32_u24 v5, v5, s33, v4
    v_add_u32 v17, s51, v5
    v_add_u32 v16, v17, v4
    s_mov_b32 s36, 0x3c382c24
    v_bfe_u32 v5, s36, v2, 8
    v_add_u32 v5, v5, v3
    v_mad_u32_u24 v5, v5, s33, v4
    v_add_u32 v19, s51, v5
    v_add_u32 v18, v19, v4
    s_mov_b32 s36, 0x584c4840
    v_bfe_u32 v5, s36, v2, 8
    v_add_u32 v5, v5, v3
    v_mad_u32_u24 v5, v5, s33, v4
    v_add_u32 v21, s51, v5
    v_add_u32 v20, v21, v4
    s_mov_b32 s36, 0x5c545044
    v_bfe_u32 v5, s36, v2, 8
    v_add_u32 v5, v5, v3
    v_mad_u32_u24 v5, v5, s33, v4
    v_add_u32 v23, s51, v5
    v_add_u32 v22, v23, v4
    s_waitcnt vmcnt(0)
    s_barrier
    ds_read_b64_tr_b16 v[24:25], v12 offset:0
    ds_read_b64_tr_b16 v[26:27], v14 offset:0
    ds_read_b64_tr_b16 v[28:29], v12 offset:8
    ds_read_b64_tr_b16 v[30:31], v14 offset:8
    ds_read_b64_tr_b16 v[32:33], v12 offset:64
    ds_read_b64_tr_b16 v[34:35], v14 offset:64
    ds_read_b64_tr_b16 v[36:37], v12 offset:72
    ds_read_b64_tr_b16 v[38:39], v14 offset:72
    ds_read_b64_tr_b16 v[40:41], v13 offset:128
    ds_read_b64_tr_b16 v[42:43], v15 offset:128
    s_waitcnt lgkmcnt(0)
    buffer_store_dwordx4 v[24:27], v11, s[12:15], s35 offen offset:0 sc1
    buffer_store_dwordx4 v[28:31], v11, s[12:15], s35 offen offset:1024 sc1
    buffer_store_dwordx4 v[32:35], v11, s[12:15], s35 offen offset:2048 sc1
    buffer_store_dwordx4 v[36:39], v11, s[12:15], s35 offen offset:3072 sc1
    s_add_u32 s35, s35, 4096
    buffer_store_dwordx4 v[40:43], v11, s[12:15], s35 offen offset:0 sc1
    ds_read_b64_tr_b16 v[44:45], v16 offset:0
    ds_read_b64_tr_b16 v[46:47], v18 offset:0
    ds_read_b64_tr_b16 v[48:49], v16 offset:8
    ds_read_b64_tr_b16 v[50:51], v18 offset:8
    ds_read_b64_tr_b16 v[52:53], v16 offset:64
    ds_read_b64_tr_b16 v[54:55], v18 offset:64
    ds_read_b64_tr_b16 v[56:57], v16 offset:72
    ds_read_b64_tr_b16 v[58:59], v18 offset:72
    ds_read_b64_tr_b16 v[60:61], v17 offset:128
    ds_read_b64_tr_b16 v[62:63], v19 offset:128
    s_waitcnt lgkmcnt(0)
    buffer_store_dwordx4 v[44:47], v11, s[12:15], s35 offen offset:1024 sc1
    buffer_store_dwordx4 v[48:51], v11, s[12:15], s35 offen offset:2048 sc1
    buffer_store_dwordx4 v[52:55], v11, s[12:15], s35 offen offset:3072 sc1
    s_add_u32 s35, s35, 4096
    buffer_store_dwordx4 v[56:59], v11, s[12:15], s35 offen offset:0 sc1
    buffer_store_dwordx4 v[60:63], v11, s[12:15], s35 offen offset:1024 sc1
    ds_read_b64_tr_b16 v[64:65], v20 offset:0
    ds_read_b64_tr_b16 v[66:67], v22 offset:0
    ds_read_b64_tr_b16 v[68:69], v20 offset:8
    ds_read_b64_tr_b16 v[70:71], v22 offset:8
    ds_read_b64_tr_b16 v[72:73], v20 offset:64
    ds_read_b64_tr_b16 v[74:75], v22 offset:64
    ds_read_b64_tr_b16 v[76:77], v20 offset:72
    ds_read_b64_tr_b16 v[78:79], v22 offset:72
    ds_read_b64_tr_b16 v[80:81], v21 offset:128
    ds_read_b64_tr_b16 v[82:83], v23 offset:128
    s_waitcnt lgkmcnt(0)
    buffer_store_dwordx4 v[64:67], v11, s[12:15], s35 offen offset:2048 sc1
    buffer_store_dwordx4 v[68:71], v11, s[12:15], s35 offen offset:3072 sc1
    s_add_u32 s35, s35, 4096
    buffer_store_dwordx4 v[72:75], v11, s[12:15], s35 offen offset:0 sc1
    buffer_store_dwordx4 v[76:79], v11, s[12:15], s35 offen offset:1024 sc1
    buffer_store_dwordx4 v[80:83], v11, s[12:15], s35 offen offset:2048 sc1
    s_add_u32 s12, s4, 0xc00000
    s_addc_u32 s13, s5, 0
    s_mov_b32 s14, 0x3c0000
    s_mov_b32 s15, 0x20000
    s_mul_i32 s57, s61, 245760
    s_mul_i32 s31, s28, 3072
    s_add_u32 s57, s57, s31
    s_add_u32 s56, s57, 245760
    s_mul_i32 s39, s3, 12288
    s_add_u32 s39, s39, s57
    v_min_u32 v22, 19, v1
    v_add_u32 v22, s3, v22
    v_subrev_u32 v9, 20, v22
    v_min_u32 v22, v22, v9
    v_lshlrev_b32 v22, 10, v22
    s_lshl_b32 s31, s61, 6
    s_add_u32 s31, s31, 32768
    v_add_u32 v22, s31, v22
    v_lshlrev_b32 v9, 4, v1
    buffer_load_dword v23, v22, s[64:67], 0 offen sc1
    s_lshl_b32 s34, s46, 6
    s_add_u32 s34, s34, 53248
    s_barrier
    s_waitcnt vmcnt(0)
    v_lshlrev_b32 v2, 4, v1
    v_mov_b32 v244, s59
    v_mov_b32 v245, s59
    v_mov_b32 v246, s59
    v_mov_b32 v247, s59
    s_mov_b64 exec, 15
    buffer_store_dwordx4 v[244:247], v2, s[64:67], s34 offen sc1
    s_mov_b64 exec, -1
    s_mov_b32 s70, 0xfffff
    s_movk_i32 s58, 0x7fff
    s_mov_b32 s71, 0
    s_mov_b64 exec, s[70:71]
    s_branch W_L1
    s_lshl_b32 s34, s46, 6
    s_add_u32 s34, s34, 53248
    s_waitcnt vmcnt(0)
    v_lshlrev_b32 v2, 4, v1
    v_mov_b32 v244, s59
    v_mov_b32 v245, s59
    v_mov_b32 v246, s59
    v_mov_b32 v247, s59
    s_mov_b64 exec, 15
    buffer_store_dwordx4 v[244:247], v2, s[64:67], s34 offen sc1
    s_mov_b64 exec, -1
H_J2:
    s_add_u32 s12, s4, 0xc00000
    s_addc_u32 s13, s5, 0
    s_mov_b32 s14, 0x3c0000
    s_mov_b32 s15, 0x20000
    s_mul_i32 s57, s61, 245760
    s_mul_i32 s31, s28, 3072
    s_add_u32 s57, s57, s31
    s_add_u32 s56, s57, 245760
    s_mul_i32 s39, s3, 12288
    s_add_u32 s39, s39, s57
    v_min_u32 v22, 19, v1
    v_add_u32 v22, s3, v22
    v_subrev_u32 v9, 20, v22
    v_min_u32 v22, v22, v9
    v_lshlrev_b32 v22, 10, v22
    s_lshl_b32 s31, s61, 6
    s_add_u32 s31, s31, 32768
    v_add_u32 v22, s31, v22
    v_lshlrev_b32 v9, 4, v1
    s_barrier
P_WALL:
    s_mov_b32 s70, 0xfffff
W_L0:
    s_movk_i32 s58, 0x7fff
    s_mov_b32 s71, 0
W_L:
    s_mov_b64 exec, s[70:71]
    buffer_load_dword v23, v22, s[64:67], 0 offen sc1
    s_mul_i32 s39, s3, 12288
    s_add_u32 s39, s39, s57
    s_waitcnt vmcnt(0)
W_L1:
    v_cmp_eq_u32 vcc, s59, v23
    s_mov_b64 exec, -1
    s_cbranch_vccz W_N
    s_andn2_b32 s70, s70, vcc_lo
    s_bitcmp1_b32 vcc_lo, 0
    s_cbranch_scc0 W_S0
    buffer_load_dwordx4 a[0:3], v9, s[12:15], s39 offen offset:0 sc1
    buffer_load_dwordx4 a[4:7], v9, s[12:15], s39 offen offset:1024 sc1
    buffer_load_dwordx4 a[8:11], v9, s[12:15], s39 offen offset:2048 sc1
W_S0:
    s_add_u32 s39, s39, 12288
    s_cmp_eq_u32 s39, s56
    s_cselect_b32 s39, s57, s39
    s_bitcmp1_b32 vcc_lo, 1
    s_cbranch_scc0 W_S1
    buffer_load_dwordx4 a[12:15], v9, s[12:15], s39 offen offset:0 sc1
    buffer_load_dwordx4 a[16:19], v9, s[12:15], s39 offen offset:1024 sc1
    buffer_load_dwordx4 a[20:23], v9, s[12:15], s39 offen offset:2048 sc1
W_S1:
    s_add_u32 s39, s39, 12288
    s_cmp_eq_u32 s39, s56
    s_cselect_b32 s39, s57, s39
    s_bitcmp1_b32 vcc_lo, 2
    s_cbranch_scc0 W_S2
    buffer_load_dwordx4 a[24:27], v9, s[12:15], s39 offen offset:0 sc1
    buffer_load_dwordx4 a[28:31], v9, s[12:15], s39 offen offset:1024 sc1
    buffer_load_dwordx4 a[32:35], v9, s[12:15], s39 offen offset:2048 sc1
W_S2:
    s_add_u32 s39, s39, 12288
    s_cmp_eq_u32 s39, s56
    s_cselect_b32 s39, s57, s39
    s_bitcmp1_b32 vcc_lo, 3
    s_cbranch_scc0 W_S3
    buffer_load_dwordx4 a[36:39], v9, s[12:15], s39 offen offset:0 sc1
    buffer_load_dwordx4 a[40:43], v9, s[12:15], s39 offen offset:1024 sc1
    buffer_load_dwordx4 a[44:47], v9, s[12:15], s39 offen offset:2048 sc1
W_S3:
    s_add_u32 s39, s39, 12288
    s_cmp_eq_u32 s39, s56
    s_cselect_b32 s39, s57, s39
    s_bitcmp1_b32 vcc_lo, 4
    s_cbranch_scc0 W_S4
    buffer_load_dwordx4 a[48:51], v9, s[12:15], s39 offen offset:0 sc1
    buffer_load_dwordx4 a[52:55], v9, s[12:15], s39 offen offset:1024 sc1
    buffer_load_dwordx4 a[56:59], v9, s[12:15], s39 offen offset:2048 sc1
W_S4:
    s_add_u32 s39, s39, 12288
    s_cmp_eq_u32 s39, s56
    s_cselect_b32 s39, s57, s39
    s_bitcmp1_b32 vcc_lo, 5
    s_cbranch_scc0 W_S5
    buffer_load_dwordx4 a[60:63], v9, s[12:15], s39 offen offset:0 sc1
    buffer_load_dwordx4 a[64:67], v9, s[12:15], s39 offen offset:1024 sc1
    buffer_load_dwordx4 a[68:71], v9, s[12:15], s39 offen offset:2048 sc1
W_S5:
    s_add_u32 s39, s39, 12288
    s_cmp_eq_u32 s39, s56
    s_cselect_b32 s39, s57, s39
    s_bitcmp1_b32 vcc_lo, 6
    s_cbranch_scc0 W_S6
    buffer_load_dwordx4 a[72:75], v9, s[12:15], s39 offen offset:0 sc1
    buffer_load_dwordx4 a[76:79], v9, s[12:15], s39 offen offset:1024 sc1
    buffer_load_dwordx4 a[80:83], v9, s[12:15], s39 offen offset:2048 sc1
W_S6:
    s_add_u32 s39, s39, 12288
    s_cmp_eq_u32 s39, s56
    s_cselect_b32 s39, s57, s39
    s_bitcmp1_b32 vcc_lo, 7
    s_cbranch_scc0 W_S7
    buffer_load_dwordx4 a[84:87], v9, s[12:15], s39 offen offset:0 sc1
    buffer_load_dwordx4 a[88:91], v9, s[12:15], s39 offen offset:1024 sc1
    buffer_load_dwordx4 a[92:95], v9, s[12:15], s39 offen offset:2048 sc1
W_S7:
    s_add_u32 s39, s39, 12288
    s_cmp_eq_u32 s39, s56
    s_cselect_b32 s39, s57, s39
    s_bitcmp1_b32 vcc_lo, 8
    s_cbranch_scc0 W_S8
    buffer_load_dwordx4 a[96:99], v9, s[12:15], s39 offen offset:0 sc1
    buffer_load_dwordx4 a[100:103], v9, s[12:15], s39 offen offset:1024 sc1
    buffer_load_dwordx4 a[104:107], v9, s[12:15], s39 offen offset:2048 sc1
W_S8:
    s_add_u32 s39, s39, 12288
    s_cmp_eq_u32 s39, s56
    s_cselect_b32 s39, s57, s39
    s_bitcmp1_b32 vcc_lo, 9
    s_cbranch_scc0 W_S9
    buffer_load_dwordx4 a[108:111], v9, s[12:15], s39 offen offset:0 sc1
    buffer_load_dwordx4 a[112:115], v9, s[12:15], s39 offen offset:1024 sc1
    buffer_load_dwordx4 a[116:119], v9, s[12:15], s39 offen offset:2048 sc1
W_S9:
    s_add_u32 s39, s39, 12288
    s_cmp_eq_u32 s39, s56
    s_cselect_b32 s39, s57, s39
    s_bitcmp1_b32 vcc_lo, 10
    s_cbranch_scc0 W_S10
    buffer_load_dwordx4 a[120:123], v9, s[12:15], s39 offen offset:0 sc1
    buffer_load_dwordx4 a[124:127], v9, s[12:15], s39 offen offset:1024 sc1
    buffer_load_dwordx4 a[128:131], v9, s[12:15], s39 offen offset:2048 sc1
W_S10:
    s_add_u32 s39, s39, 12288
    s_cmp_eq_u32 s39, s56
    s_cselect_b32 s39, s57, s39
    s_bitcmp1_b32 vcc_lo, 11
    s_cbranch_scc0 W_S11
    buffer_load_dwordx4 a[132:135], v9, s[12:15], s39 offen offset:0 sc1
    buffer_load_dwordx4 a[136:139], v9, s[12:15], s39 offen offset:1024 sc1
    buffer_load_dwordx4 a[140:143], v9, s[12:15], s39 offen offset:2048 sc1
W_S11:
    s_add_u32 s39, s39, 12288
    s_cmp_eq_u32 s39, s56
    s_cselect_b32 s39, s57, s39
    s_bitcmp1_b32 vcc_lo, 12
    s_cbranch_scc0 W_S12
    buffer_load_dwordx4 a[144:147], v9, s[12:15], s39 offen offset:0 sc1
    buffer_load_dwordx4 a[148:151], v9, s[12:15], s39 offen offset:1024 sc1
    buffer_load_dwordx4 a[152:155], v9, s[12:15], s39 offen offset:2048 sc1
W_S12:
    s_add_u32 s39, s39, 12288
    s_cmp_eq_u32 s39, s56
    s_cselect_b32 s39, s57, s39
    s_bitcmp1_b32 vcc_lo, 13
    s_cbranch_scc0 W_S13
    buffer_load_dwordx4 a[156:159], v9, s[12:15], s39 offen offset:0 sc1
    buffer_load_dwordx4 a[160:163], v9, s[12:15], s39 offen offset:1024 sc1
    buffer_load_dwordx4 a[164:167], v9, s[12:15], s39 offen offset:2048 sc1
W_S13:
    s_add_u32 s39, s39, 12288
    s_cmp_eq_u32 s39, s56
    s_cselect_b32 s39, s57, s39
    s_bitcmp1_b32 vcc_lo, 14
    s_cbranch_scc0 W_S14
    buffer_load_dwordx4 a[168:171], v9, s[12:15], s39 offen offset:0 sc1
    buffer_load_dwordx4 a[172:175], v9, s[12:15], s39 offen offset:1024 sc1
    buffer_load_dwordx4 a[176:179], v9, s[12:15], s39 offen offset:2048 sc1
W_S14:
    s_add_u32 s39, s39, 12288
    s_cmp_eq_u32 s39, s56
    s_cselect_b32 s39, s57, s39
    s_bitcmp1_b32 vcc_lo, 15
    s_cbranch_scc0 W_S15
    buffer_load_dwordx4 a[180:183], v9, s[12:15], s39 offen offset:0 sc1
    buffer_load_dwordx4 a[184:187], v9, s[12:15], s39 offen offset:1024 sc1
    buffer_load_dwordx4 a[188:191], v9, s[12:15], s39 offen offset:2048 sc1
W_S15:
    s_add_u32 s39, s39, 12288
    s_cmp_eq_u32 s39, s56
    s_cselect_b32 s39, s57, s39
    s_bitcmp1_b32 vcc_lo, 16
    s_cbranch_scc0 W_S16
    buffer_load_dwordx4 a[192:195], v9, s[12:15], s39 offen offset:0 sc1
    buffer_load_dwordx4 a[196:199], v9, s[12:15], s39 offen offset:1024 sc1
    buffer_load_dwordx4 a[200:203], v9, s[12:15], s39 offen offset:2048 sc1
W_S16:
    s_add_u32 s39, s39, 12288
    s_cmp_eq_u32 s39, s56
    s_cselect_b32 s39, s57, s39
    s_bitcmp1_b32 vcc_lo, 17
    s_cbranch_scc0 W_S17
    buffer_load_dwordx4 a[204:207], v9, s[12:15], s39 offen offset:0 sc1
    buffer_load_dwordx4 a[208:211], v9, s[12:15], s39 offen offset:1024 sc1
    buffer_load_dwordx4 a[212:215], v9, s[12:15], s39 offen offset:2048 sc1
W_S17:
    s_add_u32 s39, s39, 12288
    s_cmp_eq_u32 s39, s56
    s_cselect_b32 s39, s57, s39
    s_bitcmp1_b32 vcc_lo, 18
    s_cbranch_scc0 W_S18
    buffer_load_dwordx4 a[216:219], v9, s[12:15], s39 offen offset:0 sc1
    buffer_load_dwordx4 a[220:223], v9, s[12:15], s39 offen offset:1024 sc1
    buffer_load_dwordx4 a[224:227], v9, s[12:15], s39 offen offset:2048 sc1
W_S18:
    s_add_u32 s39, s39, 12288
    s_cmp_eq_u32 s39, s56
    s_cselect_b32 s39, s57, s39
    s_bitcmp1_b32 vcc_lo, 19
    s_cbranch_scc0 W_S19
    buffer_load_dwordx4 a[228:231], v9, s[12:15], s39 offen offset:0 sc1
    buffer_load_dwordx4 a[232:235], v9, s[12:15], s39 offen offset:1024 sc1
    buffer_load_dwordx4 a[236:239], v9, s[12:15], s39 offen offset:2048 sc1
W_S19:
    s_add_u32 s39, s39, 12288
    s_cmp_eq_u32 s39, s56
    s_cselect_b32 s39, s57, s39
    s_cmp_eq_u32 s70, 0
    s_cbranch_scc1 P_MID2
W_N:
    s_sub_u32 s58, s58, 1
    s_cbranch_scc0 W_L
    s_branch P_MID2
P_WL2:
    s_waitcnt vmcnt(0)
P_MID:
    buffer_load_dwordx4 a[156:159], v9, s[12:15], s39 offen offset:0 sc1
    buffer_load_dwordx4 a[160:163], v9, s[12:15], s39 offen offset:1024 sc1
    buffer_load_dwordx4 a[164:167], v9, s[12:15], s39 offen offset:2048 sc1
    s_add_u32 s39, s39, 12288
    s_cmp_eq_u32 s39, s56
    s_cselect_b32 s39, s57, s39
    buffer_load_dwordx4 a[168:171], v9, s[12:15], s39 offen offset:0 sc1
    buffer_load_dwordx4 a[172:175], v9, s[12:15], s39 offen offset:1024 sc1
    buffer_load_dwordx4 a[176:179], v9, s[12:15], s39 offen offset:2048 sc1
    s_add_u32 s39, s39, 12288
    s_cmp_eq_u32 s39, s56
    s_cselect_b32 s39, s57, s39
    buffer_load_dwordx4 a[180:183], v9, s[12:15], s39 offen offset:0 sc1
    buffer_load_dwordx4 a[184:187], v9, s[12:15], s39 offen offset:1024 sc1
    buffer_load_dwordx4 a[188:191], v9, s[12:15], s39 offen offset:2048 sc1
    s_add_u32 s39, s39, 12288
    s_cmp_eq_u32 s39, s56
    s_cselect_b32 s39, s57, s39
    buffer_load_dwordx4 a[192:195], v9, s[12:15], s39 offen offset:0 sc1
    buffer_load_dwordx4 a[196:199], v9, s[12:15], s39 offen offset:1024 sc1
    buffer_load_dwordx4 a[200:203], v9, s[12:15], s39 offen offset:2048 sc1
    s_add_u32 s39, s39, 12288
    s_cmp_eq_u32 s39, s56
    s_cselect_b32 s39, s57, s39
    buffer_load_dwordx4 a[204:207], v9, s[12:15], s39 offen offset:0 sc1
    buffer_load_dwordx4 a[208:211], v9, s[12:15], s39 offen offset:1024 sc1
    buffer_load_dwordx4 a[212:215], v9, s[12:15], s39 offen offset:2048 sc1
    s_add_u32 s39, s39, 12288
    s_cmp_eq_u32 s39, s56
    s_cselect_b32 s39, s57, s39
    buffer_load_dwordx4 a[216:219], v9, s[12:15], s39 offen offset:0 sc1
    buffer_load_dwordx4 a[220:223], v9, s[12:15], s39 offen offset:1024 sc1
    buffer_load_dwordx4 a[224:227], v9, s[12:15], s39 offen offset:2048 sc1
    s_add_u32 s39, s39, 12288
    s_cmp_eq_u32 s39, s56
    s_cselect_b32 s39, s57, s39
    buffer_load_dwordx4 a[228:231], v9, s[12:15], s39 offen offset:0 sc1
    buffer_load_dwordx4 a[232:235], v9, s[12:15], s39 offen offset:1024 sc1
    buffer_load_dwordx4 a[236:239], v9, s[12:15], s39 offen offset:2048 sc1
    s_add_u32 s39, s39, 12288
    s_cmp_eq_u32 s39, s56
    s_cselect_b32 s39, s57, s39
P_MID2:
    s_add_u32 s8, s4, 0x900000
    s_addc_u32 s9, s5, 0
    s_mov_b32 s10, 0x280000
    s_mov_b32 s11, 0x20000
    s_add_u32 s16, s4, 0x1300000
    s_addc_u32 s17, s5, 0
    s_mov_b32 s18, 0x730000
    s_mov_b32 s19, 0x20000
    v_lshrrev_b32 v2, 4, v1
    v_and_b32 v3, 15, v1
    v_lshlrev_b32 v4, 1, v2
    v_xor_b32 v4, v3, v4
    v_lshlrev_b32 v4, 4, v4
    v_lshl_add_u32 v11, v2, 12, v4
    v_xor_b32 v12, 128, v11
    v_add_u32 v12, 15360, v12
    s_lshl_b32 s20, s28, 15
    s_lshl_b32 s25, s60, 8
    s_add_u32 s20, s20, s25
    s_lshl_b32 s26, s28, 11
    s_add_u32 s21, s20, 2621440
    s_lshl_b32 s24, s3, 17
    s_add_u32 s24, s24, s20
    s_add_u32 s48, s4, 0x1000000
    s_addc_u32 s49, s5, 0
    s_mov_b32 s50, 0x1e0000
    s_mov_b32 s51, 0x20000
    s_and_b32 s55, s62, 3
    s_lshr_b32 s31, s63, 2
    s_add_u32 s55, s55, s31
    s_sub_u32 s31, s55, 3
    s_cselect_b32 s55, s55, s31
    v_lshrrev_b32 v4, 3, v1
    v_and_b32 v5, 7, v1
    v_lshlrev_b32 v5, 4, v5
    v_lshl_add_u32 v6, v4, 12, v5
    s_mul_i32 s46, s63, 80
    s_mul_i32 s47, s28, 24
    s_add_u32 s46, s46, s47
    s_lshl_b32 s46, s46, 12
    s_lshl_b32 s47, s62, 7
    s_add_u32 s46, s46, s47
    s_mul_i32 s47, s28, 3072
    s_mul_i32 s54, s63, 245760
    s_mul_i32 s31, s28, 61440
    s_add_u32 s54, s54, s31
    s_add_u32 s53, s54, 61440
    s_mul_i32 s52, s55, 20480
    s_add_u32 s52, s52, s54
    v_lshrrev_b32 v4, 2, v1
    v_and_b32 v5, 7, v4
    s_lshl_b32 s27, s28, 1
    v_xor_b32 v5, s27, v5
    v_lshlrev_b32 v5, 5, v5
    v_lshl_add_u32 v5, v4, 8, v5
    v_and_b32 v4, 3, v1
    v_lshl_add_u32 v16, v4, 3, v5
    v_xor_b32 v17, 32, v16
    v_xor_b32 v18, 64, v16
    v_xor_b32 v19, 96, v16
    v_xor_b32 v20, 128, v16
    v_xor_b32 v21, 160, v16
    v_xor_b32 v22, 192, v16
    v_xor_b32 v23, 224, v16
    v_lshlrev_b32 v3, 4, v3
    v_lshrrev_b32 v4, 5, v1
    v_and_b32 v5, 1, v2
    s_mov_b32 s38, 49152
    v_mad_u32_u24 v14, v4, s38, v3
    v_lshl_add_u32 v13, v5, 8, v14
    s_and_b32 s30, s28, 1
    v_xor_b32 v5, s30, v5
    v_mul_u32_u24 v5, 98304, v5
    v_add3_u32 v14, v14, v5, s38
    v_subrev_u32 v14, 48640, v14
    s_mul_i32 s30, s60, 393216
    s_mul_i32 s31, s61, 3072
    s_add_u32 s30, s30, s31
    s_mul_i32 s31, s28, 768
    s_add_u32 s30, s30, s31
    s_xor_b32 s31, s28, 0
    s_mul_i32 s31, s31, 98304
    s_add_u32 s32, s30, s31
    s_xor_b32 s31, s28, 1
    s_mul_i32 s31, s31, 98304
    s_add_u32 s33, s30, s31
    s_xor_b32 s31, s28, 2
    s_mul_i32 s31, s31, 98304
    s_add_u32 s34, s30, s31
    s_xor_b32 s31, s28, 3
    s_mul_i32 s31, s31, 98304
    s_add_u32 s35, s30, s31
    s_lshr_b32 s31, s28, 1
    s_xor_b32 s31, s31, 0
    s_mul_i32 s31, s31, 196608
    s_add_u32 s36, s30, s31
    s_lshr_b32 s31, s28, 1
    s_xor_b32 s31, s31, 1
    s_mul_i32 s31, s31, 196608
    s_add_u32 s37, s30, s31
    s_lshl_b32 s31, s28, 9
    v_add_u32 v24, s31, v3
    v_lshl_add_u32 v25, v4, 8, v24
    v_lshrrev_b32 v4, 2, v1
    v_xor_b32 v4, v4, v2
    v_and_b32 v4, 1, v4
    v_lshl_add_u32 v15, v4, 11, v25
    v_and_b32 v4, 1, v2
    v_lshl_add_u32 v10, v4, 14, v25
    s_lshl_b32 s25, s60, 4
    s_add_u32 s25, s25, s61
    s_lshl_b32 s25, s25, 12
    s_add_u32 s25, s25, 6488064
    s_and_b32 s27, s61, 7
    s_lshl_b32 s27, s27, 12
    s_sub_u32 s27, s25, s27
    v_lshrrev_b32 v2, 1, v1
    v_and_b32 v3, 1, v1
    v_lshl_add_u32 v2, v2, 3, v3
    s_lshl_b32 s31, s28, 8
    s_add_u32 s31, s31, 65536
    s_add_u32 s31, s31, s6
    v_lshl_add_u32 v2, v2, 7, s31
    s_cmp_lg_u32 s6, 0
    s_cbranch_scc1 M_R1
    s_and_b32 s31, s2, 7
    s_lshl_b32 s31, s31, 2
    s_add_u32 s31, s31, s28
    s_mul_i32 s31, s31, 5120
    s_add_u32 s31, s31, 655360
    v_lshl_add_u32 v2, v1, 7, s31
M_R1:
    s_lshl_b32 s31, s28, 5
    s_add_u32 s31, s31, s63
    s_lshl_b32 s31, s31, 6
    s_add_u32 s31, s31, 53248
    v_and_b32 v3, 3, v1
    v_lshl_add_u32 v3, v3, 9, s31
    v_cmp_gt_u32 vcc, 40, v1
    s_mov_b32 s68, 0xaaaaaaaa
    s_mov_b32 s69, s68
    v_cndmask_b32 v26, v3, v2, vcc
    s_mov_b32 s70, 0xcccccccc
    s_mov_b32 s71, s70
    s_mov_b32 s72, 0xff00ff00
    s_mov_b32 s73, s72
    s_mov_b32 s74, 0
    s_mov_b32 s75, -1
    s_mul_i32 s31, s63, 2560
    s_add_u32 s31, s31, 102400
    v_lshl_add_u32 v8, v1, 7, s31
    s_lshl_b32 s31, s61, 2
    s_add_u32 s31, s31, s28
    s_mul_i32 s22, s31, 3072
    s_add_u32 s22, s22, 6291456
    s_lshl_b32 s23, s31, 6
    s_add_u32 s23, s23, 126976
    v_mov_b32 v7, s23
    v_cmp_gt_u32 vcc, 20, v1
    v_cndmask_b32 v8, v7, v8, vcc
    v_mov_b32 v252, -1
    v_mov_b32 v253, -1
    v_mov_b32 v254, -1
    v_mov_b32 v255, -1
    v_mov_b32 v220, 0x3f803f80
    v_mov_b32 v221, 0x3f803f80
    v_mov_b32 v222, 0x3f803f80
    v_mov_b32 v223, 0x3f803f80
    s_nop 1
    s_mov_b64 exec, 0
    s_cmp_eq_u32 s28, 0
    s_cbranch_scc1 PAD_B0
    s_cmp_eq_u32 s28, 1
    s_cbranch_scc1 PAD_B1
    s_cmp_eq_u32 s28, 2
    s_cbranch_scc1 PAD_B2
    s_cmp_eq_u32 s28, 3
    s_cbranch_scc1 PAD_B3
PAD_B3:
RET_B:
    s_mov_b64 exec, -1
    s_cmp_lt_u32 s2, 192
    s_cbranch_scc1 M_P2
    s_and_b32 s31, s2, 0xc3
    s_cmp_lg_u32 s31, 0xc0
    s_cbranch_scc1 M_P1
    s_mov_b32 s40, s39
    s_mov_b32 s39, s40
    s_waitcnt vmcnt(0)
    v_mfma_f32_16x16x32_bf16 v[44:47], a[0:3], v[220:223], 0
    v_mfma_f32_16x16x32_bf16 v[48:51], a[4:7], v[220:223], 0
    v_mfma_f32_16x16x32_bf16 v[52:55], a[8:11], v[220:223], 0
    v_mfma_f32_16x16x32_bf16 v[44:47], a[12:15], v[220:223], v[44:47]
    v_mfma_f32_16x16x32_bf16 v[48:51], a[16:19], v[220:223], v[48:51]
    v_mfma_f32_16x16x32_bf16 v[52:55], a[20:23], v[220:223], v[52:55]
    v_mfma_f32_16x16x32_bf16 v[44:47], a[24:27], v[220:223], v[44:47]
    v_mfma_f32_16x16x32_bf16 v[48:51], a[28:31], v[220:223], v[48:51]
    v_mfma_f32_16x16x32_bf16 v[52:55], a[32:35], v[220:223], v[52:55]
    v_mfma_f32_16x16x32_bf16 v[44:47], a[36:39], v[220:223], v[44:47]
    v_mfma_f32_16x16x32_bf16 v[48:51], a[40:43], v[220:223], v[48:51]
    v_mfma_f32_16x16x32_bf16 v[52:55], a[44:47], v[220:223], v[52:55]
    v_mfma_f32_16x16x32_bf16 v[44:47], a[48:51], v[220:223], v[44:47]
    v_mfma_f32_16x16x32_bf16 v[48:51], a[52:55], v[220:223], v[48:51]
    v_mfma_f32_16x16x32_bf16 v[52:55], a[56:59], v[220:223], v[52:55]
    v_mfma_f32_16x16x32_bf16 v[44:47], a[60:63], v[220:223], v[44:47]
    v_mfma_f32_16x16x32_bf16 v[48:51], a[64:67], v[220:223], v[48:51]
    v_mfma_f32_16x16x32_bf16 v[52:55], a[68:71], v[220:223], v[52:55]
    v_mfma_f32_16x16x32_bf16 v[44:47], a[72:75], v[220:223], v[44:47]
    v_mfma_f32_16x16x32_bf16 v[48:51], a[76:79], v[220:223], v[48:51]
    v_mfma_f32_16x16x32_bf16 v[52:55], a[80:83], v[220:223], v[52:55]
    v_mfma_f32_16x16x32_bf16 v[44:47], a[84:87], v[220:223], v[44:47]
    v_mfma_f32_16x16x32_bf16 v[48:51], a[88:91], v[220:223], v[48:51]
    v_mfma_f32_16x16x32_bf16 v[52:55], a[92:95], v[220:223], v[52:55]
    v_mfma_f32_16x16x32_bf16 v[44:47], a[96:99], v[220:223], v[44:47]
    v_mfma_f32_16x16x32_bf16 v[48:51], a[100:103], v[220:223], v[48:51]
    v_mfma_f32_16x16x32_bf16 v[52:55], a[104:107], v[220:223], v[52:55]
    v_mfma_f32_16x16x32_bf16 v[44:47], a[108:111], v[220:223], v[44:47]
    v_mfma_f32_16x16x32_bf16 v[48:51], a[112:115], v[220:223], v[48:51]
    v_mfma_f32_16x16x32_bf16 v[52:55], a[116:119], v[220:223], v[52:55]
    v_mfma_f32_16x16x32_bf16 v[44:47], a[120:123], v[220:223], v[44:47]
    v_mfma_f32_16x16x32_bf16 v[48:51], a[124:127], v[220:223], v[48:51]
    v_mfma_f32_16x16x32_bf16 v[52:55], a[128:131], v[220:223], v[52:55]
    v_mfma_f32_16x16x32_bf16 v[44:47], a[132:135], v[220:223], v[44:47]
    v_mfma_f32_16x16x32_bf16 v[48:51], a[136:139], v[220:223], v[48:51]
    v_mfma_f32_16x16x32_bf16 v[52:55], a[140:143], v[220:223], v[52:55]
    v_mfma_f32_16x16x32_bf16 v[44:47], a[144:147], v[220:223], v[44:47]
    v_mfma_f32_16x16x32_bf16 v[48:51], a[148:151], v[220:223], v[48:51]
    v_mfma_f32_16x16x32_bf16 v[52:55], a[152:155], v[220:223], v[52:55]
    v_mfma_f32_16x16x32_bf16 v[44:47], a[156:159], v[220:223], v[44:47]
    v_mfma_f32_16x16x32_bf16 v[48:51], a[160:163], v[220:223], v[48:51]
    v_mfma_f32_16x16x32_bf16 v[52:55], a[164:167], v[220:223], v[52:55]
    v_mfma_f32_16x16x32_bf16 v[44:47], a[168:171], v[220:223], v[44:47]
    v_mfma_f32_16x16x32_bf16 v[48:51], a[172:175], v[220:223], v[48:51]
    v_mfma_f32_16x16x32_bf16 v[52:55], a[176:179], v[220:223], v[52:55]
    v_mfma_f32_16x16x32_bf16 v[44:47], a[180:183], v[220:223], v[44:47]
    v_mfma_f32_16x16x32_bf16 v[48:51], a[184:187], v[220:223], v[48:51]
    v_mfma_f32_16x16x32_bf16 v[52:55], a[188:191], v[220:223], v[52:55]
    v_mfma_f32_16x16x32_bf16 v[44:47], a[192:195], v[220:223], v[44:47]
    v_mfma_f32_16x16x32_bf16 v[48:51], a[196:199], v[220:223], v[48:51]
    v_mfma_f32_16x16x32_bf16 v[52:55], a[200:203], v[220:223], v[52:55]
    v_mfma_f32_16x16x32_bf16 v[44:47], a[204:207], v[220:223], v[44:47]
    v_mfma_f32_16x16x32_bf16 v[48:51], a[208:211], v[220:223], v[48:51]
    v_mfma_f32_16x16x32_bf16 v[52:55], a[212:215], v[220:223], v[52:55]
    v_mfma_f32_16x16x32_bf16 v[44:47], a[216:219], v[220:223], v[44:47]
    v_mfma_f32_16x16x32_bf16 v[48:51], a[220:223], v[220:223], v[48:51]
    v_mfma_f32_16x16x32_bf16 v[52:55], a[224:227], v[220:223], v[52:55]
    v_mfma_f32_16x16x32_bf16 v[44:47], a[228:231], v[220:223], v[44:47]
    v_mfma_f32_16x16x32_bf16 v[48:51], a[232:235], v[220:223], v[48:51]
    v_mfma_f32_16x16x32_bf16 v[52:55], a[236:239], v[220:223], v[52:55]
    s_nop 7
    buffer_store_dwordx4 v[44:47], v9, s[16:19], s22 offen offset:0 sc1
    buffer_store_dwordx4 v[48:51], v9, s[16:19], s22 offen offset:1024 sc1
    buffer_store_dwordx4 v[52:55], v9, s[16:19], s22 offen offset:2048 sc1
    s_branch M_P2
M_P1:
    s_and_b32 s31, s29, 3
    s_cmp_lg_u32 s31, s28
    s_cbranch_scc1 M_P3
    s_lshr_b32 s31, s29, 2
    s_lshl_b64 exec, 0x249, s31
    s_movk_i32 s58, 0x7fff
PL_3:
    buffer_load_dword v5, v26, s[64:67], 0 offen sc1
    s_waitcnt vmcnt(0)
    v_cmp_ne_u32 vcc, s59, v5
    s_cbranch_vccz PD_4
    s_mov_b64 exec, vcc
    s_sub_u32 s58, s58, 1
    s_cbranch_scc0 PL_3
PD_4:
    s_mov_b64 exec, -1
M_P3:
    s_barrier
M_P2:
    s_movk_i32 s58, 0x7fff
    s_mov_b64 s[44:45], -1
    s_mul_i32 s31, s2, 5
    s_lshr_b32 s31, s31, 5
    s_lshl_b64 s[42:43], -1, s31
PL_5:
    buffer_load_dword v5, v26, s[64:67], 0 offen sc1
    s_andn2_b64 s[44:45], s[44:45], exec
    s_waitcnt vmcnt(0)
    v_cmp_ne_u32 vcc, s59, v5
    s_or_b64 s[44:45], s[44:45], vcc
    s_cbranch_scc0 PD_6
    s_and_b64 s[40:41], vcc, s[42:43]
    s_cselect_b64 s[40:41], s[40:41], vcc
    s_ff1_i32_b64 s31, s[40:41]
    s_lshl_b64 s[40:41], 1, s31
    s_bcnt1_i32_b64 s31, vcc
    s_cselect_b64 exec, vcc, s[44:45]
    s_cmp_gt_u32 s31, 4
    s_cselect_b64 exec, s[40:41], exec
    s_sub_u32 s58, s58, 1
    s_cbranch_scc0 PL_5
PD_6:
    s_mov_b64 exec, -1
    s_and_b32 s31, s2, 0xc3
    s_cmp_lg_u32 s31, 0xc0
    s_cbranch_scc1 M_NC
    v_mov_b32 v2, 0
    v_mov_b32 v3, s59
    s_mov_b64 exec, 1
    buffer_store_dword v3, v2, s[64:67], s23 offen sc1
    s_mov_b64 exec, -1
M_NC:
    s_add_u32 m0, s26, 0
    s_nop 0
    buffer_load_dwordx4 v11, s[8:11], s24 offen sc1 lds
    buffer_load_dwordx4 v12, s[8:11], s24 offen offset:1024 sc1 lds
    s_add_u32 s24, s24, 131072
    s_cmp_eq_u32 s24, s21
    s_cselect_b32 s24, s20, s24
    s_add_u32 m0, s26, 8192
    s_nop 0
    buffer_load_dwordx4 v11, s[8:11], s24 offen sc1 lds
    buffer_load_dwordx4 v12, s[8:11], s24 offen offset:1024 sc1 lds
    s_add_u32 s24, s24, 131072
    s_cmp_eq_u32 s24, s21
    s_cselect_b32 s24, s20, s24
    s_add_u32 m0, s26, 16384
    s_nop 0
    buffer_load_dwordx4 v11, s[8:11], s24 offen sc1 lds
    buffer_load_dwordx4 v12, s[8:11], s24 offen offset:1024 sc1 lds
    s_add_u32 s24, s24, 131072
    s_cmp_eq_u32 s24, s21
    s_cselect_b32 s24, s20, s24
    s_add_u32 m0, s26, 24576
    s_nop 0
    buffer_load_dwordx4 v11, s[8:11], s24 offen sc1 lds
    buffer_load_dwordx4 v12, s[8:11], s24 offen offset:1024 sc1 lds
    s_add_u32 s24, s24, 131072
    s_cmp_eq_u32 s24, s21
    s_cselect_b32 s24, s20, s24
    s_add_u32 m0, s26, 32768
    s_nop 0
    buffer_load_dwordx4 v11, s[8:11], s24 offen sc1 lds
    buffer_load_dwordx4 v12, s[8:11], s24 offen offset:1024 sc1 lds
    s_add_u32 s24, s24, 131072
    s_cmp_eq_u32 s24, s21
    s_cselect_b32 s24, s20, s24
    s_add_u32 m0, s26, 40960
    s_nop 0
    buffer_load_dwordx4 v11, s[8:11], s24 offen sc1 lds
    buffer_load_dwordx4 v12, s[8:11], s24 offen offset:1024 sc1 lds
    s_add_u32 s24, s24, 131072
    s_cmp_eq_u32 s24, s21
    s_cselect_b32 s24, s20, s24
    s_add_u32 m0, s26, 49152
    s_nop 0
    buffer_load_dwordx4 v11, s[8:11], s24 offen sc1 lds
    buffer_load_dwordx4 v12, s[8:11], s24 offen offset:1024 sc1 lds
    s_add_u32 s24, s24, 131072
    s_cmp_eq_u32 s24, s21
    s_cselect_b32 s24, s20, s24
    s_add_u32 m0, s26, 57344
    s_nop 0
    buffer_load_dwordx4 v11, s[8:11], s24 offen sc1 lds
    buffer_load_dwordx4 v12, s[8:11], s24 offen offset:1024 sc1 lds
    s_add_u32 s24, s24, 131072
    s_cmp_eq_u32 s24, s21
    s_cselect_b32 s24, s20, s24
    s_add_u32 s30, s27, 4096
    s_add_u32 s38, s27, 8192
    s_add_u32 s45, s27, 12288
    s_waitcnt vmcnt(14)
    s_barrier
    ds_read_b64_tr_b16 v[156:157], v16 offset:0
    ds_read_b64_tr_b16 v[158:159], v16 offset:4096
    ds_read_b64_tr_b16 v[160:161], v17 offset:0
    ds_read_b64_tr_b16 v[162:163], v17 offset:4096
    ds_read_b64_tr_b16 v[164:165], v18 offset:0
    ds_read_b64_tr_b16 v[166:167], v18 offset:4096
    ds_read_b64_tr_b16 v[168:169], v19 offset:0
    ds_read_b64_tr_b16 v[170:171], v19 offset:4096
    ds_read_b64_tr_b16 v[172:173], v20 offset:0
    ds_read_b64_tr_b16 v[174:175], v20 offset:4096
    ds_read_b64_tr_b16 v[176:177], v21 offset:0
    ds_read_b64_tr_b16 v[178:179], v21 offset:4096
    ds_read_b64_tr_b16 v[180:181], v22 offset:0
    ds_read_b64_tr_b16 v[182:183], v22 offset:4096
    ds_read_b64_tr_b16 v[184:185], v23 offset:0
    ds_read_b64_tr_b16 v[186:187], v23 offset:4096
    s_cmp_lg_u32 s28, 0
    s_cbranch_scc1 M_NE
    s_cmp_ge_u32 s2, 160
    s_cbranch_scc1 M_NE
    s_lshl_b32 s31, s29, 7
    s_add_u32 s31, s31, 102400
    v_mov_b32 v2, 0
    v_mov_b32 v3, s59
    s_mov_b64 exec, 1
    buffer_store_dword v3, v2, s[64:67], s31 offen sc1
    s_mov_b64 exec, -1
    s_cmp_lg_u32 s2, 0
    s_cbranch_scc1 M_NE
    v_mov_b32 v2, 0
    v_mov_b32 v3, s59
    s_mov_b64 exec, 1
    buffer_store_dword v3, v2, s[64:67], 0 offen sc1
    s_mov_b64 exec, -1
M_NE:
    s_waitcnt lgkmcnt(0)
    v_mfma_f32_16x16x32_bf16 v[36:39], v[156:159], v[156:159], 0
    v_mfma_f32_16x16x32_bf16 v[28:31], v[220:223], v[156:159], 0
    v_mfma_f32_16x16x32_bf16 v[40:43], v[160:163], v[160:163], 0
    v_mfma_f32_16x16x32_bf16 v[32:35], v[220:223], v[160:163], 0
    v_mfma_f32_16x16x32_bf16 v[60:63], a[0:3], v[156:159], 0
    s_waitcnt vmcnt(12)
    s_barrier
    ds_read_b64_tr_b16 v[188:189], v16 offset:8192
    v_mfma_f32_16x16x32_bf16 v[64:67], a[4:7], v[156:159], 0
    ds_read_b64_tr_b16 v[190:191], v16 offset:12288
    v_mfma_f32_16x16x32_bf16 v[68:71], a[8:11], v[156:159], 0
    ds_read_b64_tr_b16 v[192:193], v17 offset:8192
    v_mfma_f32_16x16x32_bf16 v[72:75], a[0:3], v[160:163], 0
    ds_read_b64_tr_b16 v[194:195], v17 offset:12288
    v_mfma_f32_16x16x32_bf16 v[76:79], a[4:7], v[160:163], 0
    ds_read_b64_tr_b16 v[196:197], v18 offset:8192
    v_mfma_f32_16x16x32_bf16 v[80:83], a[8:11], v[160:163], 0
    ds_read_b64_tr_b16 v[198:199], v18 offset:12288
    v_mfma_f32_16x16x32_bf16 v[84:87], a[0:3], v[164:167], 0
    ds_read_b64_tr_b16 v[200:201], v19 offset:8192
    v_mfma_f32_16x16x32_bf16 v[88:91], a[4:7], v[164:167], 0
    ds_read_b64_tr_b16 v[202:203], v19 offset:12288
    v_mfma_f32_16x16x32_bf16 v[92:95], a[8:11], v[164:167], 0
    ds_read_b64_tr_b16 v[204:205], v20 offset:8192
    v_mfma_f32_16x16x32_bf16 v[96:99], a[0:3], v[168:171], 0
    ds_read_b64_tr_b16 v[206:207], v20 offset:12288
    v_mfma_f32_16x16x32_bf16 v[100:103], a[4:7], v[168:171], 0
    ds_read_b64_tr_b16 v[208:209], v21 offset:8192
    v_mfma_f32_16x16x32_bf16 v[104:107], a[8:11], v[168:171], 0
    ds_read_b64_tr_b16 v[210:211], v21 offset:12288
    v_mfma_f32_16x16x32_bf16 v[108:111], a[0:3], v[172:175], 0
    ds_read_b64_tr_b16 v[212:213], v22 offset:8192
    v_mfma_f32_16x16x32_bf16 v[112:115], a[4:7], v[172:175], 0
    ds_read_b64_tr_b16 v[214:215], v22 offset:12288
    v_mfma_f32_16x16x32_bf16 v[116:119], a[8:11], v[172:175], 0
    ds_read_b64_tr_b16 v[216:217], v23 offset:8192
    v_mfma_f32_16x16x32_bf16 v[120:123], a[0:3], v[176:179], 0
    ds_read_b64_tr_b16 v[218:219], v23 offset:12288
    v_mfma_f32_16x16x32_bf16 v[124:127], a[4:7], v[176:179], 0
    v_mfma_f32_16x16x32_bf16 v[128:131], a[8:11], v[176:179], 0
    s_add_u32 m0, s26, 65536
    v_mfma_f32_16x16x32_bf16 v[132:135], a[0:3], v[180:183], 0
    buffer_load_dwordx4 v11, s[8:11], s24 offen sc1 lds
    v_mfma_f32_16x16x32_bf16 v[136:139], a[4:7], v[180:183], 0
    v_mfma_f32_16x16x32_bf16 v[140:143], a[8:11], v[180:183], 0
    buffer_load_dwordx4 v12, s[8:11], s24 offen offset:1024 sc1 lds
    s_add_u32 s24, s24, 131072
    v_mfma_f32_16x16x32_bf16 v[144:147], a[0:3], v[184:187], 0
    s_cmp_eq_u32 s24, s21
    s_cselect_b32 s24, s20, s24
    v_mfma_f32_16x16x32_bf16 v[148:151], a[4:7], v[184:187], 0
    v_mfma_f32_16x16x32_bf16 v[152:155], a[8:11], v[184:187], 0
    s_waitcnt lgkmcnt(0)
    v_mfma_f32_16x16x32_bf16 v[36:39], v[188:191], v[188:191], v[36:39]
    v_mfma_f32_16x16x32_bf16 v[28:31], v[220:223], v[188:191], v[28:31]
    v_mfma_f32_16x16x32_bf16 v[40:43], v[192:195], v[192:195], v[40:43]
    v_mfma_f32_16x16x32_bf16 v[32:35], v[220:223], v[192:195], v[32:35]
    v_mfma_f32_16x16x32_bf16 v[60:63], a[12:15], v[188:191], v[60:63]
    s_waitcnt vmcnt(10)
    s_barrier
    ds_read_b64_tr_b16 v[156:157], v16 offset:16384
    v_mfma_f32_16x16x32_bf16 v[64:67], a[16:19], v[188:191], v[64:67]
    ds_read_b64_tr_b16 v[158:159], v16 offset:20480
    v_mfma_f32_16x16x32_bf16 v[68:71], a[20:23], v[188:191], v[68:71]
    ds_read_b64_tr_b16 v[160:161], v17 offset:16384
    v_mfma_f32_16x16x32_bf16 v[72:75], a[12:15], v[192:195], v[72:75]
    ds_read_b64_tr_b16 v[162:163], v17 offset:20480
    v_mfma_f32_16x16x32_bf16 v[76:79], a[16:19], v[192:195], v[76:79]
    ds_read_b64_tr_b16 v[164:165], v18 offset:16384
    v_mfma_f32_16x16x32_bf16 v[80:83], a[20:23], v[192:195], v[80:83]
    ds_read_b64_tr_b16 v[166:167], v18 offset:20480
    v_mfma_f32_16x16x32_bf16 v[84:87], a[12:15], v[196:199], v[84:87]
    ds_read_b64_tr_b16 v[168:169], v19 offset:16384
    v_mfma_f32_16x16x32_bf16 v[88:91], a[16:19], v[196:199], v[88:91]
    ds_read_b64_tr_b16 v[170:171], v19 offset:20480
    v_mfma_f32_16x16x32_bf16 v[92:95], a[20:23], v[196:199], v[92:95]
    ds_read_b64_tr_b16 v[172:173], v20 offset:16384
    v_mfma_f32_16x16x32_bf16 v[96:99], a[12:15], v[200:203], v[96:99]
    ds_read_b64_tr_b16 v[174:175], v20 offset:20480
    v_mfma_f32_16x16x32_bf16 v[100:103], a[16:19], v[200:203], v[100:103]
    ds_read_b64_tr_b16 v[176:177], v21 offset:16384
    v_mfma_f32_16x16x32_bf16 v[104:107], a[20:23], v[200:203], v[104:107]
    ds_read_b64_tr_b16 v[178:179], v21 offset:20480
    v_mfma_f32_16x16x32_bf16 v[108:111], a[12:15], v[204:207], v[108:111]
    ds_read_b64_tr_b16 v[180:181], v22 offset:16384
    v_mfma_f32_16x16x32_bf16 v[112:115], a[16:19], v[204:207], v[112:115]
    ds_read_b64_tr_b16 v[182:183], v22 offset:20480
    v_mfma_f32_16x16x32_bf16 v[116:119], a[20:23], v[204:207], v[116:119]
    ds_read_b64_tr_b16 v[184:185], v23 offset:16384
    v_mfma_f32_16x16x32_bf16 v[120:123], a[12:15], v[208:211], v[120:123]
    ds_read_b64_tr_b16 v[186:187], v23 offset:20480
    v_mfma_f32_16x16x32_bf16 v[124:127], a[16:19], v[208:211], v[124:127]
    buffer_load_dwordx4 a[0:3], v9, s[48:51], s52 offen offset:0 sc1
    v_mfma_f32_16x16x32_bf16 v[128:131], a[20:23], v[208:211], v[128:131]
    s_add_u32 m0, s26, 73728
    v_mfma_f32_16x16x32_bf16 v[132:135], a[12:15], v[212:215], v[132:135]
    buffer_load_dwordx4 v11, s[8:11], s24 offen sc1 lds
    v_mfma_f32_16x16x32_bf16 v[136:139], a[16:19], v[212:215], v[136:139]
    buffer_load_dwordx4 a[4:7], v9, s[48:51], s52 offen offset:1024 sc1
    v_mfma_f32_16x16x32_bf16 v[140:143], a[20:23], v[212:215], v[140:143]
    buffer_load_dwordx4 v12, s[8:11], s24 offen offset:1024 sc1 lds
    s_add_u32 s24, s24, 131072
    v_mfma_f32_16x16x32_bf16 v[144:147], a[12:15], v[216:219], v[144:147]
    s_cmp_eq_u32 s24, s21
    s_cselect_b32 s24, s20, s24
    v_mfma_f32_16x16x32_bf16 v[148:151], a[16:19], v[216:219], v[148:151]
    v_mfma_f32_16x16x32_bf16 v[152:155], a[20:23], v[216:219], v[152:155]
    s_waitcnt lgkmcnt(0)
    s_bitcmp1_b32 s61, 0
    s_cbranch_scc0 G1_S2
    v_mfma_f32_16x16x32_bf16 v[36:39], v[156:159], v[156:159], v[36:39]
    v_mfma_f32_16x16x32_bf16 v[28:31], v[220:223], v[156:159], v[28:31]
    v_mfma_f32_16x16x32_bf16 v[40:43], v[160:163], v[160:163], v[40:43]
    v_mfma_f32_16x16x32_bf16 v[32:35], v[220:223], v[160:163], v[32:35]
G1_S2:
    v_mfma_f32_16x16x32_bf16 v[60:63], a[24:27], v[156:159], v[60:63]
    ds_read_b64_tr_b16 v[188:189], v16 offset:24576
    v_mfma_f32_16x16x32_bf16 v[64:67], a[28:31], v[156:159], v[64:67]
    ds_read_b64_tr_b16 v[190:191], v16 offset:28672
    v_mfma_f32_16x16x32_bf16 v[68:71], a[32:35], v[156:159], v[68:71]
    ds_read_b64_tr_b16 v[192:193], v17 offset:24576
    v_mfma_f32_16x16x32_bf16 v[72:75], a[24:27], v[160:163], v[72:75]
    ds_read_b64_tr_b16 v[194:195], v17 offset:28672
    v_mfma_f32_16x16x32_bf16 v[76:79], a[28:31], v[160:163], v[76:79]
    ds_read_b64_tr_b16 v[196:197], v18 offset:24576
    v_mfma_f32_16x16x32_bf16 v[80:83], a[32:35], v[160:163], v[80:83]
    ds_read_b64_tr_b16 v[198:199], v18 offset:28672
    v_mfma_f32_16x16x32_bf16 v[84:87], a[24:27], v[164:167], v[84:87]
    ds_read_b64_tr_b16 v[200:201], v19 offset:24576
    v_mfma_f32_16x16x32_bf16 v[88:91], a[28:31], v[164:167], v[88:91]
    ds_read_b64_tr_b16 v[202:203], v19 offset:28672
    v_mfma_f32_16x16x32_bf16 v[92:95], a[32:35], v[164:167], v[92:95]
    ds_read_b64_tr_b16 v[204:205], v20 offset:24576
    v_mfma_f32_16x16x32_bf16 v[96:99], a[24:27], v[168:171], v[96:99]
    ds_read_b64_tr_b16 v[206:207], v20 offset:28672
    v_mfma_f32_16x16x32_bf16 v[100:103], a[28:31], v[168:171], v[100:103]
    ds_read_b64_tr_b16 v[208:209], v21 offset:24576
    v_mfma_f32_16x16x32_bf16 v[104:107], a[32:35], v[168:171], v[104:107]
    ds_read_b64_tr_b16 v[210:211], v21 offset:28672
    v_mfma_f32_16x16x32_bf16 v[108:111], a[24:27], v[172:175], v[108:111]
    ds_read_b64_tr_b16 v[212:213], v22 offset:24576
    v_mfma_f32_16x16x32_bf16 v[112:115], a[28:31], v[172:175], v[112:115]
    ds_read_b64_tr_b16 v[214:215], v22 offset:28672
    v_mfma_f32_16x16x32_bf16 v[116:119], a[32:35], v[172:175], v[116:119]
    ds_read_b64_tr_b16 v[216:217], v23 offset:24576
    v_mfma_f32_16x16x32_bf16 v[120:123], a[24:27], v[176:179], v[120:123]
    ds_read_b64_tr_b16 v[218:219], v23 offset:28672
    v_mfma_f32_16x16x32_bf16 v[124:127], a[28:31], v[176:179], v[124:127]
    buffer_load_dwordx4 a[8:11], v9, s[48:51], s52 offen offset:2048 sc1
    v_mfma_f32_16x16x32_bf16 v[128:131], a[32:35], v[176:179], v[128:131]
    s_add_u32 m0, s26, 81920
    v_mfma_f32_16x16x32_bf16 v[132:135], a[24:27], v[180:183], v[132:135]
    buffer_load_dwordx4 v11, s[8:11], s24 offen sc1 lds
    v_mfma_f32_16x16x32_bf16 v[136:139], a[28:31], v[180:183], v[136:139]
    buffer_load_dwordx4 a[12:15], v9, s[48:51], s52 offen offset:3072 sc1
    s_add_u32 s52, s52, 4096
    v_mfma_f32_16x16x32_bf16 v[140:143], a[32:35], v[180:183], v[140:143]
    buffer_load_dwordx4 v12, s[8:11], s24 offen offset:1024 sc1 lds
    s_add_u32 s24, s24, 131072
    v_mfma_f32_16x16x32_bf16 v[144:147], a[24:27], v[184:187], v[144:147]
    s_cmp_eq_u32 s24, s21
    s_cselect_b32 s24, s20, s24
    v_mfma_f32_16x16x32_bf16 v[148:151], a[28:31], v[184:187], v[148:151]
    v_mfma_f32_16x16x32_bf16 v[152:155], a[32:35], v[184:187], v[152:155]
    s_waitcnt lgkmcnt(0)
    v_mfma_f32_16x16x32_bf16 v[60:63], a[36:39], v[188:191], v[60:63]
    s_waitcnt vmcnt(14)
    s_barrier
    ds_read_b64_tr_b16 v[156:157], v16 offset:32768
    v_mfma_f32_16x16x32_bf16 v[64:67], a[40:43], v[188:191], v[64:67]
    ds_read_b64_tr_b16 v[158:159], v16 offset:36864
    v_cndmask_b32 v36, v36, v37, s[68:69]
    v_mfma_f32_16x16x32_bf16 v[68:71], a[44:47], v[188:191], v[68:71]
    ds_read_b64_tr_b16 v[160:161], v17 offset:32768
    v_cndmask_b32 v38, v38, v39, s[68:69]
    v_mfma_f32_16x16x32_bf16 v[72:75], a[36:39], v[192:195], v[72:75]
    ds_read_b64_tr_b16 v[162:163], v17 offset:36864
    v_cndmask_b32 v40, v40, v41, s[68:69]
    v_mfma_f32_16x16x32_bf16 v[76:79], a[40:43], v[192:195], v[76:79]
    ds_read_b64_tr_b16 v[164:165], v18 offset:32768
    v_cndmask_b32 v42, v42, v43, s[68:69]
    v_mfma_f32_16x16x32_bf16 v[80:83], a[44:47], v[192:195], v[80:83]
    ds_read_b64_tr_b16 v[166:167], v18 offset:36864
    v_cndmask_b32 v36, v36, v38, s[70:71]
    v_mfma_f32_16x16x32_bf16 v[84:87], a[36:39], v[196:199], v[84:87]
    ds_read_b64_tr_b16 v[168:169], v19 offset:32768
    v_cndmask_b32 v40, v40, v42, s[70:71]
    v_mfma_f32_16x16x32_bf16 v[88:91], a[40:43], v[196:199], v[88:91]
    ds_read_b64_tr_b16 v[170:171], v19 offset:36864
    v_cndmask_b32 v240, v28, v32, s[74:75]
    v_mfma_f32_16x16x32_bf16 v[92:95], a[44:47], v[196:199], v[92:95]
    ds_read_b64_tr_b16 v[172:173], v20 offset:32768
    v_mfma_f32_16x16x32_bf16 v[96:99], a[36:39], v[200:203], v[96:99]
    ds_read_b64_tr_b16 v[174:175], v20 offset:36864
    v_permlane32_swap_b32 v36, v40
    v_mfma_f32_16x16x32_bf16 v[100:103], a[40:43], v[200:203], v[100:103]
    ds_read_b64_tr_b16 v[176:177], v21 offset:32768
    v_mfma_f32_16x16x32_bf16 v[104:107], a[44:47], v[200:203], v[104:107]
    ds_read_b64_tr_b16 v[178:179], v21 offset:36864
    v_cndmask_b32 v242, v36, v40, s[72:73]
    v_mfma_f32_16x16x32_bf16 v[108:111], a[36:39], v[204:207], v[108:111]
    ds_read_b64_tr_b16 v[180:181], v22 offset:32768
    v_mov_b32 v241, s59
    v_mfma_f32_16x16x32_bf16 v[112:115], a[40:43], v[204:207], v[112:115]
    ds_read_b64_tr_b16 v[182:183], v22 offset:36864
    v_mov_b32 v243, s59
    v_mfma_f32_16x16x32_bf16 v[116:119], a[44:47], v[204:207], v[116:119]
    ds_read_b64_tr_b16 v[184:185], v23 offset:32768
    v_mfma_f32_16x16x32_bf16 v[120:123], a[36:39], v[208:211], v[120:123]
    ds_read_b64_tr_b16 v[186:187], v23 offset:36864
    v_mfma_f32_16x16x32_bf16 v[124:127], a[40:43], v[208:211], v[124:127]
    buffer_load_dwordx4 a[16:19], v9, s[48:51], s52 offen offset:0 sc1
    v_mfma_f32_16x16x32_bf16 v[128:131], a[44:47], v[208:211], v[128:131]
    s_add_u32 m0, s26, 90112
    v_mfma_f32_16x16x32_bf16 v[132:135], a[36:39], v[212:215], v[132:135]
    buffer_load_dwordx4 v11, s[8:11], s24 offen sc1 lds
    v_mfma_f32_16x16x32_bf16 v[136:139], a[40:43], v[212:215], v[136:139]
    buffer_load_dwordx4 a[20:23], v9, s[48:51], s52 offen offset:1024 sc1
    v_mfma_f32_16x16x32_bf16 v[140:143], a[44:47], v[212:215], v[140:143]
    buffer_load_dwordx4 v12, s[8:11], s24 offen offset:1024 sc1 lds
    s_add_u32 s24, s24, 131072
    v_mfma_f32_16x16x32_bf16 v[144:147], a[36:39], v[216:219], v[144:147]
    s_cmp_eq_u32 s24, s21
    s_cselect_b32 s24, s20, s24
    v_mfma_f32_16x16x32_bf16 v[148:151], a[40:43], v[216:219], v[148:151]
    v_mfma_f32_16x16x32_bf16 v[152:155], a[44:47], v[216:219], v[152:155]
    buffer_store_dwordx4 v[240:243], v15, s[16:19], s25 offen sc1
    s_waitcnt lgkmcnt(0)
    v_mfma_f32_16x16x32_bf16 v[60:63], a[48:51], v[156:159], v[60:63]
    ds_read_b64_tr_b16 v[188:189], v16 offset:40960
    v_mfma_f32_16x16x32_bf16 v[64:67], a[52:55], v[156:159], v[64:67]
    ds_read_b64_tr_b16 v[190:191], v16 offset:45056
    v_mfma_f32_16x16x32_bf16 v[68:71], a[56:59], v[156:159], v[68:71]
    ds_read_b64_tr_b16 v[192:193], v17 offset:40960
    v_mfma_f32_16x16x32_bf16 v[72:75], a[48:51], v[160:163], v[72:75]
    ds_read_b64_tr_b16 v[194:195], v17 offset:45056
    v_mfma_f32_16x16x32_bf16 v[76:79], a[52:55], v[160:163], v[76:79]
    ds_read_b64_tr_b16 v[196:197], v18 offset:40960
    v_mfma_f32_16x16x32_bf16 v[80:83], a[56:59], v[160:163], v[80:83]
    ds_read_b64_tr_b16 v[198:199], v18 offset:45056
    v_mfma_f32_16x16x32_bf16 v[84:87], a[48:51], v[164:167], v[84:87]
    ds_read_b64_tr_b16 v[200:201], v19 offset:40960
    v_mfma_f32_16x16x32_bf16 v[88:91], a[52:55], v[164:167], v[88:91]
    ds_read_b64_tr_b16 v[202:203], v19 offset:45056
    v_mfma_f32_16x16x32_bf16 v[92:95], a[56:59], v[164:167], v[92:95]
    ds_read_b64_tr_b16 v[204:205], v20 offset:40960
    v_mfma_f32_16x16x32_bf16 v[96:99], a[48:51], v[168:171], v[96:99]
    ds_read_b64_tr_b16 v[206:207], v20 offset:45056
    v_mfma_f32_16x16x32_bf16 v[100:103], a[52:55], v[168:171], v[100:103]
    ds_read_b64_tr_b16 v[208:209], v21 offset:40960
    v_mfma_f32_16x16x32_bf16 v[104:107], a[56:59], v[168:171], v[104:107]
    ds_read_b64_tr_b16 v[210:211], v21 offset:45056
    v_mfma_f32_16x16x32_bf16 v[108:111], a[48:51], v[172:175], v[108:111]
    ds_read_b64_tr_b16 v[212:213], v22 offset:40960
    v_mfma_f32_16x16x32_bf16 v[112:115], a[52:55], v[172:175], v[112:115]
    ds_read_b64_tr_b16 v[214:215], v22 offset:45056
    v_mfma_f32_16x16x32_bf16 v[116:119], a[56:59], v[172:175], v[116:119]
    ds_read_b64_tr_b16 v[216:217], v23 offset:40960
    v_mfma_f32_16x16x32_bf16 v[120:123], a[48:51], v[176:179], v[120:123]
    ds_read_b64_tr_b16 v[218:219], v23 offset:45056
    v_mfma_f32_16x16x32_bf16 v[124:127], a[52:55], v[176:179], v[124:127]
    buffer_load_dwordx4 a[24:27], v9, s[48:51], s52 offen offset:2048 sc1
    v_mfma_f32_16x16x32_bf16 v[128:131], a[56:59], v[176:179], v[128:131]
    s_add_u32 m0, s26, 98304
    v_mfma_f32_16x16x32_bf16 v[132:135], a[48:51], v[180:183], v[132:135]
    buffer_load_dwordx4 v11, s[8:11], s24 offen sc1 lds
    v_mfma_f32_16x16x32_bf16 v[136:139], a[52:55], v[180:183], v[136:139]
    buffer_load_dwordx4 a[28:31], v9, s[48:51], s52 offen offset:3072 sc1
    s_add_u32 s52, s52, 4096
    v_mfma_f32_16x16x32_bf16 v[140:143], a[56:59], v[180:183], v[140:143]
    buffer_load_dwordx4 v12, s[8:11], s24 offen offset:1024 sc1 lds
    s_add_u32 s24, s24, 131072
    v_mfma_f32_16x16x32_bf16 v[144:147], a[48:51], v[184:187], v[144:147]
    s_cmp_eq_u32 s24, s21
    s_cselect_b32 s24, s20, s24
    v_mfma_f32_16x16x32_bf16 v[148:151], a[52:55], v[184:187], v[148:151]
    v_mfma_f32_16x16x32_bf16 v[152:155], a[56:59], v[184:187], v[152:155]
    s_waitcnt lgkmcnt(0)
    v_mfma_f32_16x16x32_bf16 v[60:63], a[60:63], v[188:191], v[60:63]
    s_waitcnt vmcnt(19)
    s_barrier
    ds_read_b64_tr_b16 v[156:157], v16 offset:49152
    v_mfma_f32_16x16x32_bf16 v[64:67], a[64:67], v[188:191], v[64:67]
    ds_read_b64_tr_b16 v[158:159], v16 offset:53248
    v_mfma_f32_16x16x32_bf16 v[68:71], a[68:71], v[188:191], v[68:71]
    ds_read_b64_tr_b16 v[160:161], v17 offset:49152
    v_mfma_f32_16x16x32_bf16 v[72:75], a[60:63], v[192:195], v[72:75]
    ds_read_b64_tr_b16 v[162:163], v17 offset:53248
    v_mfma_f32_16x16x32_bf16 v[76:79], a[64:67], v[192:195], v[76:79]
    ds_read_b64_tr_b16 v[164:165], v18 offset:49152
    v_mfma_f32_16x16x32_bf16 v[80:83], a[68:71], v[192:195], v[80:83]
    ds_read_b64_tr_b16 v[166:167], v18 offset:53248
    v_mfma_f32_16x16x32_bf16 v[84:87], a[60:63], v[196:199], v[84:87]
    ds_read_b64_tr_b16 v[168:169], v19 offset:49152
    v_mfma_f32_16x16x32_bf16 v[88:91], a[64:67], v[196:199], v[88:91]
    ds_read_b64_tr_b16 v[170:171], v19 offset:53248
    v_mfma_f32_16x16x32_bf16 v[92:95], a[68:71], v[196:199], v[92:95]
    ds_read_b64_tr_b16 v[172:173], v20 offset:49152
    v_mfma_f32_16x16x32_bf16 v[96:99], a[60:63], v[200:203], v[96:99]
    ds_read_b64_tr_b16 v[174:175], v20 offset:53248
    v_mfma_f32_16x16x32_bf16 v[100:103], a[64:67], v[200:203], v[100:103]
    ds_read_b64_tr_b16 v[176:177], v21 offset:49152
    v_mfma_f32_16x16x32_bf16 v[104:107], a[68:71], v[200:203], v[104:107]
    ds_read_b64_tr_b16 v[178:179], v21 offset:53248
    v_mfma_f32_16x16x32_bf16 v[108:111], a[60:63], v[204:207], v[108:111]
    ds_read_b64_tr_b16 v[180:181], v22 offset:49152
    v_mfma_f32_16x16x32_bf16 v[112:115], a[64:67], v[204:207], v[112:115]
    ds_read_b64_tr_b16 v[182:183], v22 offset:53248
    v_mfma_f32_16x16x32_bf16 v[116:119], a[68:71], v[204:207], v[116:119]
    ds_read_b64_tr_b16 v[184:185], v23 offset:49152
    v_mfma_f32_16x16x32_bf16 v[120:123], a[60:63], v[208:211], v[120:123]
    ds_read_b64_tr_b16 v[186:187], v23 offset:53248
    v_mfma_f32_16x16x32_bf16 v[124:127], a[64:67], v[208:211], v[124:127]
    buffer_load_dwordx4 a[32:35], v9, s[48:51], s52 offen offset:0 sc1
    v_mfma_f32_16x16x32_bf16 v[128:131], a[68:71], v[208:211], v[128:131]
    s_add_u32 m0, s26, 106496
    v_mfma_f32_16x16x32_bf16 v[132:135], a[60:63], v[212:215], v[132:135]
    buffer_load_dwordx4 v11, s[8:11], s24 offen sc1 lds
    v_mfma_f32_16x16x32_bf16 v[136:139], a[64:67], v[212:215], v[136:139]
    buffer_load_dwordx4 a[36:39], v9, s[48:51], s52 offen offset:1024 sc1
    v_mfma_f32_16x16x32_bf16 v[140:143], a[68:71], v[212:215], v[140:143]
    buffer_load_dwordx4 v12, s[8:11], s24 offen offset:1024 sc1 lds
    s_add_u32 s24, s24, 131072
    v_mfma_f32_16x16x32_bf16 v[144:147], a[60:63], v[216:219], v[144:147]
    s_cmp_eq_u32 s24, s21
    s_cselect_b32 s24, s20, s24
    v_mfma_f32_16x16x32_bf16 v[148:151], a[64:67], v[216:219], v[148:151]
    v_mfma_f32_16x16x32_bf16 v[152:155], a[68:71], v[216:219], v[152:155]
    s_waitcnt lgkmcnt(0)
    v_mfma_f32_16x16x32_bf16 v[60:63], a[72:75], v[156:159], v[60:63]
    ds_read_b64_tr_b16 v[188:189], v16 offset:57344
    v_mfma_f32_16x16x32_bf16 v[64:67], a[76:79], v[156:159], v[64:67]
    ds_read_b64_tr_b16 v[190:191], v16 offset:61440
    v_mfma_f32_16x16x32_bf16 v[68:71], a[80:83], v[156:159], v[68:71]
    ds_read_b64_tr_b16 v[192:193], v17 offset:57344
    v_mfma_f32_16x16x32_bf16 v[72:75], a[72:75], v[160:163], v[72:75]
    ds_read_b64_tr_b16 v[194:195], v17 offset:61440
    v_mfma_f32_16x16x32_bf16 v[76:79], a[76:79], v[160:163], v[76:79]
    ds_read_b64_tr_b16 v[196:197], v18 offset:57344
    v_mfma_f32_16x16x32_bf16 v[80:83], a[80:83], v[160:163], v[80:83]
    ds_read_b64_tr_b16 v[198:199], v18 offset:61440
    v_mfma_f32_16x16x32_bf16 v[84:87], a[72:75], v[164:167], v[84:87]
    ds_read_b64_tr_b16 v[200:201], v19 offset:57344
    v_mfma_f32_16x16x32_bf16 v[88:91], a[76:79], v[164:167], v[88:91]
    ds_read_b64_tr_b16 v[202:203], v19 offset:61440
    v_mfma_f32_16x16x32_bf16 v[92:95], a[80:83], v[164:167], v[92:95]
PAD_B0:
    s_cbranch_execz RET_B
    ds_read_b64_tr_b16 v[204:205], v20 offset:57344
    v_mfma_f32_16x16x32_bf16 v[96:99], a[72:75], v[168:171], v[96:99]
    ds_read_b64_tr_b16 v[206:207], v20 offset:61440
    v_mfma_f32_16x16x32_bf16 v[100:103], a[76:79], v[168:171], v[100:103]
    ds_read_b64_tr_b16 v[208:209], v21 offset:57344
    v_mfma_f32_16x16x32_bf16 v[104:107], a[80:83], v[168:171], v[104:107]
    ds_read_b64_tr_b16 v[210:211], v21 offset:61440
    v_mfma_f32_16x16x32_bf16 v[108:111], a[72:75], v[172:175], v[108:111]
    ds_read_b64_tr_b16 v[212:213], v22 offset:57344
    v_mfma_f32_16x16x32_bf16 v[112:115], a[76:79], v[172:175], v[112:115]
    ds_read_b64_tr_b16 v[214:215], v22 offset:61440
    v_mfma_f32_16x16x32_bf16 v[116:119], a[80:83], v[172:175], v[116:119]
    ds_read_b64_tr_b16 v[216:217], v23 offset:57344
    v_mfma_f32_16x16x32_bf16 v[120:123], a[72:75], v[176:179], v[120:123]
    ds_read_b64_tr_b16 v[218:219], v23 offset:61440
    v_mfma_f32_16x16x32_bf16 v[124:127], a[76:79], v[176:179], v[124:127]
    buffer_load_dwordx4 a[40:43], v9, s[48:51], s52 offen offset:2048 sc1
    v_mfma_f32_16x16x32_bf16 v[128:131], a[80:83], v[176:179], v[128:131]
    s_add_u32 m0, s26, 114688
    v_mfma_f32_16x16x32_bf16 v[132:135], a[72:75], v[180:183], v[132:135]
    buffer_load_dwordx4 v11, s[8:11], s24 offen sc1 lds
    v_mfma_f32_16x16x32_bf16 v[136:139], a[76:79], v[180:183], v[136:139]
    buffer_load_dwordx4 a[44:47], v9, s[48:51], s52 offen offset:3072 sc1
    s_add_u32 s52, s52, 4096
    v_mfma_f32_16x16x32_bf16 v[140:143], a[80:83], v[180:183], v[140:143]
    buffer_load_dwordx4 v12, s[8:11], s24 offen offset:1024 sc1 lds
    s_add_u32 s24, s24, 131072
    v_mfma_f32_16x16x32_bf16 v[144:147], a[72:75], v[184:187], v[144:147]
    s_cmp_eq_u32 s24, s21
    s_cselect_b32 s24, s20, s24
    v_mfma_f32_16x16x32_bf16 v[148:151], a[76:79], v[184:187], v[148:151]
    v_mfma_f32_16x16x32_bf16 v[152:155], a[80:83], v[184:187], v[152:155]
    s_waitcnt lgkmcnt(0)
    v_mfma_f32_16x16x32_bf16 v[60:63], a[84:87], v[188:191], v[60:63]
    s_waitcnt vmcnt(21)
    s_barrier
    v_add_u32 v16, 0x10000, v16
    ds_read_b64_tr_b16 v[156:157], v16 offset:0
    v_mfma_f32_16x16x32_bf16 v[64:67], a[88:91], v[188:191], v[64:67]
    ds_read_b64_tr_b16 v[158:159], v16 offset:4096
    v_mfma_f32_16x16x32_bf16 v[68:71], a[92:95], v[188:191], v[68:71]
    v_add_u32 v17, 0x10000, v17
    ds_read_b64_tr_b16 v[160:161], v17 offset:0
    v_mfma_f32_16x16x32_bf16 v[72:75], a[84:87], v[192:195], v[72:75]
    ds_read_b64_tr_b16 v[162:163], v17 offset:4096
    v_mfma_f32_16x16x32_bf16 v[76:79], a[88:91], v[192:195], v[76:79]
    v_add_u32 v18, 0x10000, v18
    ds_read_b64_tr_b16 v[164:165], v18 offset:0
    v_mfma_f32_16x16x32_bf16 v[80:83], a[92:95], v[192:195], v[80:83]
    ds_read_b64_tr_b16 v[166:167], v18 offset:4096
    v_mfma_f32_16x16x32_bf16 v[84:87], a[84:87], v[196:199], v[84:87]
    v_add_u32 v19, 0x10000, v19
    ds_read_b64_tr_b16 v[168:169], v19 offset:0
    v_mfma_f32_16x16x32_bf16 v[88:91], a[88:91], v[196:199], v[88:91]
    ds_read_b64_tr_b16 v[170:171], v19 offset:4096
    v_mfma_f32_16x16x32_bf16 v[92:95], a[92:95], v[196:199], v[92:95]
    v_add_u32 v20, 0x10000, v20
    ds_read_b64_tr_b16 v[172:173], v20 offset:0
    v_mfma_f32_16x16x32_bf16 v[96:99], a[84:87], v[200:203], v[96:99]
    ds_read_b64_tr_b16 v[174:175], v20 offset:4096
    v_mfma_f32_16x16x32_bf16 v[100:103], a[88:91], v[200:203], v[100:103]
    v_add_u32 v21, 0x10000, v21
    ds_read_b64_tr_b16 v[176:177], v21 offset:0
    v_mfma_f32_16x16x32_bf16 v[104:107], a[92:95], v[200:203], v[104:107]
    ds_read_b64_tr_b16 v[178:179], v21 offset:4096
    v_mfma_f32_16x16x32_bf16 v[108:111], a[84:87], v[204:207], v[108:111]
    v_add_u32 v22, 0x10000, v22
    ds_read_b64_tr_b16 v[180:181], v22 offset:0
    v_mfma_f32_16x16x32_bf16 v[112:115], a[88:91], v[204:207], v[112:115]
    ds_read_b64_tr_b16 v[182:183], v22 offset:4096
    v_mfma_f32_16x16x32_bf16 v[116:119], a[92:95], v[204:207], v[116:119]
    v_add_u32 v23, 0x10000, v23
    ds_read_b64_tr_b16 v[184:185], v23 offset:0
    v_mfma_f32_16x16x32_bf16 v[120:123], a[84:87], v[208:211], v[120:123]
    ds_read_b64_tr_b16 v[186:187], v23 offset:4096
    v_mfma_f32_16x16x32_bf16 v[124:127], a[88:91], v[208:211], v[124:127]
    buffer_load_dwordx4 a[48:51], v9, s[48:51], s52 offen offset:0 sc1
    v_mfma_f32_16x16x32_bf16 v[128:131], a[92:95], v[208:211], v[128:131]
    s_add_u32 m0, s26, 122880
    v_mfma_f32_16x16x32_bf16 v[132:135], a[84:87], v[212:215], v[132:135]
    buffer_load_dwordx4 v11, s[8:11], s24 offen sc1 lds
    v_mfma_f32_16x16x32_bf16 v[136:139], a[88:91], v[212:215], v[136:139]
    buffer_load_dwordx4 a[52:55], v9, s[48:51], s52 offen offset:1024 sc1
    v_mfma_f32_16x16x32_bf16 v[140:143], a[92:95], v[212:215], v[140:143]
    buffer_load_dwordx4 v12, s[8:11], s24 offen offset:1024 sc1 lds
    s_add_u32 s24, s24, 131072
    v_mfma_f32_16x16x32_bf16 v[144:147], a[84:87], v[216:219], v[144:147]
    s_cmp_eq_u32 s24, s21
    s_cselect_b32 s24, s20, s24
    v_mfma_f32_16x16x32_bf16 v[148:151], a[88:91], v[216:219], v[148:151]
    v_mfma_f32_16x16x32_bf16 v[152:155], a[92:95], v[216:219], v[152:155]
    s_waitcnt lgkmcnt(0)
    v_mfma_f32_16x16x32_bf16 v[60:63], a[96:99], v[156:159], v[60:63]
    ds_read_b64_tr_b16 v[188:189], v16 offset:8192
    v_mfma_f32_16x16x32_bf16 v[64:67], a[100:103], v[156:159], v[64:67]
    ds_read_b64_tr_b16 v[190:191], v16 offset:12288
    v_mfma_f32_16x16x32_bf16 v[68:71], a[104:107], v[156:159], v[68:71]
    ds_read_b64_tr_b16 v[192:193], v17 offset:8192
    v_mfma_f32_16x16x32_bf16 v[72:75], a[96:99], v[160:163], v[72:75]
    ds_read_b64_tr_b16 v[194:195], v17 offset:12288
    v_mfma_f32_16x16x32_bf16 v[76:79], a[100:103], v[160:163], v[76:79]
    ds_read_b64_tr_b16 v[196:197], v18 offset:8192
    v_mfma_f32_16x16x32_bf16 v[80:83], a[104:107], v[160:163], v[80:83]
    ds_read_b64_tr_b16 v[198:199], v18 offset:12288
    v_mfma_f32_16x16x32_bf16 v[84:87], a[96:99], v[164:167], v[84:87]
    ds_read_b64_tr_b16 v[200:201], v19 offset:8192
    v_mfma_f32_16x16x32_bf16 v[88:91], a[100:103], v[164:167], v[88:91]
    ds_read_b64_tr_b16 v[202:203], v19 offset:12288
    v_mfma_f32_16x16x32_bf16 v[92:95], a[104:107], v[164:167], v[92:95]
    ds_read_b64_tr_b16 v[204:205], v20 offset:8192
    v_mfma_f32_16x16x32_bf16 v[96:99], a[96:99], v[168:171], v[96:99]
    ds_read_b64_tr_b16 v[206:207], v20 offset:12288
    v_mfma_f32_16x16x32_bf16 v[100:103], a[100:103], v[168:171], v[100:103]
    ds_read_b64_tr_b16 v[208:209], v21 offset:8192
    v_mfma_f32_16x16x32_bf16 v[104:107], a[104:107], v[168:171], v[104:107]
    ds_read_b64_tr_b16 v[210:211], v21 offset:12288
    v_mfma_f32_16x16x32_bf16 v[108:111], a[96:99], v[172:175], v[108:111]
    ds_read_b64_tr_b16 v[212:213], v22 offset:8192
    v_mfma_f32_16x16x32_bf16 v[112:115], a[100:103], v[172:175], v[112:115]
    ds_read_b64_tr_b16 v[214:215], v22 offset:12288
    v_mfma_f32_16x16x32_bf16 v[116:119], a[104:107], v[172:175], v[116:119]
    ds_read_b64_tr_b16 v[216:217], v23 offset:8192
    v_mfma_f32_16x16x32_bf16 v[120:123], a[96:99], v[176:179], v[120:123]
    ds_read_b64_tr_b16 v[218:219], v23 offset:12288
    v_mfma_f32_16x16x32_bf16 v[124:127], a[100:103], v[176:179], v[124:127]
    buffer_load_dwordx4 a[56:59], v9, s[48:51], s52 offen offset:2048 sc1
    v_mfma_f32_16x16x32_bf16 v[128:131], a[104:107], v[176:179], v[128:131]
    s_add_u32 m0, s26, 131072
    v_mfma_f32_16x16x32_bf16 v[132:135], a[96:99], v[180:183], v[132:135]
    buffer_load_dwordx4 v11, s[8:11], s24 offen sc1 lds
    v_mfma_f32_16x16x32_bf16 v[136:139], a[100:103], v[180:183], v[136:139]
    buffer_load_dwordx4 a[60:63], v9, s[48:51], s52 offen offset:3072 sc1
    s_add_u32 s52, s52, 4096
    v_mfma_f32_16x16x32_bf16 v[140:143], a[104:107], v[180:183], v[140:143]
    buffer_load_dwordx4 v12, s[8:11], s24 offen offset:1024 sc1 lds
    s_add_u32 s24, s24, 131072
    v_mfma_f32_16x16x32_bf16 v[144:147], a[96:99], v[184:187], v[144:147]
    s_cmp_eq_u32 s24, s21
    s_cselect_b32 s24, s20, s24
    v_mfma_f32_16x16x32_bf16 v[148:151], a[100:103], v[184:187], v[148:151]
    buffer_load_dwordx4 a[64:67], v9, s[48:51], s52 offen offset:0 sc1
    v_mfma_f32_16x16x32_bf16 v[152:155], a[104:107], v[184:187], v[152:155]
    s_waitcnt lgkmcnt(0)
    v_mfma_f32_16x16x32_bf16 v[60:63], a[108:111], v[188:191], v[60:63]
    s_waitcnt vmcnt(22)
    s_barrier
    ds_read_b64_tr_b16 v[156:157], v16 offset:16384
    v_mfma_f32_16x16x32_bf16 v[64:67], a[112:115], v[188:191], v[64:67]
    ds_read_b64_tr_b16 v[158:159], v16 offset:20480
    v_mfma_f32_16x16x32_bf16 v[68:71], a[116:119], v[188:191], v[68:71]
    ds_read_b64_tr_b16 v[160:161], v17 offset:16384
    v_mfma_f32_16x16x32_bf16 v[72:75], a[108:111], v[192:195], v[72:75]
    ds_read_b64_tr_b16 v[162:163], v17 offset:20480
    v_mfma_f32_16x16x32_bf16 v[76:79], a[112:115], v[192:195], v[76:79]
    ds_read_b64_tr_b16 v[164:165], v18 offset:16384
    v_mfma_f32_16x16x32_bf16 v[80:83], a[116:119], v[192:195], v[80:83]
    ds_read_b64_tr_b16 v[166:167], v18 offset:20480
    v_mfma_f32_16x16x32_bf16 v[84:87], a[108:111], v[196:199], v[84:87]
    ds_read_b64_tr_b16 v[168:169], v19 offset:16384
    v_mfma_f32_16x16x32_bf16 v[88:91], a[112:115], v[196:199], v[88:91]
    ds_read_b64_tr_b16 v[170:171], v19 offset:20480
    v_mfma_f32_16x16x32_bf16 v[92:95], a[116:119], v[196:199], v[92:95]
    ds_read_b64_tr_b16 v[172:173], v20 offset:16384
    v_mfma_f32_16x16x32_bf16 v[96:99], a[108:111], v[200:203], v[96:99]
    ds_read_b64_tr_b16 v[174:175], v20 offset:20480
    v_mfma_f32_16x16x32_bf16 v[100:103], a[112:115], v[200:203], v[100:103]
    ds_read_b64_tr_b16 v[176:177], v21 offset:16384
    v_mfma_f32_16x16x32_bf16 v[104:107], a[116:119], v[200:203], v[104:107]
    ds_read_b64_tr_b16 v[178:179], v21 offset:20480
    v_mfma_f32_16x16x32_bf16 v[108:111], a[108:111], v[204:207], v[108:111]
    ds_read_b64_tr_b16 v[180:181], v22 offset:16384
    v_mfma_f32_16x16x32_bf16 v[112:115], a[112:115], v[204:207], v[112:115]
    ds_read_b64_tr_b16 v[182:183], v22 offset:20480
    v_mfma_f32_16x16x32_bf16 v[116:119], a[116:119], v[204:207], v[116:119]
    ds_read_b64_tr_b16 v[184:185], v23 offset:16384
    v_mfma_f32_16x16x32_bf16 v[120:123], a[108:111], v[208:211], v[120:123]
    ds_read_b64_tr_b16 v[186:187], v23 offset:20480
    v_mfma_f32_16x16x32_bf16 v[124:127], a[112:115], v[208:211], v[124:127]
    buffer_load_dwordx4 a[68:71], v9, s[48:51], s52 offen offset:1024 sc1
    v_mfma_f32_16x16x32_bf16 v[128:131], a[116:119], v[208:211], v[128:131]
    s_add_u32 m0, s26, 139264
    v_mfma_f32_16x16x32_bf16 v[132:135], a[108:111], v[212:215], v[132:135]
    buffer_load_dwordx4 v11, s[8:11], s24 offen sc1 lds
    v_mfma_f32_16x16x32_bf16 v[136:139], a[112:115], v[212:215], v[136:139]
    buffer_load_dwordx4 a[72:75], v9, s[48:51], s52 offen offset:2048 sc1
    v_mfma_f32_16x16x32_bf16 v[140:143], a[116:119], v[212:215], v[140:143]
    buffer_load_dwordx4 v12, s[8:11], s24 offen offset:1024 sc1 lds
    s_add_u32 s24, s24, 131072
    v_mfma_f32_16x16x32_bf16 v[144:147], a[108:111], v[216:219], v[144:147]
    s_cmp_eq_u32 s24, s21
    s_cselect_b32 s24, s20, s24
    v_mfma_f32_16x16x32_bf16 v[148:151], a[112:115], v[216:219], v[148:151]
    buffer_load_dwordx4 a[76:79], v9, s[48:51], s52 offen offset:3072 sc1
    s_add_u32 s52, s52, 4096
    s_cmp_eq_u32 s52, s53
    s_cselect_b32 s52, s54, s52
    v_mfma_f32_16x16x32_bf16 v[152:155], a[116:119], v[216:219], v[152:155]
    s_waitcnt lgkmcnt(0)
    v_mfma_f32_16x16x32_bf16 v[60:63], a[120:123], v[156:159], v[60:63]
    ds_read_b64_tr_b16 v[188:189], v16 offset:24576
    v_mfma_f32_16x16x32_bf16 v[64:67], a[124:127], v[156:159], v[64:67]
    ds_read_b64_tr_b16 v[190:191], v16 offset:28672
    v_mfma_f32_16x16x32_bf16 v[68:71], a[128:131], v[156:159], v[68:71]
    ds_read_b64_tr_b16 v[192:193], v17 offset:24576
    v_mfma_f32_16x16x32_bf16 v[72:75], a[120:123], v[160:163], v[72:75]
    ds_read_b64_tr_b16 v[194:195], v17 offset:28672
    v_mfma_f32_16x16x32_bf16 v[76:79], a[124:127], v[160:163], v[76:79]
    ds_read_b64_tr_b16 v[196:197], v18 offset:24576
    v_mfma_f32_16x16x32_bf16 v[80:83], a[128:131], v[160:163], v[80:83]
    ds_read_b64_tr_b16 v[198:199], v18 offset:28672
    v_mfma_f32_16x16x32_bf16 v[84:87], a[120:123], v[164:167], v[84:87]
    ds_read_b64_tr_b16 v[200:201], v19 offset:24576
    v_mfma_f32_16x16x32_bf16 v[88:91], a[124:127], v[164:167], v[88:91]
    ds_read_b64_tr_b16 v[202:203], v19 offset:28672
    v_mfma_f32_16x16x32_bf16 v[92:95], a[128:131], v[164:167], v[92:95]
    ds_read_b64_tr_b16 v[204:205], v20 offset:24576
    v_mfma_f32_16x16x32_bf16 v[96:99], a[120:123], v[168:171], v[96:99]
    ds_read_b64_tr_b16 v[206:207], v20 offset:28672
    v_mfma_f32_16x16x32_bf16 v[100:103], a[124:127], v[168:171], v[100:103]
    ds_read_b64_tr_b16 v[208:209], v21 offset:24576
    v_mfma_f32_16x16x32_bf16 v[104:107], a[128:131], v[168:171], v[104:107]
    ds_read_b64_tr_b16 v[210:211], v21 offset:28672
    v_mfma_f32_16x16x32_bf16 v[108:111], a[120:123], v[172:175], v[108:111]
    ds_read_b64_tr_b16 v[212:213], v22 offset:24576
    v_mfma_f32_16x16x32_bf16 v[112:115], a[124:127], v[172:175], v[112:115]
    ds_read_b64_tr_b16 v[214:215], v22 offset:28672
    v_mfma_f32_16x16x32_bf16 v[116:119], a[128:131], v[172:175], v[116:119]
    ds_read_b64_tr_b16 v[216:217], v23 offset:24576
    v_mfma_f32_16x16x32_bf16 v[120:123], a[120:123], v[176:179], v[120:123]
    ds_read_b64_tr_b16 v[218:219], v23 offset:28672
    v_mfma_f32_16x16x32_bf16 v[124:127], a[124:127], v[176:179], v[124:127]
    buffer_load_dwordx4 a[80:83], v9, s[48:51], s52 offen offset:0 sc1
    v_mfma_f32_16x16x32_bf16 v[128:131], a[128:131], v[176:179], v[128:131]
    s_add_u32 m0, s26, 147456
    v_mfma_f32_16x16x32_bf16 v[132:135], a[120:123], v[180:183], v[132:135]
    buffer_load_dwordx4 v11, s[8:11], s24 offen sc1 lds
    v_mfma_f32_16x16x32_bf16 v[136:139], a[124:127], v[180:183], v[136:139]
    buffer_load_dwordx4 a[84:87], v9, s[48:51], s52 offen offset:1024 sc1
    v_mfma_f32_16x16x32_bf16 v[140:143], a[128:131], v[180:183], v[140:143]
    buffer_load_dwordx4 v12, s[8:11], s24 offen offset:1024 sc1 lds
    s_add_u32 s24, s24, 131072
    v_mfma_f32_16x16x32_bf16 v[144:147], a[120:123], v[184:187], v[144:147]
    s_cmp_eq_u32 s24, s21
    s_cselect_b32 s24, s20, s24
    v_mfma_f32_16x16x32_bf16 v[148:151], a[124:127], v[184:187], v[148:151]
    buffer_load_dwordx4 a[88:91], v9, s[48:51], s52 offen offset:2048 sc1
    v_mfma_f32_16x16x32_bf16 v[152:155], a[128:131], v[184:187], v[152:155]
    s_waitcnt lgkmcnt(0)
    v_mfma_f32_16x16x32_bf16 v[60:63], a[132:135], v[188:191], v[60:63]
    s_waitcnt vmcnt(23)
    s_barrier
    ds_read_b64_tr_b16 v[156:157], v16 offset:32768
    v_mfma_f32_16x16x32_bf16 v[64:67], a[136:139], v[188:191], v[64:67]
    ds_read_b64_tr_b16 v[158:159], v16 offset:36864
    v_mfma_f32_16x16x32_bf16 v[68:71], a[140:143], v[188:191], v[68:71]
    ds_read_b64_tr_b16 v[160:161], v17 offset:32768
    v_mfma_f32_16x16x32_bf16 v[72:75], a[132:135], v[192:195], v[72:75]
    ds_read_b64_tr_b16 v[162:163], v17 offset:36864
    v_mfma_f32_16x16x32_bf16 v[76:79], a[136:139], v[192:195], v[76:79]
    ds_read_b64_tr_b16 v[164:165], v18 offset:32768
    v_mfma_f32_16x16x32_bf16 v[80:83], a[140:143], v[192:195], v[80:83]
    ds_read_b64_tr_b16 v[166:167], v18 offset:36864
    v_mfma_f32_16x16x32_bf16 v[84:87], a[132:135], v[196:199], v[84:87]
    ds_read_b64_tr_b16 v[168:169], v19 offset:32768
    v_mfma_f32_16x16x32_bf16 v[88:91], a[136:139], v[196:199], v[88:91]
    ds_read_b64_tr_b16 v[170:171], v19 offset:36864
    v_mfma_f32_16x16x32_bf16 v[92:95], a[140:143], v[196:199], v[92:95]
    ds_read_b64_tr_b16 v[172:173], v20 offset:32768
    v_mfma_f32_16x16x32_bf16 v[96:99], a[132:135], v[200:203], v[96:99]
    ds_read_b64_tr_b16 v[174:175], v20 offset:36864
    v_mfma_f32_16x16x32_bf16 v[100:103], a[136:139], v[200:203], v[100:103]
    ds_read_b64_tr_b16 v[176:177], v21 offset:32768
    v_mfma_f32_16x16x32_bf16 v[104:107], a[140:143], v[200:203], v[104:107]
    ds_read_b64_tr_b16 v[178:179], v21 offset:36864
    v_mfma_f32_16x16x32_bf16 v[108:111], a[132:135], v[204:207], v[108:111]
    ds_read_b64_tr_b16 v[180:181], v22 offset:32768
    v_mfma_f32_16x16x32_bf16 v[112:115], a[136:139], v[204:207], v[112:115]
    ds_read_b64_tr_b16 v[182:183], v22 offset:36864
    v_mfma_f32_16x16x32_bf16 v[116:119], a[140:143], v[204:207], v[116:119]
    ds_read_b64_tr_b16 v[184:185], v23 offset:32768
    v_mfma_f32_16x16x32_bf16 v[120:123], a[132:135], v[208:211], v[120:123]
    ds_read_b64_tr_b16 v[186:187], v23 offset:36864
    v_mfma_f32_16x16x32_bf16 v[124:127], a[136:139], v[208:211], v[124:127]
    buffer_load_dwordx4 a[92:95], v9, s[48:51], s52 offen offset:3072 sc1
    s_add_u32 s52, s52, 4096
    v_mfma_f32_16x16x32_bf16 v[128:131], a[140:143], v[208:211], v[128:131]
    s_add_u32 m0, s26, 155648
    v_mfma_f32_16x16x32_bf16 v[132:135], a[132:135], v[212:215], v[132:135]
    buffer_load_dwordx4 v11, s[8:11], s24 offen sc1 lds
    v_mfma_f32_16x16x32_bf16 v[136:139], a[136:139], v[212:215], v[136:139]
    buffer_load_dwordx4 a[96:99], v9, s[48:51], s52 offen offset:0 sc1
    v_mfma_f32_16x16x32_bf16 v[140:143], a[140:143], v[212:215], v[140:143]
    buffer_load_dwordx4 v12, s[8:11], s24 offen offset:1024 sc1 lds
    s_add_u32 s24, s24, 131072
    v_mfma_f32_16x16x32_bf16 v[144:147], a[132:135], v[216:219], v[144:147]
    s_cmp_eq_u32 s24, s21
    s_cselect_b32 s24, s20, s24
    v_mfma_f32_16x16x32_bf16 v[148:151], a[136:139], v[216:219], v[148:151]
    buffer_load_dwordx4 a[100:103], v9, s[48:51], s52 offen offset:1024 sc1
    v_mfma_f32_16x16x32_bf16 v[152:155], a[140:143], v[216:219], v[152:155]
    buffer_load_dword v7, v8, s[64:67], 0 offen sc1
    s_waitcnt lgkmcnt(0)
    v_mfma_f32_16x16x32_bf16 v[60:63], a[144:147], v[156:159], v[60:63]
    ds_read_b64_tr_b16 v[188:189], v16 offset:40960
    v_mfma_f32_16x16x32_bf16 v[64:67], a[148:151], v[156:159], v[64:67]
    ds_read_b64_tr_b16 v[190:191], v16 offset:45056
    v_mfma_f32_16x16x32_bf16 v[68:71], a[152:155], v[156:159], v[68:71]
    ds_read_b64_tr_b16 v[192:193], v17 offset:40960
    v_mfma_f32_16x16x32_bf16 v[72:75], a[144:147], v[160:163], v[72:75]
    ds_read_b64_tr_b16 v[194:195], v17 offset:45056
    v_mfma_f32_16x16x32_bf16 v[76:79], a[148:151], v[160:163], v[76:79]
    ds_read_b64_tr_b16 v[196:197], v18 offset:40960
    v_mfma_f32_16x16x32_bf16 v[80:83], a[152:155], v[160:163], v[80:83]
    ds_read_b64_tr_b16 v[198:199], v18 offset:45056
    v_mfma_f32_16x16x32_bf16 v[84:87], a[144:147], v[164:167], v[84:87]
    ds_read_b64_tr_b16 v[200:201], v19 offset:40960
    v_mfma_f32_16x16x32_bf16 v[88:91], a[148:151], v[164:167], v[88:91]
    ds_read_b64_tr_b16 v[202:203], v19 offset:45056
    v_mfma_f32_16x16x32_bf16 v[92:95], a[152:155], v[164:167], v[92:95]
    ds_read_b64_tr_b16 v[204:205], v20 offset:40960
    v_mfma_f32_16x16x32_bf16 v[96:99], a[144:147], v[168:171], v[96:99]
    ds_read_b64_tr_b16 v[206:207], v20 offset:45056
    v_mfma_f32_16x16x32_bf16 v[100:103], a[148:151], v[168:171], v[100:103]
    ds_read_b64_tr_b16 v[208:209], v21 offset:40960
    v_mfma_f32_16x16x32_bf16 v[104:107], a[152:155], v[168:171], v[104:107]
    ds_read_b64_tr_b16 v[210:211], v21 offset:45056
    v_mfma_f32_16x16x32_bf16 v[108:111], a[144:147], v[172:175], v[108:111]
    ds_read_b64_tr_b16 v[212:213], v22 offset:40960
    v_mfma_f32_16x16x32_bf16 v[112:115], a[148:151], v[172:175], v[112:115]
    ds_read_b64_tr_b16 v[214:215], v22 offset:45056
    v_mfma_f32_16x16x32_bf16 v[116:119], a[152:155], v[172:175], v[116:119]
    ds_read_b64_tr_b16 v[216:217], v23 offset:40960
    v_mfma_f32_16x16x32_bf16 v[120:123], a[144:147], v[176:179], v[120:123]
    ds_read_b64_tr_b16 v[218:219], v23 offset:45056
    v_mfma_f32_16x16x32_bf16 v[124:127], a[148:151], v[176:179], v[124:127]
    buffer_load_dwordx4 a[104:107], v9, s[48:51], s52 offen offset:2048 sc1
    v_mfma_f32_16x16x32_bf16 v[128:131], a[152:155], v[176:179], v[128:131]
    v_mfma_f32_16x16x32_bf16 v[132:135], a[144:147], v[180:183], v[132:135]
    v_mfma_f32_16x16x32_bf16 v[136:139], a[148:151], v[180:183], v[136:139]
    buffer_load_dwordx4 a[108:111], v9, s[48:51], s52 offen offset:3072 sc1
    s_add_u32 s52, s52, 4096
    v_mfma_f32_16x16x32_bf16 v[140:143], a[152:155], v[180:183], v[140:143]
    v_mfma_f32_16x16x32_bf16 v[144:147], a[144:147], v[184:187], v[144:147]
    buffer_load_dwordx4 v[224:227], v10, s[16:19], s27 offen sc1
    v_mfma_f32_16x16x32_bf16 v[148:151], a[148:151], v[184:187], v[148:151]
    buffer_load_dwordx4 a[112:115], v9, s[48:51], s52 offen offset:0 sc1
    v_mfma_f32_16x16x32_bf16 v[152:155], a[152:155], v[184:187], v[152:155]
    buffer_load_dwordx4 v[228:231], v10, s[16:19], s30 offen sc1
    s_waitcnt lgkmcnt(0)
    v_mfma_f32_16x16x32_bf16 v[60:63], a[156:159], v[188:191], v[60:63]
    s_waitcnt vmcnt(26)
    s_barrier
    ds_read_b64_tr_b16 v[156:157], v16 offset:49152
    v_mfma_f32_16x16x32_bf16 v[64:67], a[160:163], v[188:191], v[64:67]
    ds_read_b64_tr_b16 v[158:159], v16 offset:53248
    v_mfma_f32_16x16x32_bf16 v[68:71], a[164:167], v[188:191], v[68:71]
    ds_read_b64_tr_b16 v[160:161], v17 offset:49152
    v_mfma_f32_16x16x32_bf16 v[72:75], a[156:159], v[192:195], v[72:75]
    ds_read_b64_tr_b16 v[162:163], v17 offset:53248
    v_mfma_f32_16x16x32_bf16 v[76:79], a[160:163], v[192:195], v[76:79]
    ds_read_b64_tr_b16 v[164:165], v18 offset:49152
    v_mfma_f32_16x16x32_bf16 v[80:83], a[164:167], v[192:195], v[80:83]
    ds_read_b64_tr_b16 v[166:167], v18 offset:53248
    v_mfma_f32_16x16x32_bf16 v[84:87], a[156:159], v[196:199], v[84:87]
    ds_read_b64_tr_b16 v[168:169], v19 offset:49152
    v_mfma_f32_16x16x32_bf16 v[88:91], a[160:163], v[196:199], v[88:91]
    ds_read_b64_tr_b16 v[170:171], v19 offset:53248
    v_mfma_f32_16x16x32_bf16 v[92:95], a[164:167], v[196:199], v[92:95]
    ds_read_b64_tr_b16 v[172:173], v20 offset:49152
    v_mfma_f32_16x16x32_bf16 v[96:99], a[156:159], v[200:203], v[96:99]
    ds_read_b64_tr_b16 v[174:175], v20 offset:53248
    v_mfma_f32_16x16x32_bf16 v[100:103], a[160:163], v[200:203], v[100:103]
    ds_read_b64_tr_b16 v[176:177], v21 offset:49152
    v_mfma_f32_16x16x32_bf16 v[104:107], a[164:167], v[200:203], v[104:107]
    ds_read_b64_tr_b16 v[178:179], v21 offset:53248
    v_mfma_f32_16x16x32_bf16 v[108:111], a[156:159], v[204:207], v[108:111]
    ds_read_b64_tr_b16 v[180:181], v22 offset:49152
    v_mfma_f32_16x16x32_bf16 v[112:115], a[160:163], v[204:207], v[112:115]
    ds_read_b64_tr_b16 v[182:183], v22 offset:53248
    v_mfma_f32_16x16x32_bf16 v[116:119], a[164:167], v[204:207], v[116:119]
    ds_read_b64_tr_b16 v[184:185], v23 offset:49152
    v_mfma_f32_16x16x32_bf16 v[120:123], a[156:159], v[208:211], v[120:123]
    ds_read_b64_tr_b16 v[186:187], v23 offset:53248
    v_mfma_f32_16x16x32_bf16 v[124:127], a[160:163], v[208:211], v[124:127]
    buffer_load_dwordx4 a[116:119], v9, s[48:51], s52 offen offset:1024 sc1
    v_mfma_f32_16x16x32_bf16 v[128:131], a[164:167], v[208:211], v[128:131]
    v_mfma_f32_16x16x32_bf16 v[132:135], a[156:159], v[212:215], v[132:135]
    v_mfma_f32_16x16x32_bf16 v[136:139], a[160:163], v[212:215], v[136:139]
    buffer_load_dwordx4 a[120:123], v9, s[48:51], s52 offen offset:2048 sc1
    v_mfma_f32_16x16x32_bf16 v[140:143], a[164:167], v[212:215], v[140:143]
    v_mfma_f32_16x16x32_bf16 v[144:147], a[156:159], v[216:219], v[144:147]
    buffer_load_dwordx4 v[232:235], v10, s[16:19], s38 offen sc1
    v_mfma_f32_16x16x32_bf16 v[148:151], a[160:163], v[216:219], v[148:151]
    buffer_load_dwordx4 a[124:127], v9, s[48:51], s52 offen offset:3072 sc1
    s_add_u32 s52, s52, 4096
    v_mfma_f32_16x16x32_bf16 v[152:155], a[164:167], v[216:219], v[152:155]
    buffer_load_dwordx4 a[128:131], v9, s[48:51], s52 offen offset:0 sc1
    buffer_load_dwordx4 v[236:239], v10, s[16:19], s45 offen sc1
    s_waitcnt lgkmcnt(0)
    v_mfma_f32_16x16x32_bf16 v[60:63], a[168:171], v[156:159], v[60:63]
    ds_read_b64_tr_b16 v[188:189], v16 offset:57344
    v_mfma_f32_16x16x32_bf16 v[64:67], a[172:175], v[156:159], v[64:67]
    ds_read_b64_tr_b16 v[190:191], v16 offset:61440
    v_mfma_f32_16x16x32_bf16 v[68:71], a[176:179], v[156:159], v[68:71]
    ds_read_b64_tr_b16 v[192:193], v17 offset:57344
    v_mfma_f32_16x16x32_bf16 v[72:75], a[168:171], v[160:163], v[72:75]
    ds_read_b64_tr_b16 v[194:195], v17 offset:61440
    v_mfma_f32_16x16x32_bf16 v[76:79], a[172:175], v[160:163], v[76:79]
    ds_read_b64_tr_b16 v[196:197], v18 offset:57344
    v_mfma_f32_16x16x32_bf16 v[80:83], a[176:179], v[160:163], v[80:83]
    ds_read_b64_tr_b16 v[198:199], v18 offset:61440
    v_mfma_f32_16x16x32_bf16 v[84:87], a[168:171], v[164:167], v[84:87]
    ds_read_b64_tr_b16 v[200:201], v19 offset:57344
    v_mfma_f32_16x16x32_bf16 v[88:91], a[172:175], v[164:167], v[88:91]
    ds_read_b64_tr_b16 v[202:203], v19 offset:61440
    v_mfma_f32_16x16x32_bf16 v[92:95], a[176:179], v[164:167], v[92:95]
    ds_read_b64_tr_b16 v[204:205], v20 offset:57344
    v_mfma_f32_16x16x32_bf16 v[96:99], a[168:171], v[168:171], v[96:99]
    ds_read_b64_tr_b16 v[206:207], v20 offset:61440
    v_mfma_f32_16x16x32_bf16 v[100:103], a[172:175], v[168:171], v[100:103]
    ds_read_b64_tr_b16 v[208:209], v21 offset:57344
    v_mfma_f32_16x16x32_bf16 v[104:107], a[176:179], v[168:171], v[104:107]
    ds_read_b64_tr_b16 v[210:211], v21 offset:61440
    v_mfma_f32_16x16x32_bf16 v[108:111], a[168:171], v[172:175], v[108:111]
    ds_read_b64_tr_b16 v[212:213], v22 offset:57344
    v_mfma_f32_16x16x32_bf16 v[112:115], a[172:175], v[172:175], v[112:115]
    ds_read_b64_tr_b16 v[214:215], v22 offset:61440
    v_mfma_f32_16x16x32_bf16 v[116:119], a[176:179], v[172:175], v[116:119]
    ds_read_b64_tr_b16 v[216:217], v23 offset:57344
    v_mfma_f32_16x16x32_bf16 v[120:123], a[168:171], v[176:179], v[120:123]
    ds_read_b64_tr_b16 v[218:219], v23 offset:61440
    v_mfma_f32_16x16x32_bf16 v[124:127], a[172:175], v[176:179], v[124:127]
    buffer_load_dwordx4 a[132:135], v9, s[48:51], s52 offen offset:1024 sc1
    v_mfma_f32_16x16x32_bf16 v[128:131], a[176:179], v[176:179], v[128:131]
    s_waitcnt vmcnt(12)
    v_cmp_ne_u32 vcc, s59, v7
    s_cbranch_vccnz G1_P
G1_PC:
    v_mfma_f32_16x16x32_bf16 v[132:135], a[168:171], v[180:183], v[132:135]
    v_mfma_f32_16x16x32_bf16 v[136:139], a[172:175], v[180:183], v[136:139]
    buffer_load_dwordx4 a[136:139], v9, s[48:51], s52 offen offset:2048 sc1
    v_mfma_f32_16x16x32_bf16 v[140:143], a[176:179], v[180:183], v[140:143]
    v_mfma_f32_16x16x32_bf16 v[144:147], a[168:171], v[184:187], v[144:147]
    v_mfma_f32_16x16x32_bf16 v[148:151], a[172:175], v[184:187], v[148:151]
    buffer_load_dwordx4 a[140:143], v9, s[48:51], s52 offen offset:3072 sc1
    s_add_u32 s52, s52, 4096
    v_mfma_f32_16x16x32_bf16 v[152:155], a[176:179], v[184:187], v[152:155]
    buffer_load_dwordx4 a[144:147], v9, s[48:51], s52 offen offset:0 sc1
    s_waitcnt lgkmcnt(0)
    v_mfma_f32_16x16x32_bf16 v[60:63], a[180:183], v[188:191], v[60:63]
    s_waitcnt vmcnt(27)
    s_barrier
    v_add_u32 v16, 0x10000, v16
    ds_read_b64_tr_b16 v[156:157], v16 offset:0
    v_mfma_f32_16x16x32_bf16 v[64:67], a[184:187], v[188:191], v[64:67]
    ds_read_b64_tr_b16 v[158:159], v16 offset:4096
    v_mfma_f32_16x16x32_bf16 v[68:71], a[188:191], v[188:191], v[68:71]
    v_add_u32 v17, 0x10000, v17
    ds_read_b64_tr_b16 v[160:161], v17 offset:0
    v_mfma_f32_16x16x32_bf16 v[72:75], a[180:183], v[192:195], v[72:75]
    ds_read_b64_tr_b16 v[162:163], v17 offset:4096
    v_mfma_f32_16x16x32_bf16 v[76:79], a[184:187], v[192:195], v[76:79]
    v_add_u32 v18, 0x10000, v18
    ds_read_b64_tr_b16 v[164:165], v18 offset:0
    v_mfma_f32_16x16x32_bf16 v[80:83], a[188:191], v[192:195], v[80:83]
    ds_read_b64_tr_b16 v[166:167], v18 offset:4096
    v_mfma_f32_16x16x32_bf16 v[84:87], a[180:183], v[196:199], v[84:87]
    v_add_u32 v19, 0x10000, v19
    ds_read_b64_tr_b16 v[168:169], v19 offset:0
    v_mfma_f32_16x16x32_bf16 v[88:91], a[184:187], v[196:199], v[88:91]
    ds_read_b64_tr_b16 v[170:171], v19 offset:4096
    v_mfma_f32_16x16x32_bf16 v[92:95], a[188:191], v[196:199], v[92:95]
    v_add_u32 v20, 0x10000, v20
    ds_read_b64_tr_b16 v[172:173], v20 offset:0
    v_mfma_f32_16x16x32_bf16 v[96:99], a[180:183], v[200:203], v[96:99]
    ds_read_b64_tr_b16 v[174:175], v20 offset:4096
    v_mfma_f32_16x16x32_bf16 v[100:103], a[184:187], v[200:203], v[100:103]
    v_add_u32 v21, 0x10000, v21
    ds_read_b64_tr_b16 v[176:177], v21 offset:0
    v_mfma_f32_16x16x32_bf16 v[104:107], a[188:191], v[200:203], v[104:107]
    ds_read_b64_tr_b16 v[178:179], v21 offset:4096
    v_mfma_f32_16x16x32_bf16 v[108:111], a[180:183], v[204:207], v[108:111]
    v_add_u32 v22, 0x10000, v22
    ds_read_b64_tr_b16 v[180:181], v22 offset:0
    v_mfma_f32_16x16x32_bf16 v[112:115], a[184:187], v[204:207], v[112:115]
    ds_read_b64_tr_b16 v[182:183], v22 offset:4096
    v_mfma_f32_16x16x32_bf16 v[116:119], a[188:191], v[204:207], v[116:119]
    v_add_u32 v23, 0x10000, v23
    ds_read_b64_tr_b16 v[184:185], v23 offset:0
    v_mfma_f32_16x16x32_bf16 v[120:123], a[180:183], v[208:211], v[120:123]
    ds_read_b64_tr_b16 v[186:187], v23 offset:4096
    v_mfma_f32_16x16x32_bf16 v[124:127], a[184:187], v[208:211], v[124:127]
    buffer_load_dwordx4 a[148:151], v9, s[48:51], s52 offen offset:1024 sc1
    v_mfma_f32_16x16x32_bf16 v[128:131], a[188:191], v[208:211], v[128:131]
    v_mfma_f32_16x16x32_bf16 v[132:135], a[180:183], v[212:215], v[132:135]
    buffer_load_dwordx4 v[44:47], v9, s[16:19], s22 offen offset:0 sc1
    v_mfma_f32_16x16x32_bf16 v[136:139], a[184:187], v[212:215], v[136:139]
    buffer_load_dwordx4 a[152:155], v9, s[48:51], s52 offen offset:2048 sc1
    v_mfma_f32_16x16x32_bf16 v[140:143], a[188:191], v[212:215], v[140:143]
    buffer_load_dwordx4 v[48:51], v9, s[16:19], s22 offen offset:1024 sc1
    v_mfma_f32_16x16x32_bf16 v[144:147], a[180:183], v[216:219], v[144:147]
    v_mfma_f32_16x16x32_bf16 v[148:151], a[184:187], v[216:219], v[148:151]
    buffer_load_dwordx4 a[156:159], v9, s[48:51], s52 offen offset:3072 sc1
    s_add_u32 s52, s52, 4096
    s_cmp_eq_u32 s52, s53
    s_cselect_b32 s52, s54, s52
    v_mfma_f32_16x16x32_bf16 v[152:155], a[188:191], v[216:219], v[152:155]
    buffer_load_dwordx4 a[160:163], v9, s[48:51], s52 offen offset:0 sc1
    s_waitcnt lgkmcnt(0)
    v_mfma_f32_16x16x32_bf16 v[60:63], a[192:195], v[156:159], v[60:63]
    ds_read_b64_tr_b16 v[188:189], v16 offset:8192
    v_mfma_f32_16x16x32_bf16 v[64:67], a[196:199], v[156:159], v[64:67]
    ds_read_b64_tr_b16 v[190:191], v16 offset:12288
    s_waitcnt vmcnt(10)
    v_mfma_f32_16x16x32_bf16 v[68:71], a[200:203], v[156:159], v[68:71]
    ds_read_b64_tr_b16 v[192:193], v17 offset:8192
    v_sad_u32 v2, v225, s59, 0
    v_mfma_f32_16x16x32_bf16 v[72:75], a[192:195], v[160:163], v[72:75]
    ds_read_b64_tr_b16 v[194:195], v17 offset:12288
    v_sad_u32 v2, v227, s59, v2 clamp
    v_mfma_f32_16x16x32_bf16 v[76:79], a[196:199], v[160:163], v[76:79]
    ds_read_b64_tr_b16 v[196:197], v18 offset:8192
    v_sad_u32 v2, v229, s59, v2 clamp
    v_mfma_f32_16x16x32_bf16 v[80:83], a[200:203], v[160:163], v[80:83]
    ds_read_b64_tr_b16 v[198:199], v18 offset:12288
    v_sad_u32 v2, v231, s59, v2 clamp
    v_mfma_f32_16x16x32_bf16 v[84:87], a[192:195], v[164:167], v[84:87]
    ds_read_b64_tr_b16 v[200:201], v19 offset:8192
    v_sad_u32 v2, v233, s59, v2 clamp
    v_mfma_f32_16x16x32_bf16 v[88:91], a[196:199], v[164:167], v[88:91]
    ds_read_b64_tr_b16 v[202:203], v19 offset:12288
    v_sad_u32 v2, v235, s59, v2 clamp
PAD_B1:
    s_cbranch_execz RET_B
    v_mfma_f32_16x16x32_bf16 v[92:95], a[200:203], v[164:167], v[92:95]
    ds_read_b64_tr_b16 v[204:205], v20 offset:8192
    v_sad_u32 v2, v237, s59, v2 clamp
    v_mfma_f32_16x16x32_bf16 v[96:99], a[192:195], v[168:171], v[96:99]
    ds_read_b64_tr_b16 v[206:207], v20 offset:12288
    v_sad_u32 v2, v239, s59, v2 clamp
    v_mfma_f32_16x16x32_bf16 v[100:103], a[196:199], v[168:171], v[100:103]
    ds_read_b64_tr_b16 v[208:209], v21 offset:8192
    v_cmp_ne_u32 vcc, 0, v2
    v_mfma_f32_16x16x32_bf16 v[104:107], a[200:203], v[168:171], v[104:107]
    ds_read_b64_tr_b16 v[210:211], v21 offset:12288
    s_cbranch_vccnz G1_Q
G1_QC:
    v_mfma_f32_16x16x32_bf16 v[108:111], a[192:195], v[172:175], v[108:111]
    ds_read_b64_tr_b16 v[212:213], v22 offset:8192
    v_mfma_f32_16x16x32_bf16 v[112:115], a[196:199], v[172:175], v[112:115]
    ds_read_b64_tr_b16 v[214:215], v22 offset:12288
    v_mfma_f32_16x16x32_bf16 v[116:119], a[200:203], v[172:175], v[116:119]
    ds_read_b64_tr_b16 v[216:217], v23 offset:8192
    v_mfma_f32_16x16x32_bf16 v[120:123], a[192:195], v[176:179], v[120:123]
    ds_read_b64_tr_b16 v[218:219], v23 offset:12288
    v_mfma_f32_16x16x32_bf16 v[124:127], a[196:199], v[176:179], v[124:127]
    buffer_load_dwordx4 a[164:167], v9, s[48:51], s52 offen offset:1024 sc1
    v_mfma_f32_16x16x32_bf16 v[128:131], a[200:203], v[176:179], v[128:131]
    v_mfma_f32_16x16x32_bf16 v[132:135], a[192:195], v[180:183], v[132:135]
    buffer_load_dwordx4 v[52:55], v9, s[16:19], s22 offen offset:2048 sc1
    v_mfma_f32_16x16x32_bf16 v[136:139], a[196:199], v[180:183], v[136:139]
    buffer_load_dwordx4 a[168:171], v9, s[48:51], s52 offen offset:2048 sc1
    v_mfma_f32_16x16x32_bf16 v[140:143], a[200:203], v[180:183], v[140:143]
    buffer_load_dwordx4 v[56:59], v9, s[16:19], s22 offen offset:2048 sc1
    v_mfma_f32_16x16x32_bf16 v[144:147], a[192:195], v[184:187], v[144:147]
    v_mfma_f32_16x16x32_bf16 v[148:151], a[196:199], v[184:187], v[148:151]
    buffer_load_dwordx4 a[172:175], v9, s[48:51], s52 offen offset:3072 sc1
    s_add_u32 s52, s52, 4096
    v_mfma_f32_16x16x32_bf16 v[152:155], a[200:203], v[184:187], v[152:155]
    buffer_load_dwordx4 a[176:179], v9, s[48:51], s52 offen offset:0 sc1
    s_waitcnt lgkmcnt(0)
    v_mfma_f32_16x16x32_bf16 v[60:63], a[204:207], v[188:191], v[60:63]
    s_waitcnt vmcnt(29)
    s_barrier
    ds_read_b64_tr_b16 v[156:157], v16 offset:16384
    v_mfma_f32_16x16x32_bf16 v[64:67], a[208:211], v[188:191], v[64:67]
    ds_read_b64_tr_b16 v[158:159], v16 offset:20480
    v_add_f32 v224, v224, v228
    v_mfma_f32_16x16x32_bf16 v[68:71], a[212:215], v[188:191], v[68:71]
    ds_read_b64_tr_b16 v[160:161], v17 offset:16384
    v_add_f32 v226, v226, v230
    v_mfma_f32_16x16x32_bf16 v[72:75], a[204:207], v[192:195], v[72:75]
    ds_read_b64_tr_b16 v[162:163], v17 offset:20480
    v_add_f32 v232, v232, v236
    v_mfma_f32_16x16x32_bf16 v[76:79], a[208:211], v[192:195], v[76:79]
    ds_read_b64_tr_b16 v[164:165], v18 offset:16384
    v_add_f32 v234, v234, v238
    v_mfma_f32_16x16x32_bf16 v[80:83], a[212:215], v[192:195], v[80:83]
    ds_read_b64_tr_b16 v[166:167], v18 offset:20480
    v_add_f32 v224, v224, v232
    v_mfma_f32_16x16x32_bf16 v[84:87], a[204:207], v[196:199], v[84:87]
    ds_read_b64_tr_b16 v[168:169], v19 offset:16384
    v_add_f32 v226, v226, v234
    v_mfma_f32_16x16x32_bf16 v[88:91], a[208:211], v[196:199], v[88:91]
    ds_read_b64_tr_b16 v[170:171], v19 offset:20480
    v_mov_b32 v225, v224
    v_mfma_f32_16x16x32_bf16 v[92:95], a[212:215], v[196:199], v[92:95]
    ds_read_b64_tr_b16 v[172:173], v20 offset:16384
    v_mov_b32 v227, v226
    v_mfma_f32_16x16x32_bf16 v[96:99], a[204:207], v[200:203], v[96:99]
    ds_read_b64_tr_b16 v[174:175], v20 offset:20480
    v_mfma_f32_16x16x32_bf16 v[100:103], a[208:211], v[200:203], v[100:103]
    ds_read_b64_tr_b16 v[176:177], v21 offset:16384
    v_permlane16_swap_b32 v224, v225
    v_mfma_f32_16x16x32_bf16 v[104:107], a[212:215], v[200:203], v[104:107]
    ds_read_b64_tr_b16 v[178:179], v21 offset:20480
    v_permlane16_swap_b32 v226, v227
    v_mfma_f32_16x16x32_bf16 v[108:111], a[204:207], v[204:207], v[108:111]
    ds_read_b64_tr_b16 v[180:181], v22 offset:16384
    v_mfma_f32_16x16x32_bf16 v[112:115], a[208:211], v[204:207], v[112:115]
    ds_read_b64_tr_b16 v[182:183], v22 offset:20480
    v_add_f32 v224, v224, v225
    v_mfma_f32_16x16x32_bf16 v[116:119], a[212:215], v[204:207], v[116:119]
    ds_read_b64_tr_b16 v[184:185], v23 offset:16384
    v_add_f32 v226, v226, v227
    v_mfma_f32_16x16x32_bf16 v[120:123], a[204:207], v[208:211], v[120:123]
    ds_read_b64_tr_b16 v[186:187], v23 offset:20480
    s_cmp_lg_u32 s6, 0
    s_cbranch_scc1 G1_LS
G1_LSC:
    v_mfma_f32_16x16x32_bf16 v[124:127], a[208:211], v[208:211], v[124:127]
    buffer_load_dwordx4 a[180:183], v9, s[48:51], s52 offen offset:1024 sc1
    v_mfma_f32_16x16x32_bf16 v[128:131], a[212:215], v[208:211], v[128:131]
    s_add_u32 m0, s47, 8192
    v_mfma_f32_16x16x32_bf16 v[132:135], a[204:207], v[212:215], v[132:135]
    buffer_load_dwordx4 v6, s[8:11], s46 offen sc1 lds
    s_add_u32 s46, s46, 32768
    v_mfma_f32_16x16x32_bf16 v[136:139], a[208:211], v[212:215], v[136:139]
    buffer_load_dwordx4 a[184:187], v9, s[48:51], s52 offen offset:2048 sc1
    v_mfma_f32_16x16x32_bf16 v[140:143], a[212:215], v[212:215], v[140:143]
    s_add_u32 m0, s47, 9216
    v_mfma_f32_16x16x32_bf16 v[144:147], a[204:207], v[216:219], v[144:147]
    buffer_load_dwordx4 v6, s[8:11], s46 offen sc1 lds
    s_add_u32 s46, s46, 32768
    v_mfma_f32_16x16x32_bf16 v[148:151], a[208:211], v[216:219], v[148:151]
    buffer_load_dwordx4 a[188:191], v9, s[48:51], s52 offen offset:3072 sc1
    s_add_u32 s52, s52, 4096
    v_mfma_f32_16x16x32_bf16 v[152:155], a[212:215], v[216:219], v[152:155]
    buffer_load_dwordx4 a[192:195], v9, s[48:51], s52 offen offset:0 sc1
    s_waitcnt lgkmcnt(0)
    v_mfma_f32_16x16x32_bf16 v[60:63], a[216:219], v[156:159], v[60:63]
    ds_read_b64_tr_b16 v[188:189], v16 offset:24576
    v_mfma_f32_16x16x32_bf16 v[64:67], a[220:223], v[156:159], v[64:67]
    ds_read_b64_tr_b16 v[190:191], v16 offset:28672
    v_mul_f32 v224, 0x3acccccd, v224
    v_mfma_f32_16x16x32_bf16 v[68:71], a[224:227], v[156:159], v[68:71]
    ds_read_b64_tr_b16 v[192:193], v17 offset:24576
    v_mul_f32 v226, 0x3acccccd, v226
    v_mfma_f32_16x16x32_bf16 v[72:75], a[216:219], v[160:163], v[72:75]
    ds_read_b64_tr_b16 v[194:195], v17 offset:28672
    v_cvt_pk_bf16_f32 v242, 0, v224
    v_mfma_f32_16x16x32_bf16 v[76:79], a[220:223], v[160:163], v[76:79]
    ds_read_b64_tr_b16 v[196:197], v18 offset:24576
    v_fma_f32 v226, -v224, v224, v226
    v_mfma_f32_16x16x32_bf16 v[80:83], a[224:227], v[160:163], v[80:83]
    ds_read_b64_tr_b16 v[198:199], v18 offset:28672
    v_max_f32 v226, 0, v226
    v_mfma_f32_16x16x32_bf16 v[84:87], a[216:219], v[164:167], v[84:87]
    ds_read_b64_tr_b16 v[200:201], v19 offset:24576
    v_cvt_pk_bf16_f32 v226, 0, v226
    v_mfma_f32_16x16x32_bf16 v[88:91], a[220:223], v[164:167], v[88:91]
    ds_read_b64_tr_b16 v[202:203], v19 offset:28672
    v_add_f32 v226, 0x3727c5ac, v226
    v_mfma_f32_16x16x32_bf16 v[92:95], a[224:227], v[164:167], v[92:95]
    ds_read_b64_tr_b16 v[204:205], v20 offset:24576
    v_cvt_pk_bf16_f32 v226, 0, v226
    v_mfma_f32_16x16x32_bf16 v[96:99], a[216:219], v[168:171], v[96:99]
    ds_read_b64_tr_b16 v[206:207], v20 offset:28672
    v_sqrt_f32 v226, v226
    v_mfma_f32_16x16x32_bf16 v[100:103], a[220:223], v[168:171], v[100:103]
    ds_read_b64_tr_b16 v[208:209], v21 offset:24576
    v_cvt_pk_bf16_f32 v226, 0, v226
    v_mfma_f32_16x16x32_bf16 v[104:107], a[224:227], v[168:171], v[104:107]
    ds_read_b64_tr_b16 v[210:211], v21 offset:28672
    v_rcp_f32 v240, v226
    v_mfma_f32_16x16x32_bf16 v[108:111], a[216:219], v[172:175], v[108:111]
    ds_read_b64_tr_b16 v[212:213], v22 offset:24576
    v_mul_f32 v243, v226, v226
    v_mfma_f32_16x16x32_bf16 v[112:115], a[220:223], v[172:175], v[112:115]
    ds_read_b64_tr_b16 v[214:215], v22 offset:28672
    v_mul_f32 v241, v240, v240
    v_mfma_f32_16x16x32_bf16 v[116:119], a[224:227], v[172:175], v[116:119]
    ds_read_b64_tr_b16 v[216:217], v23 offset:24576
    v_mul_f32 v241, v241, v240
    v_mfma_f32_16x16x32_bf16 v[120:123], a[216:219], v[176:179], v[120:123]
    ds_read_b64_tr_b16 v[218:219], v23 offset:28672
    v_mul_f32 v240, 0xc0135761, v240
    v_mfma_f32_16x16x32_bf16 v[124:127], a[220:223], v[176:179], v[124:127]
    buffer_load_dwordx4 a[196:199], v9, s[48:51], s52 offen offset:1024 sc1
    v_mfma_f32_16x16x32_bf16 v[128:131], a[224:227], v[176:179], v[128:131]
    s_add_u32 m0, s47, 10240
    v_mfma_f32_16x16x32_bf16 v[132:135], a[216:219], v[180:183], v[132:135]
    buffer_load_dwordx4 v6, s[8:11], s46 offen sc1 lds
    s_add_u32 s46, s46, 32768
    v_mfma_f32_16x16x32_bf16 v[136:139], a[220:223], v[180:183], v[136:139]
    buffer_load_dwordx4 a[200:203], v9, s[48:51], s52 offen offset:2048 sc1
    v_mfma_f32_16x16x32_bf16 v[140:143], a[224:227], v[180:183], v[140:143]
    v_mul_f32 v241, 0xbdd2d3e8, v241
    v_mfma_f32_16x16x32_bf16 v[144:147], a[216:219], v[184:187], v[144:147]
    v_mfma_f32_16x16x32_bf16 v[148:151], a[220:223], v[184:187], v[148:151]
    buffer_load_dwordx4 a[204:207], v9, s[48:51], s52 offen offset:3072 sc1
    s_add_u32 s52, s52, 4096
    v_mfma_f32_16x16x32_bf16 v[152:155], a[224:227], v[184:187], v[152:155]
    buffer_load_dwordx4 a[208:211], v9, s[48:51], s52 offen offset:0 sc1
    s_waitcnt lgkmcnt(0)
    v_mfma_f32_16x16x32_bf16 v[68:71], a[236:239], v[188:191], v[68:71]
    v_xor_b32 v17, 512, v24
    v_xor_b32 v21, 512, v25
    v_mfma_f32_16x16x32_bf16 v[80:83], a[236:239], v[192:195], v[80:83]
    v_xor_b32 v18, 1024, v24
    v_xor_b32 v22, 1024, v25
    v_mfma_f32_16x16x32_bf16 v[92:95], a[236:239], v[196:199], v[92:95]
    v_xor_b32 v19, 1536, v24
    v_xor_b32 v23, 1536, v25
    v_mfma_f32_16x16x32_bf16 v[104:107], a[236:239], v[200:203], v[104:107]
    buffer_load_dwordx4 a[212:215], v9, s[48:51], s52 offen offset:1024 sc1
    v_mfma_f32_16x16x32_bf16 v[116:119], a[236:239], v[204:207], v[116:119]
    buffer_load_dwordx4 a[216:219], v9, s[48:51], s52 offen offset:2048 sc1
    v_mfma_f32_16x16x32_bf16 v[128:131], a[236:239], v[208:211], v[128:131]
    buffer_load_dwordx4 a[220:223], v9, s[48:51], s52 offen offset:3072 sc1
    s_add_u32 s52, s52, 4096
    v_mfma_f32_16x16x32_bf16 v[140:143], a[236:239], v[212:215], v[140:143]
    s_waitcnt vmcnt(16)
    v_fma_f32 v2, v68, v80, v92
    v_mfma_f32_16x16x32_bf16 v[152:155], a[236:239], v[216:219], v[152:155]
    v_permlane32_swap_b32 v52, v56
    v_mfma_f32_16x16x32_bf16 v[60:63], a[228:231], v[188:191], v[60:63]
    v_permlane32_swap_b32 v53, v57
    v_mfma_f32_16x16x32_bf16 v[72:75], a[228:231], v[192:195], v[72:75]
    v_fma_f32 v2, v104, v116, v2
    v_permlane32_swap_b32 v54, v58
    v_mfma_f32_16x16x32_bf16 v[84:87], a[228:231], v[196:199], v[84:87]
    v_fma_f32 v2, v128, v140, v2
    v_permlane32_swap_b32 v55, v59
    v_mfma_f32_16x16x32_bf16 v[96:99], a[228:231], v[200:203], v[96:99]
    v_add_f32 v2, v152, v2
    v_fma_f32 v242, v2, 0, v242
    v_mfma_f32_16x16x32_bf16 v[108:111], a[228:231], v[204:207], v[108:111]
    ds_write_b128 v15, v[240:243]
    v_mfma_f32_16x16x32_bf16 v[120:123], a[228:231], v[208:211], v[120:123]
    v_permlane32_swap_b32 v68, v80
    v_mfma_f32_16x16x32_bf16 v[132:135], a[228:231], v[212:215], v[132:135]
    s_waitcnt lgkmcnt(0)
    s_barrier
    v_mfma_f32_16x16x32_bf16 v[144:147], a[228:231], v[216:219], v[144:147]
    ds_read_b128 v[156:159], v24
    ds_read_b128 v[160:163], v24 offset:256
    v_mfma_f32_16x16x32_bf16 v[64:67], a[232:235], v[188:191], v[64:67]
    ds_read_b128 v[28:31], v25
    ds_read_b128 v[164:167], v17
    v_mfma_f32_16x16x32_bf16 v[76:79], a[232:235], v[192:195], v[76:79]
    ds_read_b128 v[168:171], v17 offset:256
    ds_read_b128 v[32:35], v21
    v_mfma_f32_16x16x32_bf16 v[88:91], a[232:235], v[196:199], v[88:91]
    ds_read_b128 v[172:175], v18
    ds_read_b128 v[176:179], v18 offset:256
    v_mfma_f32_16x16x32_bf16 v[100:103], a[232:235], v[200:203], v[100:103]
    ds_read_b128 v[36:39], v22
    ds_read_b128 v[180:183], v19
    v_mfma_f32_16x16x32_bf16 v[112:115], a[232:235], v[204:207], v[112:115]
    ds_read_b128 v[184:187], v19 offset:256
    ds_read_b128 v[40:43], v23
    v_mfma_f32_16x16x32_bf16 v[124:127], a[232:235], v[208:211], v[124:127]
    v_permlane32_swap_b32 v69, v81
    v_mfma_f32_16x16x32_bf16 v[136:139], a[232:235], v[212:215], v[136:139]
    v_permlane32_swap_b32 v70, v82
    v_mfma_f32_16x16x32_bf16 v[148:151], a[232:235], v[216:219], v[148:151]
    v_permlane32_swap_b32 v71, v83
    v_permlane32_swap_b32 v92, v104
    v_permlane32_swap_b32 v93, v105
    v_permlane32_swap_b32 v94, v106
    v_permlane32_swap_b32 v95, v107
    buffer_load_dwordx4 a[224:227], v9, s[48:51], s52 offen offset:0 sc1
    buffer_load_dwordx4 a[228:231], v9, s[48:51], s52 offen offset:1024 sc1
    buffer_load_dwordx4 a[232:235], v9, s[48:51], s52 offen offset:2048 sc1
    buffer_load_dwordx4 a[236:239], v9, s[48:51], s52 offen offset:3072 sc1
    v_permlane32_swap_b32 v116, v128
    v_permlane32_swap_b32 v117, v129
    v_permlane32_swap_b32 v118, v130
    v_permlane32_swap_b32 v119, v131
    v_permlane32_swap_b32 v140, v152
    v_permlane32_swap_b32 v141, v153
    v_permlane32_swap_b32 v142, v154
    v_permlane32_swap_b32 v143, v155
    s_waitcnt lgkmcnt(0)
    v_fma_f32 v2, v158, v162, v166
    v_fma_f32 v3, v170, v174, v178
    v_fma_f32 v2, v182, v186, v2
    v_cmp_u_f32 vcc, v2, v3
    s_cbranch_vccnz G1_REDO
G1_CONT:
    v_pk_fma_f32 v[60:61], v[158:159], v[44:45], v[60:61] op_sel_hi:[0,1,1] neg_lo:[1,0,0] neg_hi:[1,0,0]
    v_pk_fma_f32 v[62:63], v[158:159], v[46:47], v[62:63] op_sel_hi:[0,1,1] neg_lo:[1,0,0] neg_hi:[1,0,0]
    v_pk_fma_f32 v[72:73], v[162:163], v[44:45], v[72:73] op_sel_hi:[0,1,1] neg_lo:[1,0,0] neg_hi:[1,0,0]
    v_pk_fma_f32 v[74:75], v[162:163], v[46:47], v[74:75] op_sel_hi:[0,1,1] neg_lo:[1,0,0] neg_hi:[1,0,0]
    v_pk_fma_f32 v[68:69], v[30:31], v[52:53], v[68:69] op_sel_hi:[0,1,1] neg_lo:[1,0,0] neg_hi:[1,0,0]
    v_pk_fma_f32 v[70:71], v[30:31], v[54:55], v[70:71] op_sel_hi:[0,1,1] neg_lo:[1,0,0] neg_hi:[1,0,0]
    v_pk_mul_f32 v[220:221], v[60:61], v[60:61]
    v_pk_mul_f32 v[222:223], v[62:63], v[62:63]
    v_pk_mul_f32 v[224:225], v[72:73], v[72:73]
    v_pk_mul_f32 v[226:227], v[74:75], v[74:75]
    v_pk_mul_f32 v[228:229], v[68:69], v[68:69]
    v_pk_mul_f32 v[230:231], v[70:71], v[70:71]
    v_pk_fma_f32 v[220:221], v[220:221], v[156:157], v[156:157] op_sel:[0,1,0] op_sel_hi:[1,1,0]
    v_pk_fma_f32 v[222:223], v[222:223], v[156:157], v[156:157] op_sel:[0,1,0] op_sel_hi:[1,1,0]
    v_pk_fma_f32 v[224:225], v[224:225], v[160:161], v[160:161] op_sel:[0,1,0] op_sel_hi:[1,1,0]
    v_pk_fma_f32 v[226:227], v[226:227], v[160:161], v[160:161] op_sel:[0,1,0] op_sel_hi:[1,1,0]
    v_pk_fma_f32 v[228:229], v[228:229], v[28:29], v[28:29] op_sel:[0,1,0] op_sel_hi:[1,1,0]
    v_pk_fma_f32 v[230:231], v[230:231], v[28:29], v[28:29] op_sel:[0,1,0] op_sel_hi:[1,1,0]
    v_pk_mul_f32 v[220:221], v[220:221], v[60:61]
    v_pk_mul_f32 v[222:223], v[222:223], v[62:63]
    v_pk_mul_f32 v[224:225], v[224:225], v[72:73]
    v_pk_mul_f32 v[226:227], v[226:227], v[74:75]
    v_pk_mul_f32 v[228:229], v[228:229], v[68:69]
    v_pk_mul_f32 v[230:231], v[230:231], v[70:71]
    v_exp_f32 v220, v220
    v_exp_f32 v221, v221
    v_pk_fma_f32 v[64:65], v[158:159], v[48:49], v[64:65] op_sel_hi:[0,1,1] neg_lo:[1,0,0] neg_hi:[1,0,0]
    v_exp_f32 v222, v222
    v_exp_f32 v223, v223
    v_pk_fma_f32 v[66:67], v[158:159], v[50:51], v[66:67] op_sel_hi:[0,1,1] neg_lo:[1,0,0] neg_hi:[1,0,0]
    v_exp_f32 v224, v224
    v_exp_f32 v225, v225
    v_pk_fma_f32 v[76:77], v[162:163], v[48:49], v[76:77] op_sel_hi:[0,1,1] neg_lo:[1,0,0] neg_hi:[1,0,0]
    v_exp_f32 v226, v226
    v_exp_f32 v227, v227
    v_pk_fma_f32 v[78:79], v[162:163], v[50:51], v[78:79] op_sel_hi:[0,1,1] neg_lo:[1,0,0] neg_hi:[1,0,0]
    v_exp_f32 v228, v228
    v_exp_f32 v229, v229
    v_pk_fma_f32 v[80:81], v[30:31], v[56:57], v[80:81] op_sel_hi:[0,1,1] neg_lo:[1,0,0] neg_hi:[1,0,0]
    v_exp_f32 v230, v230
    v_exp_f32 v231, v231
    v_pk_fma_f32 v[82:83], v[30:31], v[58:59], v[82:83] op_sel_hi:[0,1,1] neg_lo:[1,0,0] neg_hi:[1,0,0]
    v_pk_fma_f32 v[220:221], v[220:221], v[158:159], v[158:159] op_sel:[0,1,1] op_sel_hi:[1,1,1]
    v_pk_fma_f32 v[222:223], v[222:223], v[158:159], v[158:159] op_sel:[0,1,1] op_sel_hi:[1,1,1]
    v_pk_fma_f32 v[224:225], v[224:225], v[162:163], v[162:163] op_sel:[0,1,1] op_sel_hi:[1,1,1]
    v_pk_fma_f32 v[226:227], v[226:227], v[162:163], v[162:163] op_sel:[0,1,1] op_sel_hi:[1,1,1]
    v_pk_fma_f32 v[228:229], v[228:229], v[30:31], v[30:31] op_sel:[0,1,1] op_sel_hi:[1,1,1]
    v_pk_fma_f32 v[230:231], v[230:231], v[30:31], v[30:31] op_sel:[0,1,1] op_sel_hi:[1,1,1]
    v_rcp_f32 v220, v220
    v_rcp_f32 v221, v221
    v_pk_mul_f32 v[60:61], v[60:61], v[64:65]
    v_rcp_f32 v222, v222
    v_rcp_f32 v223, v223
    v_pk_mul_f32 v[62:63], v[62:63], v[66:67]
    v_rcp_f32 v224, v224
    v_rcp_f32 v225, v225
    v_pk_mul_f32 v[72:73], v[72:73], v[76:77]
    v_rcp_f32 v226, v226
    v_rcp_f32 v227, v227
    v_pk_mul_f32 v[74:75], v[74:75], v[78:79]
    v_rcp_f32 v228, v228
    v_rcp_f32 v229, v229
    v_pk_mul_f32 v[68:69], v[68:69], v[80:81]
    v_rcp_f32 v230, v230
    v_rcp_f32 v231, v231
    v_pk_mul_f32 v[70:71], v[70:71], v[82:83]
    v_pk_mul_f32 v[60:61], v[60:61], v[220:221]
    v_pk_mul_f32 v[62:63], v[62:63], v[222:223]
    v_pk_mul_f32 v[72:73], v[72:73], v[224:225]
    v_pk_mul_f32 v[74:75], v[74:75], v[226:227]
    v_pk_mul_f32 v[68:69], v[68:69], v[228:229]
    v_pk_mul_f32 v[70:71], v[70:71], v[230:231]
    v_cvt_pk_bf16_f32 v232, v60, v61
    v_cvt_pk_bf16_f32 v233, v62, v63
    v_cvt_pk_bf16_f32 v234, v72, v73
    v_cvt_pk_bf16_f32 v235, v74, v75
    v_cvt_pk_bf16_f32 v240, v68, v69
    v_cvt_pk_bf16_f32 v241, v70, v71
    v_permlane32_swap_b32 v232, v234
    v_permlane32_swap_b32 v233, v235
    buffer_store_dwordx4 v[232:235], v13, s[16:19], s32 offen sc1
    v_pk_fma_f32 v[84:85], v[166:167], v[44:45], v[84:85] op_sel_hi:[0,1,1] neg_lo:[1,0,0] neg_hi:[1,0,0]
    v_pk_fma_f32 v[86:87], v[166:167], v[46:47], v[86:87] op_sel_hi:[0,1,1] neg_lo:[1,0,0] neg_hi:[1,0,0]
    v_pk_fma_f32 v[96:97], v[170:171], v[44:45], v[96:97] op_sel_hi:[0,1,1] neg_lo:[1,0,0] neg_hi:[1,0,0]
    v_pk_fma_f32 v[98:99], v[170:171], v[46:47], v[98:99] op_sel_hi:[0,1,1] neg_lo:[1,0,0] neg_hi:[1,0,0]
    v_pk_fma_f32 v[92:93], v[34:35], v[52:53], v[92:93] op_sel_hi:[0,1,1] neg_lo:[1,0,0] neg_hi:[1,0,0]
    v_pk_fma_f32 v[94:95], v[34:35], v[54:55], v[94:95] op_sel_hi:[0,1,1] neg_lo:[1,0,0] neg_hi:[1,0,0]
    v_pk_mul_f32 v[220:221], v[84:85], v[84:85]
    v_pk_mul_f32 v[222:223], v[86:87], v[86:87]
    v_pk_mul_f32 v[224:225], v[96:97], v[96:97]
    v_pk_mul_f32 v[226:227], v[98:99], v[98:99]
    v_pk_mul_f32 v[228:229], v[92:93], v[92:93]
    v_pk_mul_f32 v[230:231], v[94:95], v[94:95]
    v_pk_fma_f32 v[220:221], v[220:221], v[164:165], v[164:165] op_sel:[0,1,0] op_sel_hi:[1,1,0]
    v_pk_fma_f32 v[222:223], v[222:223], v[164:165], v[164:165] op_sel:[0,1,0] op_sel_hi:[1,1,0]
    v_pk_fma_f32 v[224:225], v[224:225], v[168:169], v[168:169] op_sel:[0,1,0] op_sel_hi:[1,1,0]
    v_pk_fma_f32 v[226:227], v[226:227], v[168:169], v[168:169] op_sel:[0,1,0] op_sel_hi:[1,1,0]
    v_pk_fma_f32 v[228:229], v[228:229], v[32:33], v[32:33] op_sel:[0,1,0] op_sel_hi:[1,1,0]
    v_pk_fma_f32 v[230:231], v[230:231], v[32:33], v[32:33] op_sel:[0,1,0] op_sel_hi:[1,1,0]
    v_pk_mul_f32 v[220:221], v[220:221], v[84:85]
    v_pk_mul_f32 v[222:223], v[222:223], v[86:87]
    v_pk_mul_f32 v[224:225], v[224:225], v[96:97]
    v_pk_mul_f32 v[226:227], v[226:227], v[98:99]
    v_pk_mul_f32 v[228:229], v[228:229], v[92:93]
    v_pk_mul_f32 v[230:231], v[230:231], v[94:95]
    v_exp_f32 v220, v220
    v_exp_f32 v221, v221
    v_pk_fma_f32 v[88:89], v[166:167], v[48:49], v[88:89] op_sel_hi:[0,1,1] neg_lo:[1,0,0] neg_hi:[1,0,0]
    v_exp_f32 v222, v222
    v_exp_f32 v223, v223
    v_pk_fma_f32 v[90:91], v[166:167], v[50:51], v[90:91] op_sel_hi:[0,1,1] neg_lo:[1,0,0] neg_hi:[1,0,0]
    v_exp_f32 v224, v224
    v_exp_f32 v225, v225
    v_pk_fma_f32 v[100:101], v[170:171], v[48:49], v[100:101] op_sel_hi:[0,1,1] neg_lo:[1,0,0] neg_hi:[1,0,0]
    v_exp_f32 v226, v226
    v_exp_f32 v227, v227
    v_pk_fma_f32 v[102:103], v[170:171], v[50:51], v[102:103] op_sel_hi:[0,1,1] neg_lo:[1,0,0] neg_hi:[1,0,0]
    v_exp_f32 v228, v228
    v_exp_f32 v229, v229
    v_pk_fma_f32 v[104:105], v[34:35], v[56:57], v[104:105] op_sel_hi:[0,1,1] neg_lo:[1,0,0] neg_hi:[1,0,0]
    v_exp_f32 v230, v230
    v_exp_f32 v231, v231
    v_pk_fma_f32 v[106:107], v[34:35], v[58:59], v[106:107] op_sel_hi:[0,1,1] neg_lo:[1,0,0] neg_hi:[1,0,0]
    v_pk_fma_f32 v[220:221], v[220:221], v[166:167], v[166:167] op_sel:[0,1,1] op_sel_hi:[1,1,1]
    v_pk_fma_f32 v[222:223], v[222:223], v[166:167], v[166:167] op_sel:[0,1,1] op_sel_hi:[1,1,1]
    v_pk_fma_f32 v[224:225], v[224:225], v[170:171], v[170:171] op_sel:[0,1,1] op_sel_hi:[1,1,1]
    v_pk_fma_f32 v[226:227], v[226:227], v[170:171], v[170:171] op_sel:[0,1,1] op_sel_hi:[1,1,1]
    v_pk_fma_f32 v[228:229], v[228:229], v[34:35], v[34:35] op_sel:[0,1,1] op_sel_hi:[1,1,1]
    v_pk_fma_f32 v[230:231], v[230:231], v[34:35], v[34:35] op_sel:[0,1,1] op_sel_hi:[1,1,1]
    v_rcp_f32 v220, v220
    v_rcp_f32 v221, v221
    v_pk_mul_f32 v[84:85], v[84:85], v[88:89]
    v_rcp_f32 v222, v222
    v_rcp_f32 v223, v223
    v_pk_mul_f32 v[86:87], v[86:87], v[90:91]
    v_rcp_f32 v224, v224
    v_rcp_f32 v225, v225
    v_pk_mul_f32 v[96:97], v[96:97], v[100:101]
    v_rcp_f32 v226, v226
    v_rcp_f32 v227, v227
    v_pk_mul_f32 v[98:99], v[98:99], v[102:103]
    v_rcp_f32 v228, v228
    v_rcp_f32 v229, v229
    v_pk_mul_f32 v[92:93], v[92:93], v[104:105]
    v_rcp_f32 v230, v230
    v_rcp_f32 v231, v231
    v_pk_mul_f32 v[94:95], v[94:95], v[106:107]
    v_pk_mul_f32 v[84:85], v[84:85], v[220:221]
    v_pk_mul_f32 v[86:87], v[86:87], v[222:223]
    v_pk_mul_f32 v[96:97], v[96:97], v[224:225]
    v_pk_mul_f32 v[98:99], v[98:99], v[226:227]
    v_pk_mul_f32 v[92:93], v[92:93], v[228:229]
    v_pk_mul_f32 v[94:95], v[94:95], v[230:231]
    v_cvt_pk_bf16_f32 v236, v84, v85
    v_cvt_pk_bf16_f32 v237, v86, v87
    v_cvt_pk_bf16_f32 v238, v96, v97
    v_cvt_pk_bf16_f32 v239, v98, v99
    v_cvt_pk_bf16_f32 v242, v92, v93
    v_cvt_pk_bf16_f32 v243, v94, v95
    v_permlane32_swap_b32 v236, v238
    v_permlane32_swap_b32 v237, v239
    v_permlane16_swap_b32 v240, v242
    v_permlane16_swap_b32 v241, v243
    buffer_store_dwordx4 v[236:239], v13, s[16:19], s33 offen sc1
    buffer_store_dwordx4 v[240:243], v14, s[16:19], s36 offen sc1
    v_pk_fma_f32 v[108:109], v[174:175], v[44:45], v[108:109] op_sel_hi:[0,1,1] neg_lo:[1,0,0] neg_hi:[1,0,0]
    v_pk_fma_f32 v[110:111], v[174:175], v[46:47], v[110:111] op_sel_hi:[0,1,1] neg_lo:[1,0,0] neg_hi:[1,0,0]
    v_pk_fma_f32 v[120:121], v[178:179], v[44:45], v[120:121] op_sel_hi:[0,1,1] neg_lo:[1,0,0] neg_hi:[1,0,0]
    v_pk_fma_f32 v[122:123], v[178:179], v[46:47], v[122:123] op_sel_hi:[0,1,1] neg_lo:[1,0,0] neg_hi:[1,0,0]
    v_pk_fma_f32 v[116:117], v[38:39], v[52:53], v[116:117] op_sel_hi:[0,1,1] neg_lo:[1,0,0] neg_hi:[1,0,0]
    v_pk_fma_f32 v[118:119], v[38:39], v[54:55], v[118:119] op_sel_hi:[0,1,1] neg_lo:[1,0,0] neg_hi:[1,0,0]
    v_pk_mul_f32 v[220:221], v[108:109], v[108:109]
    v_pk_mul_f32 v[222:223], v[110:111], v[110:111]
    v_pk_mul_f32 v[224:225], v[120:121], v[120:121]
    v_pk_mul_f32 v[226:227], v[122:123], v[122:123]
    v_pk_mul_f32 v[228:229], v[116:117], v[116:117]
    v_pk_mul_f32 v[230:231], v[118:119], v[118:119]
    v_pk_fma_f32 v[220:221], v[220:221], v[172:173], v[172:173] op_sel:[0,1,0] op_sel_hi:[1,1,0]
    v_pk_fma_f32 v[222:223], v[222:223], v[172:173], v[172:173] op_sel:[0,1,0] op_sel_hi:[1,1,0]
    v_pk_fma_f32 v[224:225], v[224:225], v[176:177], v[176:177] op_sel:[0,1,0] op_sel_hi:[1,1,0]
    v_pk_fma_f32 v[226:227], v[226:227], v[176:177], v[176:177] op_sel:[0,1,0] op_sel_hi:[1,1,0]
    v_pk_fma_f32 v[228:229], v[228:229], v[36:37], v[36:37] op_sel:[0,1,0] op_sel_hi:[1,1,0]
    v_pk_fma_f32 v[230:231], v[230:231], v[36:37], v[36:37] op_sel:[0,1,0] op_sel_hi:[1,1,0]
    v_pk_mul_f32 v[220:221], v[220:221], v[108:109]
    v_pk_mul_f32 v[222:223], v[222:223], v[110:111]
    v_pk_mul_f32 v[224:225], v[224:225], v[120:121]
    v_pk_mul_f32 v[226:227], v[226:227], v[122:123]
    v_pk_mul_f32 v[228:229], v[228:229], v[116:117]
    v_pk_mul_f32 v[230:231], v[230:231], v[118:119]
    v_exp_f32 v220, v220
    v_exp_f32 v221, v221
    v_pk_fma_f32 v[112:113], v[174:175], v[48:49], v[112:113] op_sel_hi:[0,1,1] neg_lo:[1,0,0] neg_hi:[1,0,0]
    v_exp_f32 v222, v222
    v_exp_f32 v223, v223
    v_pk_fma_f32 v[114:115], v[174:175], v[50:51], v[114:115] op_sel_hi:[0,1,1] neg_lo:[1,0,0] neg_hi:[1,0,0]
    v_exp_f32 v224, v224
    v_exp_f32 v225, v225
    v_pk_fma_f32 v[124:125], v[178:179], v[48:49], v[124:125] op_sel_hi:[0,1,1] neg_lo:[1,0,0] neg_hi:[1,0,0]
    v_exp_f32 v226, v226
    v_exp_f32 v227, v227
    v_pk_fma_f32 v[126:127], v[178:179], v[50:51], v[126:127] op_sel_hi:[0,1,1] neg_lo:[1,0,0] neg_hi:[1,0,0]
    v_exp_f32 v228, v228
    v_exp_f32 v229, v229
    v_pk_fma_f32 v[128:129], v[38:39], v[56:57], v[128:129] op_sel_hi:[0,1,1] neg_lo:[1,0,0] neg_hi:[1,0,0]
    v_exp_f32 v230, v230
    v_exp_f32 v231, v231
    v_pk_fma_f32 v[130:131], v[38:39], v[58:59], v[130:131] op_sel_hi:[0,1,1] neg_lo:[1,0,0] neg_hi:[1,0,0]
    v_pk_fma_f32 v[220:221], v[220:221], v[174:175], v[174:175] op_sel:[0,1,1] op_sel_hi:[1,1,1]
    v_pk_fma_f32 v[222:223], v[222:223], v[174:175], v[174:175] op_sel:[0,1,1] op_sel_hi:[1,1,1]
    v_pk_fma_f32 v[224:225], v[224:225], v[178:179], v[178:179] op_sel:[0,1,1] op_sel_hi:[1,1,1]
    v_pk_fma_f32 v[226:227], v[226:227], v[178:179], v[178:179] op_sel:[0,1,1] op_sel_hi:[1,1,1]
    v_pk_fma_f32 v[228:229], v[228:229], v[38:39], v[38:39] op_sel:[0,1,1] op_sel_hi:[1,1,1]
    v_pk_fma_f32 v[230:231], v[230:231], v[38:39], v[38:39] op_sel:[0,1,1] op_sel_hi:[1,1,1]
    v_rcp_f32 v220, v220
    v_rcp_f32 v221, v221
    v_pk_mul_f32 v[108:109], v[108:109], v[112:113]
    v_rcp_f32 v222, v222
    v_rcp_f32 v223, v223
    v_pk_mul_f32 v[110:111], v[110:111], v[114:115]
    v_rcp_f32 v224, v224
    v_rcp_f32 v225, v225
    v_pk_mul_f32 v[120:121], v[120:121], v[124:125]
    v_rcp_f32 v226, v226
    v_rcp_f32 v227, v227
    v_pk_mul_f32 v[122:123], v[122:123], v[126:127]
    v_rcp_f32 v228, v228
    v_rcp_f32 v229, v229
    v_pk_mul_f32 v[116:117], v[116:117], v[128:129]
    v_rcp_f32 v230, v230
    v_rcp_f32 v231, v231
    v_pk_mul_f32 v[118:119], v[118:119], v[130:131]
    v_pk_mul_f32 v[108:109], v[108:109], v[220:221]
    v_pk_mul_f32 v[110:111], v[110:111], v[222:223]
    v_pk_mul_f32 v[120:121], v[120:121], v[224:225]
    v_pk_mul_f32 v[122:123], v[122:123], v[226:227]
    v_pk_mul_f32 v[116:117], v[116:117], v[228:229]
    v_pk_mul_f32 v[118:119], v[118:119], v[230:231]
    v_cvt_pk_bf16_f32 v232, v108, v109
    v_cvt_pk_bf16_f32 v233, v110, v111
    v_cvt_pk_bf16_f32 v234, v120, v121
    v_cvt_pk_bf16_f32 v235, v122, v123
    v_cvt_pk_bf16_f32 v244, v116, v117
    v_cvt_pk_bf16_f32 v245, v118, v119
    v_permlane32_swap_b32 v232, v234
    v_permlane32_swap_b32 v233, v235
    buffer_store_dwordx4 v[232:235], v13, s[16:19], s34 offen sc1
    v_pk_fma_f32 v[132:133], v[182:183], v[44:45], v[132:133] op_sel_hi:[0,1,1] neg_lo:[1,0,0] neg_hi:[1,0,0]
    v_pk_fma_f32 v[134:135], v[182:183], v[46:47], v[134:135] op_sel_hi:[0,1,1] neg_lo:[1,0,0] neg_hi:[1,0,0]
    v_pk_fma_f32 v[144:145], v[186:187], v[44:45], v[144:145] op_sel_hi:[0,1,1] neg_lo:[1,0,0] neg_hi:[1,0,0]
    v_pk_fma_f32 v[146:147], v[186:187], v[46:47], v[146:147] op_sel_hi:[0,1,1] neg_lo:[1,0,0] neg_hi:[1,0,0]
    v_pk_fma_f32 v[140:141], v[42:43], v[52:53], v[140:141] op_sel_hi:[0,1,1] neg_lo:[1,0,0] neg_hi:[1,0,0]
    v_pk_fma_f32 v[142:143], v[42:43], v[54:55], v[142:143] op_sel_hi:[0,1,1] neg_lo:[1,0,0] neg_hi:[1,0,0]
    v_pk_mul_f32 v[220:221], v[132:133], v[132:133]
    v_pk_mul_f32 v[222:223], v[134:135], v[134:135]
    v_pk_mul_f32 v[224:225], v[144:145], v[144:145]
    v_pk_mul_f32 v[226:227], v[146:147], v[146:147]
    v_pk_mul_f32 v[228:229], v[140:141], v[140:141]
    v_pk_mul_f32 v[230:231], v[142:143], v[142:143]
    v_pk_fma_f32 v[220:221], v[220:221], v[180:181], v[180:181] op_sel:[0,1,0] op_sel_hi:[1,1,0]
    v_pk_fma_f32 v[222:223], v[222:223], v[180:181], v[180:181] op_sel:[0,1,0] op_sel_hi:[1,1,0]
    v_pk_fma_f32 v[224:225], v[224:225], v[184:185], v[184:185] op_sel:[0,1,0] op_sel_hi:[1,1,0]
    v_pk_fma_f32 v[226:227], v[226:227], v[184:185], v[184:185] op_sel:[0,1,0] op_sel_hi:[1,1,0]
    v_pk_fma_f32 v[228:229], v[228:229], v[40:41], v[40:41] op_sel:[0,1,0] op_sel_hi:[1,1,0]
    v_pk_fma_f32 v[230:231], v[230:231], v[40:41], v[40:41] op_sel:[0,1,0] op_sel_hi:[1,1,0]
    v_pk_mul_f32 v[220:221], v[220:221], v[132:133]
    v_pk_mul_f32 v[222:223], v[222:223], v[134:135]
    v_pk_mul_f32 v[224:225], v[224:225], v[144:145]
    v_pk_mul_f32 v[226:227], v[226:227], v[146:147]
    v_pk_mul_f32 v[228:229], v[228:229], v[140:141]
    v_pk_mul_f32 v[230:231], v[230:231], v[142:143]
    v_exp_f32 v220, v220
    v_exp_f32 v221, v221
    v_pk_fma_f32 v[136:137], v[182:183], v[48:49], v[136:137] op_sel_hi:[0,1,1] neg_lo:[1,0,0] neg_hi:[1,0,0]
    v_exp_f32 v222, v222
    v_exp_f32 v223, v223
    v_pk_fma_f32 v[138:139], v[182:183], v[50:51], v[138:139] op_sel_hi:[0,1,1] neg_lo:[1,0,0] neg_hi:[1,0,0]
    v_exp_f32 v224, v224
    v_exp_f32 v225, v225
    v_pk_fma_f32 v[148:149], v[186:187], v[48:49], v[148:149] op_sel_hi:[0,1,1] neg_lo:[1,0,0] neg_hi:[1,0,0]
    v_exp_f32 v226, v226
    v_exp_f32 v227, v227
    v_pk_fma_f32 v[150:151], v[186:187], v[50:51], v[150:151] op_sel_hi:[0,1,1] neg_lo:[1,0,0] neg_hi:[1,0,0]
    v_exp_f32 v228, v228
    v_exp_f32 v229, v229
    v_pk_fma_f32 v[152:153], v[42:43], v[56:57], v[152:153] op_sel_hi:[0,1,1] neg_lo:[1,0,0] neg_hi:[1,0,0]
    v_exp_f32 v230, v230
    v_exp_f32 v231, v231
    v_pk_fma_f32 v[154:155], v[42:43], v[58:59], v[154:155] op_sel_hi:[0,1,1] neg_lo:[1,0,0] neg_hi:[1,0,0]
    v_pk_fma_f32 v[220:221], v[220:221], v[182:183], v[182:183] op_sel:[0,1,1] op_sel_hi:[1,1,1]
    v_pk_fma_f32 v[222:223], v[222:223], v[182:183], v[182:183] op_sel:[0,1,1] op_sel_hi:[1,1,1]
    v_pk_fma_f32 v[224:225], v[224:225], v[186:187], v[186:187] op_sel:[0,1,1] op_sel_hi:[1,1,1]
    v_pk_fma_f32 v[226:227], v[226:227], v[186:187], v[186:187] op_sel:[0,1,1] op_sel_hi:[1,1,1]
    v_pk_fma_f32 v[228:229], v[228:229], v[42:43], v[42:43] op_sel:[0,1,1] op_sel_hi:[1,1,1]
    v_pk_fma_f32 v[230:231], v[230:231], v[42:43], v[42:43] op_sel:[0,1,1] op_sel_hi:[1,1,1]
    v_rcp_f32 v220, v220
    v_rcp_f32 v221, v221
    v_pk_mul_f32 v[132:133], v[132:133], v[136:137]
    v_rcp_f32 v222, v222
    v_rcp_f32 v223, v223
    v_pk_mul_f32 v[134:135], v[134:135], v[138:139]
    v_rcp_f32 v224, v224
    v_rcp_f32 v225, v225
    v_pk_mul_f32 v[144:145], v[144:145], v[148:149]
    v_rcp_f32 v226, v226
    v_rcp_f32 v227, v227
    v_pk_mul_f32 v[146:147], v[146:147], v[150:151]
    v_rcp_f32 v228, v228
    v_rcp_f32 v229, v229
    v_pk_mul_f32 v[140:141], v[140:141], v[152:153]
    v_rcp_f32 v230, v230
    v_rcp_f32 v231, v231
    v_pk_mul_f32 v[142:143], v[142:143], v[154:155]
    v_pk_mul_f32 v[132:133], v[132:133], v[220:221]
    v_pk_mul_f32 v[134:135], v[134:135], v[222:223]
    v_pk_mul_f32 v[144:145], v[144:145], v[224:225]
    v_pk_mul_f32 v[146:147], v[146:147], v[226:227]
    v_pk_mul_f32 v[140:141], v[140:141], v[228:229]
    v_pk_mul_f32 v[142:143], v[142:143], v[230:231]
    v_cvt_pk_bf16_f32 v236, v132, v133
    v_cvt_pk_bf16_f32 v237, v134, v135
    v_cvt_pk_bf16_f32 v238, v144, v145
    v_cvt_pk_bf16_f32 v239, v146, v147
    v_cvt_pk_bf16_f32 v246, v140, v141
    v_cvt_pk_bf16_f32 v247, v142, v143
    v_permlane32_swap_b32 v236, v238
    v_permlane32_swap_b32 v237, v239
    v_permlane16_swap_b32 v244, v246
    v_permlane16_swap_b32 v245, v247
    buffer_store_dwordx4 v[236:239], v13, s[16:19], s35 offen sc1
    buffer_store_dwordx4 v[244:247], v14, s[16:19], s37 offen sc1
    s_load_dwordx2 s[6:7], s[0:1], 88
    s_lshl_b32 s39, s60, 4
    s_add_u32 s39, s39, s61
    s_lshl_b32 s39, s39, 7
    s_add_u32 s39, s39, 131072
    s_lshl_b32 s39, s60, 13
    s_lshl_b32 s38, s61, 5
    s_add_u32 s39, s39, s38
    s_add_u32 s39, s39, 131072
    v_lshlrev_b32 v20, 9, v1
    v_mov_b32 v21, s59
    s_add_u32 s44, s28, s63
    s_and_b32 s44, s44, 3
    v_lshlrev_b32 v19, 4, v1
PAD_B2:
    s_cbranch_execz RET_B
    s_lshr_b32 s31, s62, 1
    s_lshl_b32 s31, s31, 2
    s_add_u32 s31, s31, s28
    s_lshl_b32 s31, s31, 9
    s_add_u32 s31, s31, 131072
    v_and_b32 v4, 3, v1
    v_lshl_add_u32 v18, v4, 7, s31
    s_lshl_b32 s31, s62, 3
    s_add_u32 s31, s31, s63
    s_lshl_b32 s31, s31, 2
    s_add_u32 s31, s31, s28
    s_lshl_b32 s31, s31, 7
    s_add_u32 s31, s31, 131072
    v_lshl_add_u32 v18, v4, 5, s31
    s_add_u32 s37, s55, 0
    s_sub_u32 s38, s37, 3
    s_cselect_b32 s37, s37, s38
    s_lshl_b32 s37, s37, 12
    v_add_u32 v6, s37, v19
    s_add_u32 s37, s55, 1
    s_sub_u32 s38, s37, 3
    s_cselect_b32 s37, s37, s38
    s_lshl_b32 s37, s37, 12
    v_add_u32 v7, s37, v19
    s_add_u32 s37, s55, 2
    s_sub_u32 s38, s37, 3
    s_cselect_b32 s37, s37, s38
    s_lshl_b32 s37, s37, 12
    v_add_u32 v8, s37, v19
    s_lshl_b32 s35, s62, 2
    s_mul_i32 s36, s28, 12288
    s_add_u32 s37, s44, 1
    s_and_b32 s37, s37, 3
    s_add_u32 s38, s37, s35
    s_mul_i32 s38, s38, 49152
    s_add_u32 s40, s38, s36
    s_mul_i32 s37, s37, 15360
    s_add_u32 s37, s37, 24576
    v_add_u32 v9, s37, v19
    s_add_u32 s37, s44, 2
    s_and_b32 s37, s37, 3
    s_add_u32 s38, s37, s35
    s_mul_i32 s38, s38, 49152
    s_add_u32 s41, s38, s36
    s_mul_i32 s37, s37, 15360
    s_add_u32 s37, s37, 29696
    v_add_u32 v10, s37, v19
    s_add_u32 s37, s44, 3
    s_and_b32 s37, s37, 3
    s_add_u32 s38, s37, s35
    s_mul_i32 s38, s38, 49152
    s_add_u32 s42, s38, s36
    s_mul_i32 s37, s37, 15360
    s_add_u32 s37, s37, 34816
    v_add_u32 v11, s37, v19
    s_add_u32 s37, s44, 4
    s_and_b32 s37, s37, 3
    s_add_u32 s38, s37, s35
    s_mul_i32 s38, s38, 49152
    s_add_u32 s43, s38, s36
    s_mul_i32 s37, s44, 15360
    s_add_u32 s37, s37, 24576
    v_add_u32 v12, s37, v19
    v_lshrrev_b32 v2, 4, v1
    v_bfe_u32 v3, v1, 2, 2
    v_lshlrev_b32 v15, 3, v4
    v_lshl_add_u32 v15, v3, 7, v15
    s_lshl_b32 s37, s44, 5
    s_add_u32 s37, s37, 8192
    v_add_u32 v15, s37, v15
    v_lshl_add_u32 v13, v2, 10, v15
    v_lshl_add_u32 v14, v2, 9, v15
    v_and_b32 v15, 1, v3
    v_lshlrev_b32 v15, 8, v15
    v_lshl_add_u32 v15, v4, 1, v15
    v_lshrrev_b32 v3, 1, v3
    v_add_u32 v15, v15, v3
    v_mul_u32_u24 v3, 1280, v15
    v_lshl_add_u32 v15, v2, 4, v3
    v_lshl_add_u32 v16, v2, 3, v3
    s_lshr_b32 s37, s62, 3
    s_lshl_b32 s37, s37, 9
    s_and_b32 s38, s62, 1
    s_lshl_b32 s38, s38, 2
    s_add_u32 s38, s38, s44
    s_lshl_b32 s38, s38, 5
    s_add_u32 s37, s37, s38
    s_bfe_u32 s38, s62, 0x20001
    s_lshl_b32 s38, s38, 3
    s_add_u32 s37, s37, s38
    s_mul_i32 s37, s37, 1280
    s_mul_i32 s38, s63, 160
    s_add_u32 s45, s37, s38
    s_waitcnt lgkmcnt(0)
    s_mov_b32 s20, s6
    s_mov_b32 s21, s7
    s_mov_b32 s22, 0x280000
    s_mov_b32 s23, 0x20000
    s_waitcnt vmcnt(0)
    s_barrier
    s_cmp_lg_u32 s28, 0
    s_cbranch_scc1 G_NF
    s_mov_b64 exec, 0xffff
    buffer_store_dword v21, v20, s[64:67], s39 offen sc1
    s_mov_b64 exec, -1
G_NF:
    s_movk_i32 s58, 0x7fff
PL_7:
    buffer_load_dword v5, v18, s[64:67], 0 offen sc1
    s_waitcnt vmcnt(0)
    v_cmp_ne_u32 vcc, s59, v5
    s_cbranch_vccz PD_8
    s_mov_b64 exec, vcc
    s_sub_u32 s58, s58, 1
    s_cbranch_scc0 PL_7
PD_8:
    s_mov_b64 exec, -1
    buffer_load_dwordx4 v[64:67], v6, s[16:19], s40 offen offset:0 sc1
    buffer_load_dwordx4 v[68:71], v6, s[16:19], s40 offen offset:1024 sc1
    buffer_load_dwordx4 v[72:75], v6, s[16:19], s40 offen offset:2048 sc1
    buffer_load_dwordx4 v[76:79], v6, s[16:19], s40 offen offset:3072 sc1
    buffer_load_dwordx4 v[80:83], v7, s[16:19], s40 offen offset:0 sc1
    buffer_load_dwordx4 v[84:87], v7, s[16:19], s40 offen offset:1024 sc1
    buffer_load_dwordx4 v[88:91], v7, s[16:19], s40 offen offset:2048 sc1
    buffer_load_dwordx4 v[92:95], v7, s[16:19], s40 offen offset:3072 sc1
    buffer_load_dwordx4 v[96:99], v8, s[16:19], s40 offen offset:0 sc1
    buffer_load_dwordx4 v[100:103], v8, s[16:19], s40 offen offset:1024 sc1
    buffer_load_dwordx4 v[104:107], v8, s[16:19], s40 offen offset:2048 sc1
    buffer_load_dwordx4 v[108:111], v8, s[16:19], s40 offen offset:3072 sc1
    s_waitcnt vmcnt(11)
    v_mfma_f32_16x16x32_bf16 v[24:27], a[0:3], v[64:67], 0
    buffer_load_dwordx4 v[112:115], v6, s[16:19], s41 offen offset:0 sc1
    v_mfma_f32_16x16x32_bf16 v[28:31], a[4:7], v[64:67], 0
    v_mfma_f32_16x16x32_bf16 v[32:35], a[8:11], v[64:67], 0
    v_mfma_f32_16x16x32_bf16 v[36:39], a[12:15], v[64:67], 0
    v_mfma_f32_16x16x32_bf16 v[40:43], a[16:19], v[64:67], 0
    s_waitcnt vmcnt(11)
    v_mfma_f32_16x16x32_bf16 v[24:27], a[20:23], v[68:71], v[24:27]
    buffer_load_dwordx4 v[116:119], v6, s[16:19], s41 offen offset:1024 sc1
    v_mfma_f32_16x16x32_bf16 v[28:31], a[24:27], v[68:71], v[28:31]
    v_mfma_f32_16x16x32_bf16 v[32:35], a[28:31], v[68:71], v[32:35]
    v_mfma_f32_16x16x32_bf16 v[36:39], a[32:35], v[68:71], v[36:39]
    v_mfma_f32_16x16x32_bf16 v[40:43], a[36:39], v[68:71], v[40:43]
    s_waitcnt vmcnt(11)
    v_mfma_f32_16x16x32_bf16 v[24:27], a[40:43], v[72:75], v[24:27]
    buffer_load_dwordx4 v[120:123], v6, s[16:19], s41 offen offset:2048 sc1
    v_mfma_f32_16x16x32_bf16 v[28:31], a[44:47], v[72:75], v[28:31]
    v_mfma_f32_16x16x32_bf16 v[32:35], a[48:51], v[72:75], v[32:35]
    v_mfma_f32_16x16x32_bf16 v[36:39], a[52:55], v[72:75], v[36:39]
    v_mfma_f32_16x16x32_bf16 v[40:43], a[56:59], v[72:75], v[40:43]
    s_waitcnt vmcnt(11)
    v_mfma_f32_16x16x32_bf16 v[24:27], a[60:63], v[76:79], v[24:27]
    buffer_load_dwordx4 v[124:127], v6, s[16:19], s41 offen offset:3072 sc1
    v_mfma_f32_16x16x32_bf16 v[28:31], a[64:67], v[76:79], v[28:31]
    v_mfma_f32_16x16x32_bf16 v[32:35], a[68:71], v[76:79], v[32:35]
    v_mfma_f32_16x16x32_bf16 v[36:39], a[72:75], v[76:79], v[36:39]
    v_mfma_f32_16x16x32_bf16 v[40:43], a[76:79], v[76:79], v[40:43]
    s_waitcnt vmcnt(11)
    v_mfma_f32_16x16x32_bf16 v[24:27], a[80:83], v[80:83], v[24:27]
    buffer_load_dwordx4 v[128:131], v7, s[16:19], s41 offen offset:0 sc1
    v_mfma_f32_16x16x32_bf16 v[28:31], a[84:87], v[80:83], v[28:31]
    v_mfma_f32_16x16x32_bf16 v[32:35], a[88:91], v[80:83], v[32:35]
    v_mfma_f32_16x16x32_bf16 v[36:39], a[92:95], v[80:83], v[36:39]
    v_mfma_f32_16x16x32_bf16 v[40:43], a[96:99], v[80:83], v[40:43]
    s_waitcnt vmcnt(11)
    v_mfma_f32_16x16x32_bf16 v[24:27], a[100:103], v[84:87], v[24:27]
    buffer_load_dwordx4 v[132:135], v7, s[16:19], s41 offen offset:1024 sc1
    v_mfma_f32_16x16x32_bf16 v[28:31], a[104:107], v[84:87], v[28:31]
    v_mfma_f32_16x16x32_bf16 v[32:35], a[108:111], v[84:87], v[32:35]
    v_mfma_f32_16x16x32_bf16 v[36:39], a[112:115], v[84:87], v[36:39]
    v_mfma_f32_16x16x32_bf16 v[40:43], a[116:119], v[84:87], v[40:43]
    s_waitcnt vmcnt(11)
    v_mfma_f32_16x16x32_bf16 v[24:27], a[120:123], v[88:91], v[24:27]
    buffer_load_dwordx4 v[136:139], v7, s[16:19], s41 offen offset:2048 sc1
    v_mfma_f32_16x16x32_bf16 v[28:31], a[124:127], v[88:91], v[28:31]
    v_mfma_f32_16x16x32_bf16 v[32:35], a[128:131], v[88:91], v[32:35]
    v_mfma_f32_16x16x32_bf16 v[36:39], a[132:135], v[88:91], v[36:39]
    v_mfma_f32_16x16x32_bf16 v[40:43], a[136:139], v[88:91], v[40:43]
    s_waitcnt vmcnt(11)
    v_mfma_f32_16x16x32_bf16 v[24:27], a[140:143], v[92:95], v[24:27]
    buffer_load_dwordx4 v[140:143], v7, s[16:19], s41 offen offset:3072 sc1
    v_mfma_f32_16x16x32_bf16 v[28:31], a[144:147], v[92:95], v[28:31]
    v_mfma_f32_16x16x32_bf16 v[32:35], a[148:151], v[92:95], v[32:35]
    v_mfma_f32_16x16x32_bf16 v[36:39], a[152:155], v[92:95], v[36:39]
    v_mfma_f32_16x16x32_bf16 v[40:43], a[156:159], v[92:95], v[40:43]
    s_waitcnt vmcnt(11)
    v_mfma_f32_16x16x32_bf16 v[24:27], a[160:163], v[96:99], v[24:27]
    buffer_load_dwordx4 v[144:147], v8, s[16:19], s41 offen offset:0 sc1
    v_mfma_f32_16x16x32_bf16 v[28:31], a[164:167], v[96:99], v[28:31]
    v_mfma_f32_16x16x32_bf16 v[32:35], a[168:171], v[96:99], v[32:35]
    v_mfma_f32_16x16x32_bf16 v[36:39], a[172:175], v[96:99], v[36:39]
    v_mfma_f32_16x16x32_bf16 v[40:43], a[176:179], v[96:99], v[40:43]
    s_waitcnt vmcnt(11)
    v_mfma_f32_16x16x32_bf16 v[24:27], a[180:183], v[100:103], v[24:27]
    buffer_load_dwordx4 v[148:151], v8, s[16:19], s41 offen offset:1024 sc1
    v_mfma_f32_16x16x32_bf16 v[28:31], a[184:187], v[100:103], v[28:31]
    v_mfma_f32_16x16x32_bf16 v[32:35], a[188:191], v[100:103], v[32:35]
    v_mfma_f32_16x16x32_bf16 v[36:39], a[192:195], v[100:103], v[36:39]
    v_mfma_f32_16x16x32_bf16 v[40:43], a[196:199], v[100:103], v[40:43]
    s_waitcnt vmcnt(11)
    v_mfma_f32_16x16x32_bf16 v[24:27], a[200:203], v[104:107], v[24:27]
    buffer_load_dwordx4 v[152:155], v8, s[16:19], s41 offen offset:2048 sc1
    v_mfma_f32_16x16x32_bf16 v[28:31], a[204:207], v[104:107], v[28:31]
    v_mfma_f32_16x16x32_bf16 v[32:35], a[208:211], v[104:107], v[32:35]
    v_mfma_f32_16x16x32_bf16 v[36:39], a[212:215], v[104:107], v[36:39]
    v_mfma_f32_16x16x32_bf16 v[40:43], a[216:219], v[104:107], v[40:43]
    s_waitcnt vmcnt(11)
    v_mfma_f32_16x16x32_bf16 v[24:27], a[220:223], v[108:111], v[24:27]
    buffer_load_dwordx4 v[156:159], v8, s[16:19], s41 offen offset:3072 sc1
    v_mfma_f32_16x16x32_bf16 v[28:31], a[224:227], v[108:111], v[28:31]
    v_mfma_f32_16x16x32_bf16 v[32:35], a[228:231], v[108:111], v[32:35]
    v_mfma_f32_16x16x32_bf16 v[36:39], a[232:235], v[108:111], v[36:39]
    v_mfma_f32_16x16x32_bf16 v[40:43], a[236:239], v[108:111], v[40:43]
    s_waitcnt vmcnt(11)
    v_mfma_f32_16x16x32_bf16 v[44:47], a[0:3], v[112:115], 0
    buffer_load_dwordx4 v[160:163], v6, s[16:19], s42 offen offset:0 sc1
    v_mfma_f32_16x16x32_bf16 v[48:51], a[4:7], v[112:115], 0
    v_mfma_f32_16x16x32_bf16 v[52:55], a[8:11], v[112:115], 0

    v_mfma_f32_16x16x32_bf16 v[56:59], a[12:15], v[112:115], 0
    v_mfma_f32_16x16x32_bf16 v[60:63], a[16:19], v[112:115], 0
    ds_write_b128 v9, v[24:27] offset:0
    s_waitcnt vmcnt(11)
    v_mfma_f32_16x16x32_bf16 v[44:47], a[20:23], v[116:119], v[44:47]
    buffer_load_dwordx4 v[164:167], v6, s[16:19], s42 offen offset:1024 sc1
    v_mfma_f32_16x16x32_bf16 v[48:51], a[24:27], v[116:119], v[48:51]
    ds_write_b128 v9, v[28:31] offset:1024
    v_mfma_f32_16x16x32_bf16 v[52:55], a[28:31], v[116:119], v[52:55]
    v_mfma_f32_16x16x32_bf16 v[56:59], a[32:35], v[116:119], v[56:59]
    ds_write_b128 v9, v[32:35] offset:2048
    v_mfma_f32_16x16x32_bf16 v[60:63], a[36:39], v[116:119], v[60:63]
    s_waitcnt vmcnt(11)
    v_mfma_f32_16x16x32_bf16 v[44:47], a[40:43], v[120:123], v[44:47]
    ds_write_b128 v9, v[36:39] offset:3072
    buffer_load_dwordx4 v[168:171], v6, s[16:19], s42 offen offset:2048 sc1
    v_mfma_f32_16x16x32_bf16 v[48:51], a[44:47], v[120:123], v[48:51]
    v_mfma_f32_16x16x32_bf16 v[52:55], a[48:51], v[120:123], v[52:55]
    ds_write_b128 v9, v[40:43] offset:4096
    v_mfma_f32_16x16x32_bf16 v[56:59], a[52:55], v[120:123], v[56:59]
    v_mfma_f32_16x16x32_bf16 v[60:63], a[56:59], v[120:123], v[60:63]
    s_waitcnt vmcnt(11)
    v_mfma_f32_16x16x32_bf16 v[44:47], a[60:63], v[124:127], v[44:47]
    buffer_load_dwordx4 v[172:175], v6, s[16:19], s42 offen offset:3072 sc1
    v_mfma_f32_16x16x32_bf16 v[48:51], a[64:67], v[124:127], v[48:51]
    v_mfma_f32_16x16x32_bf16 v[52:55], a[68:71], v[124:127], v[52:55]
    v_mfma_f32_16x16x32_bf16 v[56:59], a[72:75], v[124:127], v[56:59]
    v_mfma_f32_16x16x32_bf16 v[60:63], a[76:79], v[124:127], v[60:63]
    s_waitcnt vmcnt(11)
    v_mfma_f32_16x16x32_bf16 v[44:47], a[80:83], v[128:131], v[44:47]
    buffer_load_dwordx4 v[176:179], v7, s[16:19], s42 offen offset:0 sc1
    v_mfma_f32_16x16x32_bf16 v[48:51], a[84:87], v[128:131], v[48:51]
    v_mfma_f32_16x16x32_bf16 v[52:55], a[88:91], v[128:131], v[52:55]
    v_mfma_f32_16x16x32_bf16 v[56:59], a[92:95], v[128:131], v[56:59]
    v_mfma_f32_16x16x32_bf16 v[60:63], a[96:99], v[128:131], v[60:63]
    s_waitcnt vmcnt(11)
    v_mfma_f32_16x16x32_bf16 v[44:47], a[100:103], v[132:135], v[44:47]
    buffer_load_dwordx4 v[180:183], v7, s[16:19], s42 offen offset:1024 sc1
    v_mfma_f32_16x16x32_bf16 v[48:51], a[104:107], v[132:135], v[48:51]
    v_mfma_f32_16x16x32_bf16 v[52:55], a[108:111], v[132:135], v[52:55]
    v_mfma_f32_16x16x32_bf16 v[56:59], a[112:115], v[132:135], v[56:59]
    v_mfma_f32_16x16x32_bf16 v[60:63], a[116:119], v[132:135], v[60:63]
    s_waitcnt vmcnt(11)
    v_mfma_f32_16x16x32_bf16 v[44:47], a[120:123], v[136:139], v[44:47]
    buffer_load_dwordx4 v[184:187], v7, s[16:19], s42 offen offset:2048 sc1
    v_mfma_f32_16x16x32_bf16 v[48:51], a[124:127], v[136:139], v[48:51]
    v_mfma_f32_16x16x32_bf16 v[52:55], a[128:131], v[136:139], v[52:55]
    v_mfma_f32_16x16x32_bf16 v[56:59], a[132:135], v[136:139], v[56:59]
    v_mfma_f32_16x16x32_bf16 v[60:63], a[136:139], v[136:139], v[60:63]
    s_waitcnt vmcnt(11)
    v_mfma_f32_16x16x32_bf16 v[44:47], a[140:143], v[140:143], v[44:47]
    buffer_load_dwordx4 v[188:191], v7, s[16:19], s42 offen offset:3072 sc1
    v_mfma_f32_16x16x32_bf16 v[48:51], a[144:147], v[140:143], v[48:51]
    v_mfma_f32_16x16x32_bf16 v[52:55], a[148:151], v[140:143], v[52:55]
    v_mfma_f32_16x16x32_bf16 v[56:59], a[152:155], v[140:143], v[56:59]
    v_mfma_f32_16x16x32_bf16 v[60:63], a[156:159], v[140:143], v[60:63]
    s_waitcnt vmcnt(11)
    v_mfma_f32_16x16x32_bf16 v[44:47], a[160:163], v[144:147], v[44:47]
    buffer_load_dwordx4 v[192:195], v8, s[16:19], s42 offen offset:0 sc1
    v_mfma_f32_16x16x32_bf16 v[48:51], a[164:167], v[144:147], v[48:51]
    v_mfma_f32_16x16x32_bf16 v[52:55], a[168:171], v[144:147], v[52:55]
    v_mfma_f32_16x16x32_bf16 v[56:59], a[172:175], v[144:147], v[56:59]
    v_mfma_f32_16x16x32_bf16 v[60:63], a[176:179], v[144:147], v[60:63]
    s_waitcnt vmcnt(11)
    v_mfma_f32_16x16x32_bf16 v[44:47], a[180:183], v[148:151], v[44:47]
    buffer_load_dwordx4 v[196:199], v8, s[16:19], s42 offen offset:1024 sc1
    v_mfma_f32_16x16x32_bf16 v[48:51], a[184:187], v[148:151], v[48:51]
    v_mfma_f32_16x16x32_bf16 v[52:55], a[188:191], v[148:151], v[52:55]
    v_mfma_f32_16x16x32_bf16 v[56:59], a[192:195], v[148:151], v[56:59]
    v_mfma_f32_16x16x32_bf16 v[60:63], a[196:199], v[148:151], v[60:63]
    s_waitcnt vmcnt(11)
    v_mfma_f32_16x16x32_bf16 v[44:47], a[200:203], v[152:155], v[44:47]
    buffer_load_dwordx4 v[200:203], v8, s[16:19], s42 offen offset:2048 sc1
    v_mfma_f32_16x16x32_bf16 v[48:51], a[204:207], v[152:155], v[48:51]
    v_mfma_f32_16x16x32_bf16 v[52:55], a[208:211], v[152:155], v[52:55]
    v_mfma_f32_16x16x32_bf16 v[56:59], a[212:215], v[152:155], v[56:59]
    v_mfma_f32_16x16x32_bf16 v[60:63], a[216:219], v[152:155], v[60:63]
    s_waitcnt vmcnt(11)
    v_mfma_f32_16x16x32_bf16 v[44:47], a[220:223], v[156:159], v[44:47]
    buffer_load_dwordx4 v[204:207], v8, s[16:19], s42 offen offset:3072 sc1
    v_mfma_f32_16x16x32_bf16 v[48:51], a[224:227], v[156:159], v[48:51]
    v_mfma_f32_16x16x32_bf16 v[52:55], a[228:231], v[156:159], v[52:55]
    v_mfma_f32_16x16x32_bf16 v[56:59], a[232:235], v[156:159], v[56:59]
    v_mfma_f32_16x16x32_bf16 v[60:63], a[236:239], v[156:159], v[60:63]
    s_waitcnt vmcnt(11)
    v_mfma_f32_16x16x32_bf16 v[24:27], a[0:3], v[160:163], 0
    buffer_load_dwordx4 v[208:211], v6, s[16:19], s43 offen offset:0 sc1
    v_mfma_f32_16x16x32_bf16 v[28:31], a[4:7], v[160:163], 0
    v_mfma_f32_16x16x32_bf16 v[32:35], a[8:11], v[160:163], 0

    v_mfma_f32_16x16x32_bf16 v[36:39], a[12:15], v[160:163], 0
    v_mfma_f32_16x16x32_bf16 v[40:43], a[16:19], v[160:163], 0
    ds_write_b128 v10, v[44:47] offset:0
    s_waitcnt vmcnt(11)
    v_mfma_f32_16x16x32_bf16 v[24:27], a[20:23], v[164:167], v[24:27]
    buffer_load_dwordx4 v[212:215], v6, s[16:19], s43 offen offset:1024 sc1
    v_mfma_f32_16x16x32_bf16 v[28:31], a[24:27], v[164:167], v[28:31]
    ds_write_b128 v10, v[48:51] offset:1024
    v_mfma_f32_16x16x32_bf16 v[32:35], a[28:31], v[164:167], v[32:35]
    v_mfma_f32_16x16x32_bf16 v[36:39], a[32:35], v[164:167], v[36:39]
    ds_write_b128 v10, v[52:55] offset:2048
    v_mfma_f32_16x16x32_bf16 v[40:43], a[36:39], v[164:167], v[40:43]
    s_waitcnt vmcnt(11)
    v_mfma_f32_16x16x32_bf16 v[24:27], a[40:43], v[168:171], v[24:27]
    ds_write_b128 v10, v[56:59] offset:3072
    buffer_load_dwordx4 v[216:219], v6, s[16:19], s43 offen offset:2048 sc1
    v_mfma_f32_16x16x32_bf16 v[28:31], a[44:47], v[168:171], v[28:31]
    v_mfma_f32_16x16x32_bf16 v[32:35], a[48:51], v[168:171], v[32:35]
    ds_write_b128 v10, v[60:63] offset:4096
    v_mfma_f32_16x16x32_bf16 v[36:39], a[52:55], v[168:171], v[36:39]
    v_mfma_f32_16x16x32_bf16 v[40:43], a[56:59], v[168:171], v[40:43]
    s_waitcnt vmcnt(11)
    v_mfma_f32_16x16x32_bf16 v[24:27], a[60:63], v[172:175], v[24:27]
    buffer_load_dwordx4 v[220:223], v6, s[16:19], s43 offen offset:3072 sc1
    v_mfma_f32_16x16x32_bf16 v[28:31], a[64:67], v[172:175], v[28:31]
    v_mfma_f32_16x16x32_bf16 v[32:35], a[68:71], v[172:175], v[32:35]
    v_mfma_f32_16x16x32_bf16 v[36:39], a[72:75], v[172:175], v[36:39]
    v_mfma_f32_16x16x32_bf16 v[40:43], a[76:79], v[172:175], v[40:43]
    s_waitcnt vmcnt(11)
    v_mfma_f32_16x16x32_bf16 v[24:27], a[80:83], v[176:179], v[24:27]
    buffer_load_dwordx4 v[224:227], v7, s[16:19], s43 offen offset:0 sc1
    v_mfma_f32_16x16x32_bf16 v[28:31], a[84:87], v[176:179], v[28:31]
    v_mfma_f32_16x16x32_bf16 v[32:35], a[88:91], v[176:179], v[32:35]
    v_mfma_f32_16x16x32_bf16 v[36:39], a[92:95], v[176:179], v[36:39]
    v_mfma_f32_16x16x32_bf16 v[40:43], a[96:99], v[176:179], v[40:43]
    s_waitcnt vmcnt(11)
    v_mfma_f32_16x16x32_bf16 v[24:27], a[100:103], v[180:183], v[24:27]
    buffer_load_dwordx4 v[228:231], v7, s[16:19], s43 offen offset:1024 sc1
    v_mfma_f32_16x16x32_bf16 v[28:31], a[104:107], v[180:183], v[28:31]
    v_mfma_f32_16x16x32_bf16 v[32:35], a[108:111], v[180:183], v[32:35]
    v_mfma_f32_16x16x32_bf16 v[36:39], a[112:115], v[180:183], v[36:39]
    v_mfma_f32_16x16x32_bf16 v[40:43], a[116:119], v[180:183], v[40:43]
    s_waitcnt vmcnt(11)
    v_mfma_f32_16x16x32_bf16 v[24:27], a[120:123], v[184:187], v[24:27]
    buffer_load_dwordx4 v[232:235], v7, s[16:19], s43 offen offset:2048 sc1
    v_mfma_f32_16x16x32_bf16 v[28:31], a[124:127], v[184:187], v[28:31]
    v_mfma_f32_16x16x32_bf16 v[32:35], a[128:131], v[184:187], v[32:35]
    v_mfma_f32_16x16x32_bf16 v[36:39], a[132:135], v[184:187], v[36:39]
    v_mfma_f32_16x16x32_bf16 v[40:43], a[136:139], v[184:187], v[40:43]
    s_waitcnt vmcnt(11)
    v_mfma_f32_16x16x32_bf16 v[24:27], a[140:143], v[188:191], v[24:27]
    buffer_load_dwordx4 v[236:239], v7, s[16:19], s43 offen offset:3072 sc1
    v_mfma_f32_16x16x32_bf16 v[28:31], a[144:147], v[188:191], v[28:31]
    v_mfma_f32_16x16x32_bf16 v[32:35], a[148:151], v[188:191], v[32:35]
    v_mfma_f32_16x16x32_bf16 v[36:39], a[152:155], v[188:191], v[36:39]
    v_mfma_f32_16x16x32_bf16 v[40:43], a[156:159], v[188:191], v[40:43]
    s_waitcnt vmcnt(11)
    v_mfma_f32_16x16x32_bf16 v[24:27], a[160:163], v[192:195], v[24:27]
    buffer_load_dwordx4 v[240:243], v8, s[16:19], s43 offen offset:0 sc1
    v_mfma_f32_16x16x32_bf16 v[28:31], a[164:167], v[192:195], v[28:31]
    v_mfma_f32_16x16x32_bf16 v[32:35], a[168:171], v[192:195], v[32:35]
    v_mfma_f32_16x16x32_bf16 v[36:39], a[172:175], v[192:195], v[36:39]
    v_mfma_f32_16x16x32_bf16 v[40:43], a[176:179], v[192:195], v[40:43]
    s_waitcnt vmcnt(11)
    v_mfma_f32_16x16x32_bf16 v[24:27], a[180:183], v[196:199], v[24:27]
    buffer_load_dwordx4 v[244:247], v8, s[16:19], s43 offen offset:1024 sc1
    v_mfma_f32_16x16x32_bf16 v[28:31], a[184:187], v[196:199], v[28:31]
    v_mfma_f32_16x16x32_bf16 v[32:35], a[188:191], v[196:199], v[32:35]
    v_mfma_f32_16x16x32_bf16 v[36:39], a[192:195], v[196:199], v[36:39]
    v_mfma_f32_16x16x32_bf16 v[40:43], a[196:199], v[196:199], v[40:43]
    s_waitcnt vmcnt(11)
    v_mfma_f32_16x16x32_bf16 v[24:27], a[200:203], v[200:203], v[24:27]
    buffer_load_dwordx4 v[248:251], v8, s[16:19], s43 offen offset:2048 sc1
    v_mfma_f32_16x16x32_bf16 v[28:31], a[204:207], v[200:203], v[28:31]
    v_mfma_f32_16x16x32_bf16 v[32:35], a[208:211], v[200:203], v[32:35]
    v_mfma_f32_16x16x32_bf16 v[36:39], a[212:215], v[200:203], v[36:39]
    v_mfma_f32_16x16x32_bf16 v[40:43], a[216:219], v[200:203], v[40:43]
    s_waitcnt vmcnt(11)
    v_mfma_f32_16x16x32_bf16 v[24:27], a[220:223], v[204:207], v[24:27]
    buffer_load_dwordx4 v[252:255], v8, s[16:19], s43 offen offset:3072 sc1
    v_mfma_f32_16x16x32_bf16 v[28:31], a[224:227], v[204:207], v[28:31]
    v_mfma_f32_16x16x32_bf16 v[32:35], a[228:231], v[204:207], v[32:35]
    v_mfma_f32_16x16x32_bf16 v[36:39], a[232:235], v[204:207], v[36:39]
    v_mfma_f32_16x16x32_bf16 v[40:43], a[236:239], v[204:207], v[40:43]
    s_waitcnt vmcnt(11)
    v_mfma_f32_16x16x32_bf16 v[44:47], a[0:3], v[208:211], 0
    v_mfma_f32_16x16x32_bf16 v[48:51], a[4:7], v[208:211], 0
    v_mfma_f32_16x16x32_bf16 v[52:55], a[8:11], v[208:211], 0

    v_mfma_f32_16x16x32_bf16 v[56:59], a[12:15], v[208:211], 0
    v_mfma_f32_16x16x32_bf16 v[60:63], a[16:19], v[208:211], 0
    ds_write_b128 v11, v[24:27] offset:0
    s_waitcnt vmcnt(10)
    v_mfma_f32_16x16x32_bf16 v[44:47], a[20:23], v[212:215], v[44:47]
    v_mfma_f32_16x16x32_bf16 v[48:51], a[24:27], v[212:215], v[48:51]
    ds_write_b128 v11, v[28:31] offset:1024
    v_mfma_f32_16x16x32_bf16 v[52:55], a[28:31], v[212:215], v[52:55]
    v_mfma_f32_16x16x32_bf16 v[56:59], a[32:35], v[212:215], v[56:59]
    ds_write_b128 v11, v[32:35] offset:2048
    v_mfma_f32_16x16x32_bf16 v[60:63], a[36:39], v[212:215], v[60:63]
    s_waitcnt vmcnt(9)
    v_mfma_f32_16x16x32_bf16 v[44:47], a[40:43], v[216:219], v[44:47]
    ds_write_b128 v11, v[36:39] offset:3072
    v_mfma_f32_16x16x32_bf16 v[48:51], a[44:47], v[216:219], v[48:51]
    v_mfma_f32_16x16x32_bf16 v[52:55], a[48:51], v[216:219], v[52:55]
    ds_write_b128 v11, v[40:43] offset:4096
    v_mfma_f32_16x16x32_bf16 v[56:59], a[52:55], v[216:219], v[56:59]
    v_mfma_f32_16x16x32_bf16 v[60:63], a[56:59], v[216:219], v[60:63]
    s_waitcnt vmcnt(8)
    v_mfma_f32_16x16x32_bf16 v[44:47], a[60:63], v[220:223], v[44:47]
    v_mfma_f32_16x16x32_bf16 v[48:51], a[64:67], v[220:223], v[48:51]
    s_waitcnt lgkmcnt(0)
    s_barrier
    ds_read_b64_tr_b16 v[124:125], v13 offset:0
    ds_read_b128 v[64:67], v12 offset:0
    v_mfma_f32_16x16x32_bf16 v[52:55], a[68:71], v[220:223], v[52:55]
    ds_read_b128 v[68:71], v12 offset:5120
    ds_read_b128 v[72:75], v12 offset:10240
    v_mfma_f32_16x16x32_bf16 v[56:59], a[72:75], v[220:223], v[56:59]
    ds_read_b64_tr_b16 v[126:127], v13 offset:512
    ds_read_b128 v[76:79], v12 offset:1024
    v_mfma_f32_16x16x32_bf16 v[60:63], a[76:79], v[220:223], v[60:63]
    ds_read_b128 v[80:83], v12 offset:6144
    ds_read_b128 v[84:87], v12 offset:11264
    s_waitcnt vmcnt(7)
    v_mfma_f32_16x16x32_bf16 v[44:47], a[80:83], v[224:227], v[44:47]
    ds_read_b64_tr_b16 v[128:129], v13 offset:4096
    ds_read_b128 v[88:91], v12 offset:2048
    v_mfma_f32_16x16x32_bf16 v[48:51], a[84:87], v[224:227], v[48:51]
    ds_read_b128 v[92:95], v12 offset:7168
    ds_read_b128 v[96:99], v12 offset:12288
    v_mfma_f32_16x16x32_bf16 v[52:55], a[88:91], v[224:227], v[52:55]
    ds_read_b64_tr_b16 v[130:131], v13 offset:4608
    ds_read_b128 v[100:103], v12 offset:3072
    v_mfma_f32_16x16x32_bf16 v[56:59], a[92:95], v[224:227], v[56:59]
    ds_read_b128 v[104:107], v12 offset:8192
    ds_read_b128 v[108:111], v12 offset:13312
    v_mfma_f32_16x16x32_bf16 v[60:63], a[96:99], v[224:227], v[60:63]
    ds_read_b64_tr_b16 v[132:133], v14 offset:8192
    ds_read_b128 v[112:115], v12 offset:4096
    s_waitcnt vmcnt(6)
    v_mfma_f32_16x16x32_bf16 v[44:47], a[100:103], v[228:231], v[44:47]
    ds_read_b128 v[116:119], v12 offset:9216
    ds_read_b128 v[120:123], v12 offset:14336
    v_mfma_f32_16x16x32_bf16 v[48:51], a[104:107], v[228:231], v[48:51]
    s_waitcnt lgkmcnt(12)
    v_lshlrev_b32 v136, 16, v124
    v_and_b32 v137, 0xffff0000, v124
    v_mfma_f32_16x16x32_bf16 v[52:55], a[108:111], v[228:231], v[52:55]
    v_lshlrev_b32 v138, 16, v125
    v_and_b32 v139, 0xffff0000, v125
    v_mfma_f32_16x16x32_bf16 v[56:59], a[112:115], v[228:231], v[56:59]
    v_add_f32 v64, v64, v68
    v_add_f32 v65, v65, v69
    v_mfma_f32_16x16x32_bf16 v[60:63], a[116:119], v[228:231], v[60:63]
    v_add_f32 v66, v66, v70
    v_add_f32 v67, v67, v71
    s_waitcnt vmcnt(5)
    v_mfma_f32_16x16x32_bf16 v[44:47], a[120:123], v[232:235], v[44:47]
    v_add_f32 v136, v136, v72
    v_add_f32 v137, v137, v73
    v_mfma_f32_16x16x32_bf16 v[48:51], a[124:127], v[232:235], v[48:51]
    v_add_f32 v138, v138, v74
    v_add_f32 v139, v139, v75
    v_mfma_f32_16x16x32_bf16 v[52:55], a[128:131], v[232:235], v[52:55]
    v_add_f32 v136, v136, v64
    v_add_f32 v137, v137, v65
    v_mfma_f32_16x16x32_bf16 v[56:59], a[132:135], v[232:235], v[56:59]
    v_add_f32 v138, v138, v66
    v_add_f32 v139, v139, v67
    v_mfma_f32_16x16x32_bf16 v[60:63], a[136:139], v[232:235], v[60:63]
    s_waitcnt lgkmcnt(12)
    v_lshlrev_b32 v140, 16, v126
    v_and_b32 v141, 0xffff0000, v126
    s_waitcnt vmcnt(4)
    v_mfma_f32_16x16x32_bf16 v[44:47], a[140:143], v[236:239], v[44:47]
    v_lshlrev_b32 v142, 16, v127
    v_and_b32 v143, 0xffff0000, v127
    v_mfma_f32_16x16x32_bf16 v[48:51], a[144:147], v[236:239], v[48:51]
    v_add_f32 v76, v76, v80
    v_add_f32 v77, v77, v81
    v_mfma_f32_16x16x32_bf16 v[52:55], a[148:151], v[236:239], v[52:55]
    v_add_f32 v78, v78, v82
    v_add_f32 v79, v79, v83
    v_mfma_f32_16x16x32_bf16 v[56:59], a[152:155], v[236:239], v[56:59]
    v_add_f32 v140, v140, v84
    v_add_f32 v141, v141, v85
    v_mfma_f32_16x16x32_bf16 v[60:63], a[156:159], v[236:239], v[60:63]
    v_add_f32 v142, v142, v86
    v_add_f32 v143, v143, v87
    s_waitcnt vmcnt(3)
    v_mfma_f32_16x16x32_bf16 v[44:47], a[160:163], v[240:243], v[44:47]
    v_add_f32 v140, v140, v76
    v_add_f32 v141, v141, v77
    v_mfma_f32_16x16x32_bf16 v[48:51], a[164:167], v[240:243], v[48:51]
    v_add_f32 v142, v142, v78
    v_add_f32 v143, v143, v79
    v_mfma_f32_16x16x32_bf16 v[52:55], a[168:171], v[240:243], v[52:55]
    s_waitcnt lgkmcnt(8)
    v_lshlrev_b32 v144, 16, v128
    v_and_b32 v145, 0xffff0000, v128
    v_mfma_f32_16x16x32_bf16 v[56:59], a[172:175], v[240:243], v[56:59]
    v_lshlrev_b32 v146, 16, v129
    v_and_b32 v147, 0xffff0000, v129
    v_mfma_f32_16x16x32_bf16 v[60:63], a[176:179], v[240:243], v[60:63]
    v_add_f32 v88, v88, v92
    v_add_f32 v89, v89, v93
    s_waitcnt vmcnt(2)
    v_mfma_f32_16x16x32_bf16 v[44:47], a[180:183], v[244:247], v[44:47]
    v_add_f32 v90, v90, v94
    v_add_f32 v91, v91, v95
    v_mfma_f32_16x16x32_bf16 v[48:51], a[184:187], v[244:247], v[48:51]
    v_add_f32 v144, v144, v96
    v_add_f32 v145, v145, v97
    v_mfma_f32_16x16x32_bf16 v[52:55], a[188:191], v[244:247], v[52:55]
    v_add_f32 v146, v146, v98
    v_add_f32 v147, v147, v99
    v_mfma_f32_16x16x32_bf16 v[56:59], a[192:195], v[244:247], v[56:59]
    v_add_f32 v144, v144, v88
    v_add_f32 v145, v145, v89
    v_mfma_f32_16x16x32_bf16 v[60:63], a[196:199], v[244:247], v[60:63]
    v_add_f32 v146, v146, v90
    v_add_f32 v147, v147, v91
    s_waitcnt vmcnt(1)
    v_mfma_f32_16x16x32_bf16 v[44:47], a[200:203], v[248:251], v[44:47]
    s_waitcnt lgkmcnt(4)
    v_lshlrev_b32 v148, 16, v130
    v_and_b32 v149, 0xffff0000, v130
    v_mfma_f32_16x16x32_bf16 v[48:51], a[204:207], v[248:251], v[48:51]
    v_lshlrev_b32 v150, 16, v131
    v_and_b32 v151, 0xffff0000, v131
    v_mfma_f32_16x16x32_bf16 v[52:55], a[208:211], v[248:251], v[52:55]
    v_add_f32 v100, v100, v104
    v_add_f32 v101, v101, v105
    v_mfma_f32_16x16x32_bf16 v[56:59], a[212:215], v[248:251], v[56:59]
    v_add_f32 v102, v102, v106
    v_add_f32 v103, v103, v107
    v_mfma_f32_16x16x32_bf16 v[60:63], a[216:219], v[248:251], v[60:63]
    v_add_f32 v148, v148, v108
    v_add_f32 v149, v149, v109
    s_waitcnt vmcnt(0)
    v_mfma_f32_16x16x32_bf16 v[44:47], a[220:223], v[252:255], v[44:47]
    v_add_f32 v150, v150, v110
    v_add_f32 v151, v151, v111
    v_mfma_f32_16x16x32_bf16 v[48:51], a[224:227], v[252:255], v[48:51]
    v_add_f32 v148, v148, v100
    v_add_f32 v149, v149, v101
    v_mfma_f32_16x16x32_bf16 v[52:55], a[228:231], v[252:255], v[52:55]
    v_add_f32 v150, v150, v102
    v_add_f32 v151, v151, v103
    v_mfma_f32_16x16x32_bf16 v[56:59], a[232:235], v[252:255], v[56:59]
    s_waitcnt lgkmcnt(0)
    v_lshlrev_b32 v152, 16, v132
    v_and_b32 v153, 0xffff0000, v132
    v_mfma_f32_16x16x32_bf16 v[60:63], a[236:239], v[252:255], v[60:63]
    v_lshlrev_b32 v154, 16, v133
    v_and_b32 v155, 0xffff0000, v133
    v_add_f32 v112, v112, v116
    v_add_f32 v113, v113, v117
    v_add_f32 v114, v114, v118
    v_add_f32 v115, v115, v119
    v_add_f32 v152, v152, v120
    v_add_f32 v153, v153, v121
    v_add_f32 v154, v154, v122
    v_add_f32 v155, v155, v123
    v_add_f32 v152, v152, v112
    v_add_f32 v153, v153, v113
    v_add_f32 v154, v154, v114
    v_add_f32 v155, v155, v115

    v_pk_add_f32 v[136:137], v[136:137], v[44:45]
    v_pk_add_f32 v[138:139], v[138:139], v[46:47]
    v_cvt_pk_bf16_f32 v64, v136, v137
    v_cvt_pk_bf16_f32 v65, v138, v139
    v_pk_add_f32 v[140:141], v[140:141], v[48:49]
    v_pk_add_f32 v[142:143], v[142:143], v[50:51]
    v_cvt_pk_bf16_f32 v66, v140, v141
    v_cvt_pk_bf16_f32 v67, v142, v143
    buffer_store_dwordx4 v[64:67], v15, s[20:23], s45 offen offset:0
    v_pk_add_f32 v[144:145], v[144:145], v[52:53]
    v_pk_add_f32 v[146:147], v[146:147], v[54:55]
    v_cvt_pk_bf16_f32 v68, v144, v145
    v_cvt_pk_bf16_f32 v69, v146, v147
    v_pk_add_f32 v[148:149], v[148:149], v[56:57]
    v_pk_add_f32 v[150:151], v[150:151], v[58:59]
    v_cvt_pk_bf16_f32 v70, v148, v149
    v_cvt_pk_bf16_f32 v71, v150, v151
    buffer_store_dwordx4 v[68:71], v15, s[20:23], s45 offen offset:64
    v_pk_add_f32 v[152:153], v[152:153], v[60:61]
    v_pk_add_f32 v[154:155], v[154:155], v[62:63]
    v_cvt_pk_bf16_f32 v72, v152, v153
    v_cvt_pk_bf16_f32 v73, v154, v155
    buffer_store_dwordx2 v[72:73], v16, s[20:23], s45 offen offset:128
P_END:
    s_endpgm
G1_REDO:
    s_cmp_lg_u32 s6, 0
    s_cbranch_scc1 G1_CONT
    s_mov_b32 s6, 36864
    s_waitcnt vmcnt(0)
    s_barrier
    s_add_u32 s12, s4, 0xc00000
    s_addc_u32 s13, s5, 0
    s_mov_b32 s14, 0x3c0000
    s_mov_b32 s15, 0x20000
    s_mul_i32 s57, s61, 245760
    s_mul_i32 s31, s28, 3072
    s_add_u32 s57, s57, s31
    s_add_u32 s56, s57, 245760
    s_mul_i32 s39, s3, 12288
    s_add_u32 s39, s39, s57
    v_min_u32 v22, 19, v1
    v_add_u32 v22, s3, v22
    v_subrev_u32 v9, 20, v22
    v_min_u32 v22, v22, v9
    v_lshlrev_b32 v22, 10, v22
    s_lshl_b32 s31, s61, 6
    s_add_u32 s31, s31, 32768
    v_add_u32 v22, s31, v22
    v_lshlrev_b32 v9, 4, v1
    s_branch P_WALL
G1_P:
    s_movk_i32 s58, 0x7fff
PL_9:
    buffer_load_dword v7, v8, s[64:67], 0 offen sc1
    s_waitcnt vmcnt(0)
    v_cmp_ne_u32 vcc, s59, v7
    s_cbranch_vccz PD_10
    s_mov_b64 exec, vcc
    s_sub_u32 s58, s58, 1
    s_cbranch_scc0 PL_9
PD_10:
    s_mov_b64 exec, -1
    s_branch G1_PC
G1_Q:
    s_movk_i32 s58, 0x7fff
G1_QL:
    buffer_load_dwordx4 v[224:227], v10, s[16:19], s27 offen sc1
    buffer_load_dwordx4 v[228:231], v10, s[16:19], s30 offen sc1
    buffer_load_dwordx4 v[232:235], v10, s[16:19], s38 offen sc1
    buffer_load_dwordx4 v[236:239], v10, s[16:19], s45 offen sc1
    s_waitcnt vmcnt(0)
    v_sad_u32 v2, v225, s59, 0
    v_sad_u32 v2, v227, s59, v2 clamp
    v_sad_u32 v2, v229, s59, v2 clamp
    v_sad_u32 v2, v231, s59, v2 clamp
    v_sad_u32 v2, v233, s59, v2 clamp
    v_sad_u32 v2, v235, s59, v2 clamp
    v_sad_u32 v2, v237, s59, v2 clamp
    v_sad_u32 v2, v239, s59, v2 clamp
    v_cmp_ne_u32 vcc, 0, v2
    s_cbranch_vccz G1_QC
    s_sub_u32 s58, s58, 1
    s_cbranch_scc0 G1_QL
    s_branch G1_QC
G1_LS:
    s_waitcnt vmcnt(0)
    s_barrier
    v_and_b32 v2, 0xffff, v16
    v_and_b32 v3, 0xffff, v17
    s_movk_i32 s58, 19
    v_mov_b32 v28, 0
    v_mov_b32 v29, 0
    v_mov_b32 v30, 0
    v_mov_b32 v31, 0
    v_mov_b32 v32, 0
    v_mov_b32 v33, 0
    v_mov_b32 v34, 0
    v_mov_b32 v35, 0
    v_mov_b32 v36, 0
    v_mov_b32 v37, 0
    v_mov_b32 v38, 0
    v_mov_b32 v39, 0
    v_mov_b32 v40, 0
    v_mov_b32 v41, 0
    v_mov_b32 v42, 0
    v_mov_b32 v43, 0
G1_LL:
    ds_read_b64_tr_b16 v[232:233], v2 offset:0
    ds_read_b64_tr_b16 v[234:235], v2 offset:4096
    ds_read_b64_tr_b16 v[236:237], v3 offset:0
    ds_read_b64_tr_b16 v[238:239], v3 offset:4096
    v_add_u32 v2, 8192, v2
    v_add_u32 v3, 8192, v3
    s_waitcnt lgkmcnt(0)
    v_mfma_f32_16x16x32_bf16 v[36:39], v[232:235], v[232:235], v[36:39]
    v_mfma_f32_16x16x32_bf16 v[28:31], v[220:223], v[232:235], v[28:31]
    v_mfma_f32_16x16x32_bf16 v[40:43], v[236:239], v[236:239], v[40:43]
    v_mfma_f32_16x16x32_bf16 v[32:35], v[220:223], v[236:239], v[32:35]
    s_nop 7
    s_sub_u32 s58, s58, 1
    s_cbranch_scc0 G1_LL
    s_nop 7
    v_cndmask_b32 v36, v36, v37, s[68:69]
    v_cndmask_b32 v38, v38, v39, s[68:69]
    v_cndmask_b32 v40, v40, v41, s[68:69]
    v_cndmask_b32 v42, v42, v43, s[68:69]
    v_cndmask_b32 v36, v36, v38, s[70:71]
    v_cndmask_b32 v40, v40, v42, s[70:71]
    v_cndmask_b32 v224, v28, v32, s[74:75]
    s_nop 1
    v_permlane32_swap_b32 v36, v40
    s_nop 1
    v_cndmask_b32 v226, v36, v40, s[72:73]
    s_barrier
    s_branch G1_LSC
    s_endpgm
.section .rodata,"a"
.p2align 6
.amdhsa_kernel sequential_preLN__ssm_conv_s4d__geglu_ffn__prompt_kernel
  .amdhsa_next_free_vgpr 512
  .amdhsa_next_free_sgpr 80
  .amdhsa_accum_offset 256
  .amdhsa_group_segment_fixed_size 0
  .amdhsa_kernarg_size 112
  .amdhsa_user_sgpr_count 2
  .amdhsa_user_sgpr_kernarg_segment_ptr 1
  .amdhsa_system_sgpr_workgroup_id_x 1
.end_amdhsa_kernel
```
